```python
import torch

def _softmax(x, axis=-1):
    return torch.softmax(x, dim=axis)

def _gelu(x):
    return torch.nn.functional.gelu(x, approximate='tanh')

def _silu(x):
    return torch.nn.functional.silu(x)

def _sigmoid(x):
    return torch.sigmoid(x)

def _layernorm(x, axis=-1, eps=1e-05):
    m = x.mean(dim=axis, keepdim=True)
    v = x.var(dim=axis, keepdim=True, unbiased=False)
    return (x - m) / torch.sqrt(v + eps)

def _scatter_add(tgt, idx, src, axis=0):
    return tgt.clone().index_add_(axis, idx, src)

def _segment_sum(src, seg, n):
    out = torch.zeros((n,) + src.shape[1:], dtype=src.dtype)
    return out.index_add_(0, seg, src)

def _pad(x, pw):
    flat = tuple((v for pair in reversed(pw) for v in pair))
    return torch.nn.functional.pad(x, flat)
kernel_name = 'adaLN_cond__grouped_kv_mqa__dense_activation_silu__prompt'

def setup_inputs():

    _w = lambda a: (lambda t: t.to(torch.bfloat16) if t.is_floating_point() else t)(torch.as_tensor(a))

    def _A_setup():
        B, S, D, H = (1, 2048, 512, 32)
        Dh = D // H
        return {'x': _w((lambda *s: torch.randn(*s, dtype=torch.bfloat16) * 0.05)(B, S, D)), 'wq': _w((lambda *s: torch.randn(*s, dtype=torch.bfloat16) * 0.05)(D, H * Dh)), 'wk': _w((lambda *s: torch.randn(*s, dtype=torch.bfloat16) * 0.05)(D, Dh)), 'wv': _w((lambda *s: torch.randn(*s, dtype=torch.bfloat16) * 0.05)(D, Dh)), 'wo': _w((lambda *s: torch.randn(*s, dtype=torch.bfloat16) * 0.05)(H * Dh, D))}
    _A_in = _A_setup()

    def _B_setup():
        B, S, D, F = (1, 2048, 512, 1376)
        return {'x': _w((lambda *s: torch.randn(*s, dtype=torch.bfloat16) * 0.05)(B, S, D)), 'w1': _w((lambda *s: torch.randn(*s, dtype=torch.bfloat16) * 3.2)(D, F) * D ** (-0.5)), 'w2': _w((lambda *s: torch.randn(*s, dtype=torch.bfloat16) * 1.6)(F, D) * F ** (-0.5))}
    _B_in = _B_setup()
    return {'A_x': _A_in['x'], 'A_wq': _A_in['wq'], 'A_wk': _A_in['wk'], 'A_wv': _A_in['wv'], 'A_wo': _A_in['wo'], 'B_x': _B_in['x'], 'B_w1': _B_in['w1'], 'B_w2': _B_in['w2'], 'c': _w((lambda *s: torch.randn(*s, dtype=torch.bfloat16) * 0.1)(1, 512) * 8.0), 'w_mod': _w((lambda *s: torch.randn(*s, dtype=torch.bfloat16) * 0.1)(512, 6 * 512) * 512 ** (-0.5) * 8.0)}

def reference(A_x, A_wq, A_wk, A_wv, A_wo, B_x, B_w1, B_w2, c, w_mod):

    def _A_ref(x, wq, wk, wv, wo):
        B, S, D = x.shape
        H = 32
        Dh = D // H
        q = (lambda x, *d: x.permute(*d))((x @ wq).reshape(B, S, H, Dh), 0, 2, 1, 3)
        k = x @ wk
        v = x @ wv
        scores = torch.einsum('bhqd,bkd->bhqk', q, k) * Dh ** (-0.5)
        p = _softmax(scores, axis=-1)
        o = torch.einsum('bhqk,bkd->bhqd', p, v)
        return (lambda x, *d: x.permute(*d))(o, 0, 2, 1, 3).reshape(B, S, H * Dh) @ wo

    def _B_ref(x, w1, w2):
        h = torch.einsum('bsd,df->bsf', x, w1)
        h = _silu(h)
        out = torch.einsum('bsf,fd->bsd', h, w2)
        return out
    x = A_x
    mod = (_silu(c) @ w_mod).reshape(c.shape[0], 6, 1, -1)
    sa, ca, ga, sb, cb, gb = (mod[:, 0].clone(), mod[:, 1].clone(), mod[:, 2].clone(), mod[:, 3].clone(), mod[:, 4].clone(), mod[:, 5].clone())
    h = _layernorm(x, axis=-1) * (1 + ca) + sa
    x = x + ga * _A_ref(h, A_wq, A_wk, A_wv, A_wo)
    h = _layernorm(x, axis=-1) * (1 + cb) + sb
    x = x + gb * _B_ref(h, B_w1, B_w2)
    return x
```

```asm
; @launch grid=(256,1,1) block=(512,1,1) lds=163840
.amdgcn_target "amdgcn-amd-amdhsa--gfx950"
.text
.globl adaLN_cond__grouped_kv_mqa__dense_activation_silu__prompt_kernel
.p2align 8
.type adaLN_cond__grouped_kv_mqa__dense_activation_silu__prompt_kernel,@function
adaLN_cond__grouped_kv_mqa__dense_activation_silu__prompt_kernel:
    s_cmp_ge_u32 s2, 256
    s_cbranch_scc1 L_kb_end
    s_load_dwordx8 s[80:87], s[0:1], 64
    s_load_dwordx16 s[64:79], s[0:1], 0
    s_load_dwordx2 s[6:7], s[0:1], 96
    v_lshrrev_b32 v1, 6, v0
    s_and_b32 s28, s2, 7
    v_readfirstlane_b32 s3, v1
    s_lshr_b32 s29, s2, 3
    v_and_b32 v1, 63, v0
    v_lshlrev_b32 v2, 4, v1
    v_lshrrev_b32 v12, 3, v1
    v_and_b32 v15, 0x70, v2
    v_mul_u32_u24 v5, 6144, v12
    v_add_u32 v5, v5, v15
    v_lshlrev_b32 v9, 1, v1
    v_mov_b32 v10, 0
    s_mov_b32 s47, 0x20000
    s_mov_b32 s11, s47
    s_mov_b32 s15, s47
    s_mov_b32 s99, s47
    s_lshl_b32 s48, s28, 3
    s_add_u32 s48, s48, s29
    s_lshr_b32 s37, s48, 4
    s_lshl_b32 s37, s37, 3
    s_add_u32 s37, s37, s3
    s_mul_i32 s39, s37, 98304
    s_and_b32 s40, s48, 15
    s_lshl_b32 s40, s40, 7
    s_add_u32 s39, s39, s40
    s_lshl_b32 s37, s37, 5
    s_mul_i32 s34, s3, 12288
    s_add_u32 s41, s34, 10240
    s_mov_b32 m0, s41
    s_mov_b32 s46, 3145728
    s_movk_i32 s10, 1024
    s_mov_b32 s14, 0x1000000
    s_mov_b32 s49, 61440
    s_mov_b32 s98, 0x200000
    s_lshl_b32 s20, s28, 5
    s_add_u32 s20, s20, s29
    s_lshr_b32 s90, s20, 2
    s_and_b32 s91, s29, 3
    s_lshl_b32 s31, s90, 5
    s_lshl2_add_u32 s32, s3, s91
    s_add_u32 s31, s31, s32
    s_lshl_b32 s31, s31, 10
    s_cmp_ge_u32 s29, 8
    s_waitcnt lgkmcnt(0)
    s_mov_b64 s[12:13], s[6:7]
    s_cbranch_scc1 L_f_nomod1
    s_mov_b64 s[44:45], s[82:83]
    s_mov_b64 s[8:9], s[80:81]
    buffer_load_ushort v84, v9, s[8:11], s37 offen
    buffer_load_dwordx4 v5, s[44:47], s39 offen lds
    s_add_u32 s39, s39, 48128
    buffer_load_dwordx4 v5, s[44:47], s39 offen offset:1024 lds
    buffer_load_dword v11, v10, s[12:15], s49 offen sc1
L_f_nomod1:
    s_getpc_b64 s[56:57]
    s_lshl_b32 s58, s3, 9
    s_add_u32 s56, s56, s58
    s_addc_u32 s57, s57, 0
    s_load_dword s58, s[56:57], 256
    s_load_dword s58, s[56:57], 320
    s_load_dword s58, s[56:57], 384
    s_load_dword s58, s[56:57], 448
    s_load_dword s58, s[56:57], 512
    s_load_dword s58, s[56:57], 576
    s_load_dword s58, s[56:57], 640
    s_load_dword s58, s[56:57], 704
    s_barrier
    s_mov_b64 s[96:97], s[64:65]
    buffer_load_dwordx4 v[32:35], v2, s[96:99], s31 offen
    buffer_load_dword v11, v10, s[12:15], s49 offen sc1
    s_xor_b32 s37, s31, 1024
    buffer_load_dwordx4 v[36:39], v2, s[96:99], s37 offen
    s_mov_b32 s8, s66
    s_mov_b32 s9, s67
    s_mov_b32 s10, 524288
    v_lshlrev_b32 v4, 2, v1
    v_and_b32 v8, 3, v1
    v_lshrrev_b32 v7, 2, v1
    v_lshlrev_b32 v7, 10, v7
    v_lshl_add_u32 v3, v8, 4, v7
    s_lshr_b32 s51, s3, 2
    s_and_b32 s52, s3, 3
    s_lshl_b32 s33, s51, 18
    s_lshl_b32 s35, s91, 8
    s_add_u32 s33, s33, s35
    s_lshl_b32 s35, s52, 6
    s_add_u32 s33, s33, s35
    s_lshr_b32 s35, s29, 2
    s_lshl_b32 s35, s35, 1
    v_bfe_u32 v6, v1, 2, 2
    v_lshrrev_b32 v17, 4, v1
    v_bfe_u32 v31, v1, 5, 1
    v_and_b32 v30, 31, v1
    v_bfe_u32 v13, v1, 4, 1
    v_lshl_add_u32 v7, v31, 3, v6
    v_lshlrev_b32 v14, 5, v13
    v_lshl_add_u32 v14, v8, 3, v14
    s_barrier
    s_cmp_ge_u32 s29, 8
    s_cbranch_scc1 L_f_nomod2
    s_lshl_b32 s37, s3, 7
    s_add_u32 s37, s37, 151552
    v_add_u32 v86, s37, v9
    v_lshl_add_u32 v88, v31, 4, s37
    s_lshl_b32 s37, s3, 8
    s_add_u32 s37, s37, 147456
    v_add_u32 v87, s37, v4
    v_lshl_add_u32 v89, v7, 7, v14
    v_add_u32 v89, s41, v89
    s_waitcnt vmcnt(6)
    v_lshlrev_b32 v84, 16, v84
    v_mul_f32 v85, 0xbfb8aa3b, v84
    v_exp_f32 v85, v85
    s_nop 0
    v_add_f32 v85, 1.0, v85
    v_rcp_f32 v85, v85
    s_nop 0
    v_mul_f32 v84, v84, v85
    v_cvt_pk_bf16_f32 v84, v84, v84
    ds_write_b16 v86, v84
    v_add_u32 v86, 147456, v4
    s_waitcnt lgkmcnt(0)
    ds_read_b128 v[132:135], v88
    s_waitcnt vmcnt(3)
    ds_read_b64_tr_b16 v[136:137], v89 offset:0
    ds_read_b64_tr_b16 v[138:139], v89 offset:512
    ds_read_b64_tr_b16 v[140:141], v89 offset:64
    ds_read_b64_tr_b16 v[142:143], v89 offset:576
    v_add_u32 v91, 1, v11
    s_waitcnt lgkmcnt(0)
    v_mfma_f32_32x32x16_bf16 v[96:111], v[132:135], v[136:139], 0
    v_mfma_f32_32x32x16_bf16 v[112:127], v[132:135], v[140:143], 0
    s_mov_b32 exec_hi, 0
    s_nop 9
    ds_write_b32 v87, v96
    ds_write_b32 v87, v112 offset:128
    s_mov_b64 exec, -1
    s_waitcnt lgkmcnt(0)
    s_barrier
    s_cmp_lg_u32 s3, 0
    s_cbranch_scc1 L_f_nomod2
    ds_read2st64_b32 v[132:133], v86 offset0:0 offset1:1
    ds_read2st64_b32 v[134:135], v86 offset0:2 offset1:3
    ds_read2st64_b32 v[136:137], v86 offset0:4 offset1:5
    ds_read2st64_b32 v[138:139], v86 offset0:6 offset1:7
    s_lshl_b32 s37, s48, 9
    v_lshlrev_b32 v86, 3, v1
    s_waitcnt lgkmcnt(0)
    v_pk_add_f32 v[132:133], v[132:133], v[134:135]
    v_pk_add_f32 v[136:137], v[136:137], v[138:139]
    v_pk_add_f32 v[132:133], v[132:133], v[136:137]
    v_add_f32 v90, v132, v133
    buffer_store_dwordx2 v[90:91], v86, s[12:15], s37 offen sc1
L_f_nomod2:
    s_cmp_lg_u32 s3, 1
    s_cbranch_scc1 L_f_nowo1
    s_lshr_b32 s53, s29, 1
    s_and_b32 s54, s29, 1
    s_lshl_b32 s53, s53, 15
    s_lshl_b32 s54, s54, 6
    s_add_u32 s53, s53, s54
    s_lshl_b32 s54, s28, 7
    s_add_u32 s53, s53, s54
    s_mov_b32 m0, 153600
    s_mov_b32 s44, s72
    s_mov_b32 s45, s73
    s_mov_b32 s46, 0x80000
    buffer_load_dwordx4 v3, s[44:47], s53 offen lds
    s_add_u32 s53, s53, 15360
    buffer_load_dwordx4 v3, s[44:47], s53 offen offset:1024 lds
L_f_nowo1:
    s_cmp_lg_u32 s3, 3
    s_cbranch_scc1 L_f_nokv0
    s_cmp_ge_u32 s91, 2
    s_cselect_b32 s44, s70, s68
    s_cselect_b32 s45, s71, s69
    s_mov_b32 s46, 16384
    s_lshl_b32 s39, s35, 9
    s_mov_b32 s37, 131072
L_f_kvl:
    s_mov_b32 m0, s37
    s_and_b32 s53, s39, 8191
    buffer_load_dwordx4 v2, s[44:47], s53 offen lds
    s_add_u32 m0, s37, 8192
    s_add_u32 s53, s53, 8192
    buffer_load_dwordx4 v2, s[44:47], s53 offen lds
    s_add_u32 s39, s39, 1024
    s_add_u32 s37, s37, 1024
    s_cmp_lt_u32 s37, 139264
    s_cbranch_scc1 L_f_kvl
L_f_nokv0:
    s_xor_b32 s37, s31, 2048
    buffer_load_dwordx4 v[40:43], v2, s[96:99], s37 offen
    s_xor_b32 s37, s31, 3072
    buffer_load_dwordx4 v[44:47], v2, s[96:99], s37 offen
    s_add_u32 m0, s34, 0
    s_add_u32 s37, s35, 0
    s_and_b32 s37, s37, 15
    s_lshl_b32 s37, s37, 14
    s_add_u32 s37, s37, s33
    buffer_load_dwordx4 v3, s[8:11], s37 offen lds
    s_add_u32 s37, s37, 15360
    buffer_load_dwordx4 v3, s[8:11], s37 offen offset:1024 lds
    s_cmp_lg_u32 s3, 5
    s_cbranch_scc1 L_f_notouch
    v_lshlrev_b32 v16, 7, v1
    s_getpc_b64 s[44:45]
    s_mov_b32 s46, 0x9000
    s_lshl_b32 s53, s29, 10
    s_mov_b64 exec, 0xff
    buffer_load_dword v252, v16, s[44:47], s53 offen offset:3072
    s_lshl_b32 s53, s28, 10
    s_add_u32 s53, s53, 40960
    buffer_load_dword v252, v16, s[12:15], s53 offen
    s_lshl_b32 s53, s28, 9
    s_add_u32 s53, s53, 49152
    buffer_load_dword v252, v16, s[12:15], s53 offen
    s_mov_b64 exec, -1
    s_mov_b32 s44, s80
    s_mov_b32 s45, s81
    s_mov_b32 s46, 1024
    s_lshl_b32 s53, s28, 7
    buffer_load_ushort v84, v9, s[44:47], s53 offen
L_f_notouch:
    s_barrier
    s_add_u32 m0, s34, 2048
    s_add_u32 s37, s35, 2
    s_and_b32 s37, s37, 15
    s_lshl_b32 s37, s37, 14
    s_add_u32 s37, s37, s33
    buffer_load_dwordx4 v3, s[8:11], s37 offen lds
    s_add_u32 s37, s37, 15360
    buffer_load_dwordx4 v3, s[8:11], s37 offen offset:1024 lds
    v_lshl_add_u32 v16, v7, 6, v14
    v_add_u32 v16, s34, v16
    v_mov_b32 v18, 0x3f803f80
    s_waitcnt vmcnt(8)
    v_dot2_f32_bf16 v128, v32, v18, 0
    v_dot2_f32_bf16 v129, v32, v32, 0
    v_dot2_f32_bf16 v128, v33, v18, v128
    v_dot2_f32_bf16 v129, v33, v33, v129
    v_dot2_f32_bf16 v128, v34, v18, v128
    v_dot2_f32_bf16 v129, v34, v34, v129
    v_dot2_f32_bf16 v128, v35, v18, v128
    v_dot2_f32_bf16 v129, v35, v35, v129
    s_waitcnt vmcnt(6)
    v_dot2_f32_bf16 v130, v36, v18, 0
    v_dot2_f32_bf16 v131, v36, v36, 0
    v_dot2_f32_bf16 v130, v37, v18, v130
    v_dot2_f32_bf16 v131, v37, v37, v131
    v_dot2_f32_bf16 v130, v38, v18, v130
    v_dot2_f32_bf16 v131, v38, v38, v131
    v_dot2_f32_bf16 v130, v39, v18, v130
    v_dot2_f32_bf16 v131, v39, v39, v131
    s_waitcnt vmcnt(5)
    v_dot2_f32_bf16 v132, v40, v18, 0
    v_dot2_f32_bf16 v133, v40, v40, 0
    v_dot2_f32_bf16 v132, v41, v18, v132
    v_dot2_f32_bf16 v133, v41, v41, v133
    v_dot2_f32_bf16 v132, v42, v18, v132
    v_dot2_f32_bf16 v133, v42, v42, v133
    v_dot2_f32_bf16 v132, v43, v18, v132
    v_dot2_f32_bf16 v133, v43, v43, v133
    s_waitcnt vmcnt(4)
    v_dot2_f32_bf16 v134, v44, v18, 0
    v_dot2_f32_bf16 v135, v44, v44, 0
    v_dot2_f32_bf16 v134, v45, v18, v134
    v_dot2_f32_bf16 v135, v45, v45, v135
    v_dot2_f32_bf16 v134, v46, v18, v134
    v_dot2_f32_bf16 v135, v46, v46, v135
    v_dot2_f32_bf16 v134, v47, v18, v134
    v_dot2_f32_bf16 v135, v47, v47, v135
    v_readfirstlane_b32 s92, v11
    s_getreg_b32 s4, hwreg(HW_REG_XCC_ID, 0, 4)
    s_add_u32 s92, s92, 1
    s_add_u32 s4, s4, 8
    s_lshl_b32 s4, s4, 28
    s_xor_b32 s4, s4, s92
    s_lshl_b32 s42, s20, 5
    s_add_u32 s42, s42, 327680
    s_cmp_lg_u32 s3, 1
    s_cbranch_scc1 L_f_nowo2
    v_lshlrev_b32 v82, 4, v31
    v_lshl_add_u32 v82, v13, 2, v82
    v_and_b32 v83, 1, v6
    v_add_u32 v82, v82, v83
    v_lshrrev_b32 v83, 1, v6
    v_lshl_add_u32 v82, v83, 3, v82
    v_lshlrev_b32 v82, 6, v82
    v_lshl_add_u32 v82, v8, 3, v82
    v_add_u32 v82, 153600, v82
    ds_read_b64_tr_b16 v[88:89], v82 offset:0
    ds_read_b64_tr_b16 v[90:91], v82 offset:128
    ds_read_b64_tr_b16 v[92:93], v82 offset:32
    ds_read_b64_tr_b16 v[94:95], v82 offset:160
    s_lshr_b32 s37, s29, 1
    s_and_b32 s38, s29, 1
    s_lshl_b32 s38, s38, 12
    s_lshl_b32 s53, s28, 13
    s_add_u32 s38, s38, s53
    s_lshr_b32 s53, s37, 1
    s_lshl_b32 s53, s53, 16
    s_add_u32 s38, s38, s53
    s_and_b32 s53, s37, 1
    s_lshl_b32 s53, s53, 10
    s_add_u32 s38, s38, s53
    s_add_u32 s38, s38, 524288
    s_waitcnt lgkmcnt(0)
    buffer_store_dwordx4 v[88:91], v2, s[12:15], s38 offen offset:0 sc1
    buffer_store_dwordx4 v[92:95], v2, s[12:15], s38 offen offset:2048 sc1
L_f_nowo2:
    s_lshl_b32 s54, s3, 10
    s_add_u32 m0, s34, 4096
    s_add_u32 s37, s35, 4
    s_and_b32 s37, s37, 15
    s_lshl_b32 s37, s37, 14
    s_add_u32 s37, s37, s33
    buffer_load_dwordx4 v3, s[8:11], s37 offen lds
    s_add_u32 s37, s37, 15360
    buffer_load_dwordx4 v3, s[8:11], s37 offen offset:1024 lds
    v_permlane32_swap_b32 v128, v132
    v_permlane32_swap_b32 v129, v133
    v_permlane32_swap_b32 v130, v134
    v_permlane32_swap_b32 v131, v135
    v_add_f32 v128, v128, v132
    v_add_f32 v129, v129, v133
    v_add_f32 v130, v130, v134
    v_add_f32 v131, v131, v135
    v_lshlrev_b32 v48, 16, v32
    v_and_b32 v49, 0xffff0000, v32
    v_permlane16_swap_b32 v128, v130
    v_permlane16_swap_b32 v129, v131
    v_add_f32 v128, v128, v130
    v_add_f32 v129, v129, v131
    v_lshlrev_b32 v50, 16, v33
    v_add_f32_dpp v128, v128, v128 row_ror:1 row_mask:0xf bank_mask:0xf
    v_add_f32_dpp v129, v129, v129 row_ror:1 row_mask:0xf bank_mask:0xf
    v_and_b32 v51, 0xffff0000, v33
    v_add_f32_dpp v128, v128, v128 row_ror:2 row_mask:0xf bank_mask:0xf
    v_add_f32_dpp v129, v129, v129 row_ror:2 row_mask:0xf bank_mask:0xf
    v_lshlrev_b32 v52, 16, v34
    v_add_f32_dpp v128, v128, v128 row_ror:4 row_mask:0xf bank_mask:0xf
    v_add_f32_dpp v129, v129, v129 row_ror:4 row_mask:0xf bank_mask:0xf
    v_and_b32 v53, 0xffff0000, v34
    v_add_f32_dpp v128, v128, v128 row_ror:8 row_mask:0xf bank_mask:0xf
    v_add_f32_dpp v129, v129, v129 row_ror:8 row_mask:0xf bank_mask:0xf
    v_mul_f32 v128, 0x3b000000, v128
    v_lshlrev_b32 v54, 16, v35
    v_mul_f32 v129, 0x3b000000, v129
    v_and_b32 v55, 0xffff0000, v35
    v_fma_f32 v129, -v128, v128, v129
    v_lshlrev_b32 v56, 16, v36
    v_max_f32 v129, 0, v129
    v_and_b32 v57, 0xffff0000, v36
    v_cvt_pk_bf16_f32 v129, v129, v128
    v_lshlrev_b32 v58, 16, v37
    v_and_b32 v128, 0xffff0000, v129
    v_and_b32 v59, 0xffff0000, v37
    v_lshlrev_b32 v129, 16, v129
    v_lshlrev_b32 v60, 16, v38
    v_add_f32 v129, 0x3727c5ac, v129
    v_and_b32 v61, 0xffff0000, v38
    v_cvt_pk_bf16_f32 v129, v129, v129
    v_lshlrev_b32 v62, 16, v39
    v_lshlrev_b32 v129, 16, v129
    v_and_b32 v63, 0xffff0000, v39
    v_sqrt_f32 v129, v129
    v_lshlrev_b32 v64, 16, v40
    v_cvt_pk_bf16_f32 v129, v129, v129
    v_and_b32 v65, 0xffff0000, v40
    v_lshlrev_b32 v129, 16, v129
    v_lshlrev_b32 v66, 16, v41
    v_rcp_f32 v129, v129
    v_and_b32 v67, 0xffff0000, v41
    v_mul_f32 v128, -v128, v129
    v_lshlrev_b32 v68, 16, v42
    s_add_u32 s53, s54, 0
    buffer_load_dwordx4 v[208:211], v2, s[12:15], s53 offen sc1
    s_add_u32 s53, s54, 8192
    buffer_load_dwordx4 v[212:215], v2, s[12:15], s53 offen sc1
    s_add_u32 s53, s54, 16384
    buffer_load_dwordx4 v[216:219], v2, s[12:15], s53 offen sc1
    s_add_u32 s53, s54, 24576
    buffer_load_dwordx4 v[220:223], v2, s[12:15], s53 offen sc1
    v_readlane_b32 s56, v128, 0
    v_readlane_b32 s57, v129, 0
    v_readlane_b32 s58, v128, 16
    v_readlane_b32 s59, v129, 16
    v_readlane_b32 s60, v128, 32
    v_readlane_b32 s61, v129, 32
    v_readlane_b32 s40, v128, 48
    v_readlane_b32 s41, v129, 48
    v_and_b32 v69, 0xffff0000, v42
    v_lshlrev_b32 v70, 16, v43
    v_and_b32 v71, 0xffff0000, v43
    v_lshlrev_b32 v72, 16, v44
    v_and_b32 v73, 0xffff0000, v44
    v_lshlrev_b32 v74, 16, v45
    v_and_b32 v75, 0xffff0000, v45
    v_lshlrev_b32 v76, 16, v46
    v_and_b32 v77, 0xffff0000, v46
    v_lshlrev_b32 v78, 16, v47
    v_and_b32 v79, 0xffff0000, v47
    v_pk_fma_f32 v[48:49], v[48:49], s[56:57], s[56:57] op_sel:[0,1,0] op_sel_hi:[1,1,0]
    v_pk_fma_f32 v[50:51], v[50:51], s[56:57], s[56:57] op_sel:[0,1,0] op_sel_hi:[1,1,0]
    v_pk_fma_f32 v[52:53], v[52:53], s[56:57], s[56:57] op_sel:[0,1,0] op_sel_hi:[1,1,0]
    v_pk_fma_f32 v[54:55], v[54:55], s[56:57], s[56:57] op_sel:[0,1,0] op_sel_hi:[1,1,0]
    v_pk_fma_f32 v[56:57], v[56:57], s[58:59], s[58:59] op_sel:[0,1,0] op_sel_hi:[1,1,0]
    v_pk_fma_f32 v[58:59], v[58:59], s[58:59], s[58:59] op_sel:[0,1,0] op_sel_hi:[1,1,0]
    v_pk_fma_f32 v[60:61], v[60:61], s[58:59], s[58:59] op_sel:[0,1,0] op_sel_hi:[1,1,0]
    v_pk_fma_f32 v[62:63], v[62:63], s[58:59], s[58:59] op_sel:[0,1,0] op_sel_hi:[1,1,0]
    v_pk_fma_f32 v[64:65], v[64:65], s[60:61], s[60:61] op_sel:[0,1,0] op_sel_hi:[1,1,0]
    v_pk_fma_f32 v[66:67], v[66:67], s[60:61], s[60:61] op_sel:[0,1,0] op_sel_hi:[1,1,0]
    v_pk_fma_f32 v[68:69], v[68:69], s[60:61], s[60:61] op_sel:[0,1,0] op_sel_hi:[1,1,0]
    v_pk_fma_f32 v[70:71], v[70:71], s[60:61], s[60:61] op_sel:[0,1,0] op_sel_hi:[1,1,0]
    v_pk_fma_f32 v[72:73], v[72:73], s[40:41], s[40:41] op_sel:[0,1,0] op_sel_hi:[1,1,0]
    v_pk_fma_f32 v[74:75], v[74:75], s[40:41], s[40:41] op_sel:[0,1,0] op_sel_hi:[1,1,0]
    v_pk_fma_f32 v[76:77], v[76:77], s[40:41], s[40:41] op_sel:[0,1,0] op_sel_hi:[1,1,0]
    v_pk_fma_f32 v[78:79], v[78:79], s[40:41], s[40:41] op_sel:[0,1,0] op_sel_hi:[1,1,0]
    s_lshl_b32 s53, s35, 1
    v_subrev_u32 v19, s53, v30
    v_and_b32 v19, 31, v19
    v_lshlrev_b32 v18, 9, v19
    v_lshl_add_u32 v18, v31, 14, v18
    v_add_u32 v18, 98304, v18
    v_and_b32 v19, 7, v19
    s_lshl_b32 s53, s3, 2
    s_add_u32 s53, s53, s91
    v_xor_b32 v19, s53, v19
    v_lshlrev_b32 v19, 4, v19
    v_add_u32 v132, v19, v18
    v_xad_u32 v133, v19, 16, v18
    v_xad_u32 v134, v19, 32, v18
    v_xad_u32 v135, v19, 48, v18
    s_lshl_b32 s53, s51, 11
    s_lshl_b32 s39, s52, 8
    s_add_u32 s53, s53, s39
    s_add_u32 s53, s53, 147456
    v_and_b32 v28, 0xf0, v4
    v_bfe_u32 v29, v1, 1, 1
    v_lshl_add_u32 v28, v29, 10, v28
    v_and_b32 v29, 1, v1
    v_lshl_add_u32 v28, v29, 3, v28
    v_add_u32 v28, s53, v28
    v_add_u32 v29, 147456, v2
    s_lshl_b32 s53, s51, 14
    s_add_u32 s53, s53, 98304
    v_lshl_add_u32 v20, v31, 9, s53
    v_add_u32 v24, 0, v31
    v_xor_b32 v24, v24, v30
    v_lshl_add_u32 v24, v24, 4, v20
    v_add_u32 v25, 2, v31
    v_xor_b32 v25, v25, v30
    v_lshl_add_u32 v25, v25, 4, v20
    v_add_u32 v26, 4, v31
    v_xor_b32 v26, v26, v30
    v_lshl_add_u32 v26, v26, 4, v20
    v_add_u32 v27, 6, v31
    v_xor_b32 v27, v27, v30
    v_lshl_add_u32 v27, v27, 4, v20
    v_lshl_add_u32 v136, v17, 3, v6
    v_lshlrev_b32 v136, 5, v136
    v_lshl_add_u32 v136, v8, 3, v136
    v_add_u32 v136, 131072, v136
    v_and_b32 v18, 15, v1
    s_and_b32 s39, s91, 1
    s_lshl_b32 s39, s39, 4
    v_add_u32 v19, s39, v18
    v_xor_b32 v20, v17, v19
    v_xor_b32 v21, 4, v20
    v_lshlrev_b32 v20, 4, v20
    v_lshlrev_b32 v21, 4, v21
    v_lshl_add_u32 v20, v17, 9, v20
    v_lshl_add_u32 v21, v17, 9, v21
    v_add_u32 v20, 98304, v20
    v_add_u32 v21, 98304, v21
    s_cmp_lg_u32 s3, 3
    s_cbranch_scc1 L_f_nokvw
    ds_read_b64_tr_b16 v[80:81], v136 offset:0
    ds_read_b64_tr_b16 v[82:83], v136 offset:128
    ds_read_b64_tr_b16 v[84:85], v136 offset:1024
    ds_read_b64_tr_b16 v[86:87], v136 offset:1152
    ds_read_b64_tr_b16 v[88:89], v136 offset:2048
    ds_read_b64_tr_b16 v[90:91], v136 offset:2176
    ds_read_b64_tr_b16 v[92:93], v136 offset:3072
    ds_read_b64_tr_b16 v[94:95], v136 offset:3200
    ds_read_b64_tr_b16 v[96:97], v136 offset:4096
    ds_read_b64_tr_b16 v[98:99], v136 offset:4224
    ds_read_b64_tr_b16 v[100:101], v136 offset:5120
    ds_read_b64_tr_b16 v[102:103], v136 offset:5248
    ds_read_b64_tr_b16 v[104:105], v136 offset:6144
    ds_read_b64_tr_b16 v[106:107], v136 offset:6272
    ds_read_b64_tr_b16 v[108:109], v136 offset:7168
    ds_read_b64_tr_b16 v[110:111], v136 offset:7296
    ds_read_b64_tr_b16 v[228:229], v136 offset:8192
    ds_read_b64_tr_b16 v[230:231], v136 offset:8320
    ds_read_b64_tr_b16 v[232:233], v136 offset:9216
    ds_read_b64_tr_b16 v[234:235], v136 offset:9344
    ds_read_b64_tr_b16 v[236:237], v136 offset:10240
    ds_read_b64_tr_b16 v[238:239], v136 offset:10368
    ds_read_b64_tr_b16 v[240:241], v136 offset:11264
    ds_read_b64_tr_b16 v[242:243], v136 offset:11392
    ds_read_b64_tr_b16 v[244:245], v136 offset:12288
    ds_read_b64_tr_b16 v[246:247], v136 offset:12416
    ds_read_b64_tr_b16 v[248:249], v136 offset:13312
    ds_read_b64_tr_b16 v[250:251], v136 offset:13440
    ds_read_b64_tr_b16 v[140:141], v136 offset:14336
    ds_read_b64_tr_b16 v[142:143], v136 offset:14464
    ds_read_b64_tr_b16 v[128:129], v136 offset:15360
    ds_read_b64_tr_b16 v[130:131], v136 offset:15488
L_f_nokvw:
    s_waitcnt vmcnt(0)
    s_add_u32 s53, s42, 8192
    s_cmp_lg_u32 s3, 1
    s_cselect_b32 s53, 0x40000000, s53
    v_mov_b32 v137, s92
    s_mov_b64 exec, 1
    buffer_store_dword v137, v10, s[12:15], s53 offen sc1
    s_mov_b64 exec, -1
    s_cmp_lg_u32 s3, 5
    s_cbranch_scc1 L_f_nosc
    v_lshlrev_b32 v84, 16, v84
    v_mul_f32 v85, 0xbfb8aa3b, v84
    v_exp_f32 v85, v85
    s_nop 0
    v_add_f32 v85, 1.0, v85
    v_rcp_f32 v85, v85
    s_nop 0
    v_mul_f32 v84, v84, v85
    v_cvt_pk_bf16_f32 v84, v84, v84
    v_add_u32 v85, 152576, v9
    ds_write_b16 v85, v84
L_f_nosc:
    ds_read_b64_tr_b16 v[144:145], v16 offset:0
    ds_read_b64_tr_b16 v[146:147], v16 offset:256
    ds_read_b64_tr_b16 v[148:149], v16 offset:1024
    ds_read_b64_tr_b16 v[150:151], v16 offset:1280
    ds_read_b64_tr_b16 v[152:153], v16 offset:2048
    ds_read_b64_tr_b16 v[154:155], v16 offset:2304
    ds_read_b64_tr_b16 v[156:157], v16 offset:3072
    ds_read_b64_tr_b16 v[158:159], v16 offset:3328
    s_add_u32 m0, s34, 6144
    s_add_u32 s37, s35, 6
    s_and_b32 s37, s37, 15
    s_lshl_b32 s37, s37, 14
    s_add_u32 s37, s37, s33
    buffer_load_dwordx4 v3, s[8:11], s37 offen lds
    s_add_u32 s37, s37, 15360
    buffer_load_dwordx4 v3, s[8:11], s37 offen offset:1024 lds
    s_add_u32 m0, s34, 8192
    s_add_u32 s37, s35, 8
    s_and_b32 s37, s37, 15
    s_lshl_b32 s37, s37, 14
    s_add_u32 s37, s37, s33
    buffer_load_dwordx4 v3, s[8:11], s37 offen lds
    s_add_u32 s37, s37, 15360
    buffer_load_dwordx4 v3, s[8:11], s37 offen offset:1024 lds
    s_mov_b32 s38, 0
L_f_pollA:
    v_xor_b32 v209, s92, v209
    v_xor_b32 v211, s92, v211
    v_xor_b32 v213, s92, v213
    v_xor_b32 v215, s92, v215
    v_xor_b32 v217, s92, v217
    v_xor_b32 v219, s92, v219
    v_xor_b32 v221, s92, v221
    v_xor_b32 v223, s92, v223
    v_or3_b32 v209, v209, v211, v213
    v_or3_b32 v215, v215, v217, v219
    v_or3_b32 v209, v209, v221, v223
    v_or_b32 v209, v209, v215
    v_cmp_ne_u32 vcc, 0, v209
    s_add_u32 s38, s38, 1
    s_cmp_eq_u64 vcc, 0
    s_cbranch_scc1 L_f_pollA_out
    s_cmp_gt_u32 s38, 1048576
    s_cbranch_scc1 L_f_pollA_out
    s_sleep 4
    s_add_u32 s53, s54, 0
    buffer_load_dwordx4 v[208:211], v2, s[12:15], s53 offen sc1
    s_add_u32 s53, s54, 8192
    buffer_load_dwordx4 v[212:215], v2, s[12:15], s53 offen sc1
    s_add_u32 s53, s54, 16384
    buffer_load_dwordx4 v[216:219], v2, s[12:15], s53 offen sc1
    s_add_u32 s53, s54, 24576
    buffer_load_dwordx4 v[220:223], v2, s[12:15], s53 offen sc1
    s_waitcnt vmcnt(0)
    s_branch L_f_pollA
L_f_pollA_out:
    s_cmp_ge_u32 s3, 4
    s_cselect_b32 s53, 1.0, 0
    v_add_f32 v208, v208, v212
    v_add_f32 v210, v210, v214
    v_add_f32 v216, v216, v220
    v_add_f32 v218, v218, v222
    v_add_f32 v208, v208, v216
    v_add_f32 v210, v210, v218
    v_cvt_pk_bf16_f32 v208, v208, v210
    v_and_b32 v209, 0xffff0000, v208
    v_lshlrev_b32 v208, 16, v208
    v_add_f32 v209, s53, v209
    v_add_f32 v208, s53, v208
    v_cvt_pk_bf16_f32 v208, v208, v209
    v_and_b32 v209, 0xffff0000, v208
    v_lshlrev_b32 v208, 16, v208
    ds_write_b64 v28, v[208:209]
    s_waitcnt lgkmcnt(0)
    s_barrier
    ds_read_b128 v[112:115], v29
    ds_read_b128 v[120:123], v29 offset:2048
    ds_read_b128 v[116:119], v29 offset:1024
    ds_read_b128 v[124:127], v29 offset:3072
    s_waitcnt lgkmcnt(0)
    v_pk_fma_f32 v[48:49], v[48:49], v[120:121], v[112:113]
    v_pk_fma_f32 v[50:51], v[50:51], v[122:123], v[114:115]
    v_pk_fma_f32 v[52:53], v[52:53], v[124:125], v[116:117]
    v_pk_fma_f32 v[54:55], v[54:55], v[126:127], v[118:119]
    v_cvt_pk_bf16_f32 v32, v48, v49
    v_cvt_pk_bf16_f32 v33, v50, v51
    v_cvt_pk_bf16_f32 v34, v52, v53
    v_cvt_pk_bf16_f32 v35, v54, v55
    ds_write_b128 v132, v[32:35]
    v_pk_fma_f32 v[56:57], v[56:57], v[120:121], v[112:113]
    v_pk_fma_f32 v[58:59], v[58:59], v[122:123], v[114:115]
    v_pk_fma_f32 v[60:61], v[60:61], v[124:125], v[116:117]
    v_pk_fma_f32 v[62:63], v[62:63], v[126:127], v[118:119]
    v_cvt_pk_bf16_f32 v36, v56, v57
    v_cvt_pk_bf16_f32 v37, v58, v59
    v_cvt_pk_bf16_f32 v38, v60, v61
    v_cvt_pk_bf16_f32 v39, v62, v63
    ds_write_b128 v133, v[36:39]
    v_pk_fma_f32 v[64:65], v[64:65], v[120:121], v[112:113]
    v_pk_fma_f32 v[66:67], v[66:67], v[122:123], v[114:115]
    v_pk_fma_f32 v[68:69], v[68:69], v[124:125], v[116:117]
    v_pk_fma_f32 v[70:71], v[70:71], v[126:127], v[118:119]
    v_cvt_pk_bf16_f32 v40, v64, v65
    v_cvt_pk_bf16_f32 v41, v66, v67
    v_cvt_pk_bf16_f32 v42, v68, v69
    v_cvt_pk_bf16_f32 v43, v70, v71
    ds_write_b128 v134, v[40:43]
    v_pk_fma_f32 v[72:73], v[72:73], v[120:121], v[112:113]
    v_pk_fma_f32 v[74:75], v[74:75], v[122:123], v[114:115]
    v_pk_fma_f32 v[76:77], v[76:77], v[124:125], v[116:117]
    v_pk_fma_f32 v[78:79], v[78:79], v[126:127], v[118:119]
    v_cvt_pk_bf16_f32 v44, v72, v73
    v_cvt_pk_bf16_f32 v45, v74, v75
    v_cvt_pk_bf16_f32 v46, v76, v77
    v_cvt_pk_bf16_f32 v47, v78, v79
    ds_write_b128 v135, v[44:47]
    s_waitcnt lgkmcnt(0)
    s_barrier
    s_cmp_lg_u32 s3, 3
    s_cbranch_scc1 L_f_mm
    s_setprio 3
    ds_read_b128 v[48:51], v20 offset:0
    ds_read_b128 v[52:55], v21 offset:2048
    ds_read_b128 v[56:59], v20 offset:4096
    ds_read_b128 v[60:63], v21 offset:6144
    ds_read_b128 v[64:67], v20 offset:8192
    ds_read_b128 v[68:71], v21 offset:10240
    ds_read_b128 v[72:75], v20 offset:12288
    ds_read_b128 v[76:79], v21 offset:14336
    s_cmp_ge_u32 s91, 2
    s_cbranch_scc1 L_f_vjob
    s_waitcnt lgkmcnt(7)
    v_mfma_f32_16x16x32_bf16 v[224:227], v[80:83], v[48:51], 0
    s_waitcnt lgkmcnt(6)
    v_mfma_f32_16x16x32_bf16 v[224:227], v[84:87], v[52:55], v[224:227]
    ds_read_b128 v[48:51], v20 offset:16384
    s_waitcnt lgkmcnt(6)
    v_mfma_f32_16x16x32_bf16 v[224:227], v[88:91], v[56:59], v[224:227]
    ds_read_b128 v[52:55], v21 offset:18432
    s_waitcnt lgkmcnt(6)
    v_mfma_f32_16x16x32_bf16 v[224:227], v[92:95], v[60:63], v[224:227]
    ds_read_b128 v[56:59], v20 offset:20480
    s_waitcnt lgkmcnt(6)
    v_mfma_f32_16x16x32_bf16 v[224:227], v[96:99], v[64:67], v[224:227]
    ds_read_b128 v[60:63], v21 offset:22528
    s_waitcnt lgkmcnt(6)
    v_mfma_f32_16x16x32_bf16 v[224:227], v[100:103], v[68:71], v[224:227]
    ds_read_b128 v[64:67], v20 offset:24576
    s_waitcnt lgkmcnt(6)
    v_mfma_f32_16x16x32_bf16 v[224:227], v[104:107], v[72:75], v[224:227]
    ds_read_b128 v[68:71], v21 offset:26624
    s_waitcnt lgkmcnt(6)
    v_mfma_f32_16x16x32_bf16 v[224:227], v[108:111], v[76:79], v[224:227]
    ds_read_b128 v[72:75], v20 offset:28672
    s_waitcnt lgkmcnt(6)
    v_mfma_f32_16x16x32_bf16 v[224:227], v[228:231], v[48:51], v[224:227]
    ds_read_b128 v[76:79], v21 offset:30720
    s_waitcnt lgkmcnt(6)
    v_mfma_f32_16x16x32_bf16 v[224:227], v[232:235], v[52:55], v[224:227]
    s_waitcnt lgkmcnt(5)
    v_mfma_f32_16x16x32_bf16 v[224:227], v[236:239], v[56:59], v[224:227]
    s_waitcnt lgkmcnt(4)
    v_mfma_f32_16x16x32_bf16 v[224:227], v[240:243], v[60:63], v[224:227]
    s_waitcnt lgkmcnt(3)
    v_mfma_f32_16x16x32_bf16 v[224:227], v[244:247], v[64:67], v[224:227]
    s_waitcnt lgkmcnt(2)
    v_mfma_f32_16x16x32_bf16 v[224:227], v[248:251], v[68:71], v[224:227]
    s_waitcnt lgkmcnt(1)
    v_mfma_f32_16x16x32_bf16 v[224:227], v[140:143], v[72:75], v[224:227]
    s_waitcnt lgkmcnt(0)
    v_mfma_f32_16x16x32_bf16 v[224:227], v[128:131], v[76:79], v[224:227]
    v_lshlrev_b32 v22, 9, v13
    v_lshl_add_u32 v22, v19, 4, v22
    v_lshl_add_u32 v22, v31, 3, v22
    s_lshl_b32 s43, s90, 10
    s_add_u32 s43, s43, 196608
    s_branch L_f_kvdone
L_f_vjob:
    s_waitcnt lgkmcnt(7)
    v_mfma_f32_16x16x32_bf16 v[224:227], v[48:51], v[80:83], 0
    s_waitcnt lgkmcnt(6)
    v_mfma_f32_16x16x32_bf16 v[224:227], v[52:55], v[84:87], v[224:227]
    ds_read_b128 v[48:51], v20 offset:16384
    s_waitcnt lgkmcnt(6)
    v_mfma_f32_16x16x32_bf16 v[224:227], v[56:59], v[88:91], v[224:227]
    ds_read_b128 v[52:55], v21 offset:18432
    s_waitcnt lgkmcnt(6)
    v_mfma_f32_16x16x32_bf16 v[224:227], v[60:63], v[92:95], v[224:227]
    ds_read_b128 v[56:59], v20 offset:20480
    s_waitcnt lgkmcnt(6)
    v_mfma_f32_16x16x32_bf16 v[224:227], v[64:67], v[96:99], v[224:227]
    ds_read_b128 v[60:63], v21 offset:22528
    s_waitcnt lgkmcnt(6)
    v_mfma_f32_16x16x32_bf16 v[224:227], v[68:71], v[100:103], v[224:227]
    ds_read_b128 v[64:67], v20 offset:24576
    s_waitcnt lgkmcnt(6)
    v_mfma_f32_16x16x32_bf16 v[224:227], v[72:75], v[104:107], v[224:227]
    ds_read_b128 v[68:71], v21 offset:26624
    s_waitcnt lgkmcnt(6)
    v_mfma_f32_16x16x32_bf16 v[224:227], v[76:79], v[108:111], v[224:227]
    ds_read_b128 v[72:75], v20 offset:28672
    s_waitcnt lgkmcnt(6)
    v_mfma_f32_16x16x32_bf16 v[224:227], v[48:51], v[228:231], v[224:227]
    ds_read_b128 v[76:79], v21 offset:30720
    s_waitcnt lgkmcnt(6)
    v_mfma_f32_16x16x32_bf16 v[224:227], v[52:55], v[232:235], v[224:227]
    s_waitcnt lgkmcnt(5)
    v_mfma_f32_16x16x32_bf16 v[224:227], v[56:59], v[236:239], v[224:227]
    s_waitcnt lgkmcnt(4)
    v_mfma_f32_16x16x32_bf16 v[224:227], v[60:63], v[240:243], v[224:227]
    s_waitcnt lgkmcnt(3)
    v_mfma_f32_16x16x32_bf16 v[224:227], v[64:67], v[244:247], v[224:227]
    s_waitcnt lgkmcnt(2)
    v_mfma_f32_16x16x32_bf16 v[224:227], v[68:71], v[248:251], v[224:227]
    s_waitcnt lgkmcnt(1)
    v_mfma_f32_16x16x32_bf16 v[224:227], v[72:75], v[140:143], v[224:227]
    s_waitcnt lgkmcnt(0)
    v_mfma_f32_16x16x32_bf16 v[224:227], v[76:79], v[128:131], v[224:227]
    v_lshlrev_b32 v22, 9, v31
    v_lshl_add_u32 v22, v19, 4, v22
    v_lshl_add_u32 v22, v13, 3, v22
    s_lshl_b32 s43, s90, 10
    s_add_u32 s43, s43, 262144
    s_nop 0
L_f_kvdone:
    s_nop 2
    v_cvt_pk_bf16_f32 v224, v224, v225
    v_cvt_pk_bf16_f32 v225, v226, v227
    buffer_store_dwordx2 v[224:225], v22, s[12:15], s43 offen sc1
    s_add_u32 m0, s34, 10240
    s_add_u32 s37, s35, 10
    s_and_b32 s37, s37, 15
    s_lshl_b32 s37, s37, 14
    s_add_u32 s37, s37, s33
    buffer_load_dwordx4 v3, s[8:11], s37 offen lds
    s_add_u32 s37, s37, 15360
    buffer_load_dwordx4 v3, s[8:11], s37 offen offset:1024 lds
    s_add_u32 m0, s34, 0
    s_add_u32 s37, s35, 12
    s_and_b32 s37, s37, 15
    s_lshl_b32 s37, s37, 14
    s_add_u32 s37, s37, s33
    buffer_load_dwordx4 v3, s[8:11], s37 offen lds
    s_add_u32 s37, s37, 15360
    buffer_load_dwordx4 v3, s[8:11], s37 offen offset:1024 lds
    s_add_u32 m0, s34, 2048
    s_add_u32 s37, s35, 14
    s_and_b32 s37, s37, 15
    s_lshl_b32 s37, s37, 14
    s_add_u32 s37, s37, s33
    buffer_load_dwordx4 v3, s[8:11], s37 offen lds
    s_add_u32 s37, s37, 15360
    buffer_load_dwordx4 v3, s[8:11], s37 offen offset:1024 lds
    v_dot2_f32_bf16 v100, v224, v224, 0
    v_dot2_f32_bf16 v100, v225, v225, v100
    v_mov_b32 v101, s92
    v_mov_b32 v102, s4
    v_mov_b32 v103, s92
    v_mov_b32 v99, v100
    s_nop 1
    v_permlane16_swap_b32 v100, v99
    v_add_f32 v100, v100, v99
    v_mov_b32 v99, v100
    s_nop 1
    v_permlane32_swap_b32 v100, v99
    v_add_f32 v100, v100, v99
    s_nop 1
    v_max_f32_dpp v100, v100, v100 row_ror:1 row_mask:0xf bank_mask:0xf
    s_nop 1
    v_max_f32_dpp v100, v100, v100 row_ror:2 row_mask:0xf bank_mask:0xf
    s_nop 1
    v_max_f32_dpp v100, v100, v100 row_ror:4 row_mask:0xf bank_mask:0xf
    s_nop 1
    v_max_f32_dpp v100, v100, v100 row_ror:8 row_mask:0xf bank_mask:0xf
    s_waitcnt vmcnt(6)
    s_mov_b64 exec, 1
    buffer_store_dwordx4 v[100:103], v10, s[12:15], s42 offen sc1
    s_mov_b64 exec, -1
    s_branch L_f_mm2
L_f_mm:
    s_add_u32 m0, s34, 10240
    s_add_u32 s37, s35, 10
    s_and_b32 s37, s37, 15
    s_lshl_b32 s37, s37, 14
    s_add_u32 s37, s37, s33
    buffer_load_dwordx4 v3, s[8:11], s37 offen lds
    s_add_u32 s37, s37, 15360
    buffer_load_dwordx4 v3, s[8:11], s37 offen offset:1024 lds
    s_add_u32 m0, s34, 0
    s_add_u32 s37, s35, 12
    s_and_b32 s37, s37, 15
    s_lshl_b32 s37, s37, 14
    s_add_u32 s37, s37, s33
    buffer_load_dwordx4 v3, s[8:11], s37 offen lds
    s_add_u32 s37, s37, 15360
    buffer_load_dwordx4 v3, s[8:11], s37 offen offset:1024 lds
    s_add_u32 m0, s34, 2048
    s_add_u32 s37, s35, 14
    s_and_b32 s37, s37, 15
    s_lshl_b32 s37, s37, 14
    s_add_u32 s37, s37, s33
    buffer_load_dwordx4 v3, s[8:11], s37 offen lds
    s_add_u32 s37, s37, 15360
    buffer_load_dwordx4 v3, s[8:11], s37 offen offset:1024 lds
    s_mov_b32 s53, 0x40000000
    s_mov_b64 exec, 1
    buffer_store_dword v10, v10, s[12:15], s53 offen
    s_mov_b64 exec, -1
L_f_mm2:
    s_lshl_b32 s47, s3, 10
    s_add_u32 s47, s47, 327680
    s_add_u32 s50, s47, 8192
    v_lshlrev_b32 v12, 5, v30
    ds_read_b128 v[228:231], v24 offset:0
    ds_read_b128 v[232:235], v25 offset:1024
    ds_read_b128 v[236:239], v26 offset:2048
    ds_read_b128 v[240:243], v27 offset:3072
    s_mov_b32 exec_hi, 0
    buffer_load_dword v124, v12, s[12:15], s50 offen sc1
    s_mov_b64 exec, -1
    ds_read_b64_tr_b16 v[160:161], v16 offset:4096
    ds_read_b64_tr_b16 v[162:163], v16 offset:4352
    ds_read_b128 v[244:247], v24 offset:4096
    s_waitcnt lgkmcnt(6)
    v_mfma_f32_32x32x16_bf16 v[128:143], v[144:147], v[228:231], 0
    ds_read_b64_tr_b16 v[164:165], v16 offset:5120
    ds_read_b64_tr_b16 v[166:167], v16 offset:5376
    ds_read_b128 v[248:251], v25 offset:5120
    s_waitcnt lgkmcnt(8)
    v_mfma_f32_32x32x16_bf16 v[128:143], v[148:151], v[232:235], v[128:143]
    s_waitcnt vmcnt(11)
    ds_read_b64_tr_b16 v[168:169], v16 offset:6144
    ds_read_b64_tr_b16 v[170:171], v16 offset:6400
    ds_read_b128 v[228:231], v26 offset:6144
    s_waitcnt lgkmcnt(10)
    v_mfma_f32_32x32x16_bf16 v[128:143], v[152:155], v[236:239], v[128:143]
    s_waitcnt vmcnt(10)
    ds_read_b64_tr_b16 v[172:173], v16 offset:7168
    ds_read_b64_tr_b16 v[174:175], v16 offset:7424
    ds_read_b128 v[232:235], v27 offset:7168
    s_waitcnt lgkmcnt(12)
    v_mfma_f32_32x32x16_bf16 v[128:143], v[156:159], v[240:243], v[128:143]
    s_waitcnt vmcnt(9)
    ds_read_b64_tr_b16 v[176:177], v16 offset:8192
    ds_read_b64_tr_b16 v[178:179], v16 offset:8448
    ds_read_b128 v[236:239], v24 offset:8192
    s_waitcnt lgkmcnt(12)
    v_mfma_f32_32x32x16_bf16 v[128:143], v[160:163], v[244:247], v[128:143]
    s_waitcnt vmcnt(8)
    ds_read_b64_tr_b16 v[180:181], v16 offset:9216
    ds_read_b64_tr_b16 v[182:183], v16 offset:9472
    ds_read_b128 v[240:243], v25 offset:9216
    s_waitcnt lgkmcnt(12)
    v_mfma_f32_32x32x16_bf16 v[128:143], v[164:167], v[248:251], v[128:143]
    s_waitcnt vmcnt(7)
    ds_read_b64_tr_b16 v[184:185], v16 offset:10240
    ds_read_b64_tr_b16 v[186:187], v16 offset:10496
    ds_read_b128 v[244:247], v26 offset:10240
    s_waitcnt lgkmcnt(12)
    v_mfma_f32_32x32x16_bf16 v[128:143], v[168:171], v[228:231], v[128:143]
    s_waitcnt vmcnt(6)
    ds_read_b64_tr_b16 v[188:189], v16 offset:11264
    ds_read_b64_tr_b16 v[190:191], v16 offset:11520
    ds_read_b128 v[248:251], v27 offset:11264
    s_waitcnt lgkmcnt(12)
    v_mfma_f32_32x32x16_bf16 v[128:143], v[172:175], v[232:235], v[128:143]
    s_waitcnt vmcnt(5)
    ds_read_b64_tr_b16 v[192:193], v16 offset:0
    ds_read_b64_tr_b16 v[194:195], v16 offset:256
    ds_read_b128 v[228:231], v24 offset:12288
    s_waitcnt lgkmcnt(12)
    v_mfma_f32_32x32x16_bf16 v[128:143], v[176:179], v[236:239], v[128:143]
    s_waitcnt vmcnt(4)
    ds_read_b64_tr_b16 v[196:197], v16 offset:1024
    ds_read_b64_tr_b16 v[198:199], v16 offset:1280
    ds_read_b128 v[232:235], v25 offset:13312
    s_waitcnt lgkmcnt(12)
    v_mfma_f32_32x32x16_bf16 v[128:143], v[180:183], v[240:243], v[128:143]
    s_waitcnt vmcnt(3)
    ds_read_b64_tr_b16 v[200:201], v16 offset:2048
    ds_read_b64_tr_b16 v[202:203], v16 offset:2304
    ds_read_b128 v[236:239], v26 offset:14336
    s_waitcnt lgkmcnt(12)
    v_mfma_f32_32x32x16_bf16 v[128:143], v[184:187], v[244:247], v[128:143]
    s_waitcnt vmcnt(2)
    ds_read_b64_tr_b16 v[204:205], v16 offset:3072
    ds_read_b64_tr_b16 v[206:207], v16 offset:3328
    ds_read_b128 v[240:243], v27 offset:15360
    s_waitcnt lgkmcnt(12)
    v_mfma_f32_32x32x16_bf16 v[128:143], v[188:191], v[248:251], v[128:143]
    s_waitcnt lgkmcnt(9)
    v_mfma_f32_32x32x16_bf16 v[128:143], v[192:195], v[228:231], v[128:143]
    s_waitcnt lgkmcnt(6)
    v_mfma_f32_32x32x16_bf16 v[128:143], v[196:199], v[232:235], v[128:143]
    s_waitcnt lgkmcnt(3)
    v_mfma_f32_32x32x16_bf16 v[128:143], v[200:203], v[236:239], v[128:143]
    s_waitcnt lgkmcnt(0)
    v_mfma_f32_32x32x16_bf16 v[128:143], v[204:207], v[240:243], v[128:143]
    s_nop 2
    s_cmp_lt_u32 s3, 4
    s_cbranch_scc1 L_f_qfin
    v_add_u32 v20, s34, v2
    s_nop 5
    ds_write_b128 v20, v[128:131] offset:4096
    ds_write_b128 v20, v[132:135] offset:5120
    ds_write_b128 v20, v[136:139] offset:6144
    ds_write_b128 v20, v[140:143] offset:7168
    s_waitcnt lgkmcnt(0)
    s_barrier
    s_mov_b32 s25, 0x40000000
    v_mov_b32 v173, 0
    s_waitcnt vmcnt(0)
    s_mov_b32 s38, 0
L_f_woa:
    v_cmp_eq_u32 vcc, s92, v124
    s_add_u32 s38, s38, 1
    s_cmp_eq_u32 vcc_lo, -1
    s_cbranch_scc1 L_f_woa_ok
    s_cmp_gt_u32 s38, 1048576
    s_cbranch_scc1 L_f_woa_ok
    s_sleep 4
    buffer_load_dword v124, v12, s[12:15], s50 offen sc1
    s_waitcnt vmcnt(0)
    s_branch L_f_woa
L_f_woa_ok:
    s_lshl_b32 s27, s3, 13
    s_add_u32 s27, s27, 524288
    s_lshl_b32 s37, s91, 17
    s_add_u32 s37, s37, s27
    buffer_load_dwordx4 v[184:187], v2, s[12:15], s37 offen offset:0 sc1
    buffer_load_dwordx4 v[188:191], v2, s[12:15], s37 offen offset:1024 sc1
    buffer_load_dwordx4 v[192:195], v2, s[12:15], s37 offen offset:2048 sc1
    buffer_load_dwordx4 v[196:199], v2, s[12:15], s37 offen offset:3072 sc1
    s_add_u32 s37, s37, 4096
    buffer_load_dwordx4 v[200:203], v2, s[12:15], s37 offen offset:0 sc1
    buffer_load_dwordx4 v[204:207], v2, s[12:15], s37 offen offset:1024 sc1
    buffer_load_dwordx4 v[208:211], v2, s[12:15], s37 offen offset:2048 sc1
    buffer_load_dwordx4 v[212:215], v2, s[12:15], s37 offen offset:3072 sc1
    s_branch L_f_join
L_f_qfin:
    s_waitcnt vmcnt(0)
    s_mov_b32 s38, 0
L_f_wob:
    v_cmp_eq_u32 vcc, s92, v124
    s_add_u32 s38, s38, 1
    s_cmp_eq_u32 vcc_lo, -1
    s_cbranch_scc1 L_f_wob_ok
    s_cmp_gt_u32 s38, 1048576
    s_cbranch_scc1 L_f_wob_ok
    s_sleep 4
    buffer_load_dword v124, v12, s[12:15], s50 offen sc1
    s_waitcnt vmcnt(0)
    s_branch L_f_wob
L_f_wob_ok:
    s_lshl_b32 s27, s3, 13
    s_add_u32 s27, s27, 524288
    s_lshl_b32 s37, s91, 17
    s_add_u32 s37, s37, s27
    buffer_load_dwordx4 v[184:187], v2, s[12:15], s37 offen offset:0 sc1
    buffer_load_dwordx4 v[188:191], v2, s[12:15], s37 offen offset:1024 sc1
    buffer_load_dwordx4 v[192:195], v2, s[12:15], s37 offen offset:2048 sc1
    buffer_load_dwordx4 v[196:199], v2, s[12:15], s37 offen offset:3072 sc1
    s_add_u32 s37, s37, 4096
    buffer_load_dwordx4 v[200:203], v2, s[12:15], s37 offen offset:0 sc1
    buffer_load_dwordx4 v[204:207], v2, s[12:15], s37 offen offset:1024 sc1
    buffer_load_dwordx4 v[208:211], v2, s[12:15], s37 offen offset:2048 sc1
    buffer_load_dwordx4 v[212:215], v2, s[12:15], s37 offen offset:3072 sc1
    s_add_u32 s39, s34, 49152
    v_add_u32 v20, s39, v2
    v_lshrrev_b32 v22, 3, v30
    v_lshlrev_b32 v22, 13, v22
    v_lshl_add_u32 v22, v31, 9, v22
    v_and_b32 v21, 7, v30
    v_lshl_add_u32 v22, v21, 4, v22
    s_lshl_b32 s39, s90, 15
    s_lshl_b32 s40, s91, 11
    s_add_u32 s39, s39, s40
    s_lshr_b32 s40, s3, 1
    s_lshl_b32 s40, s40, 10
    s_add_u32 s39, s39, s40
    s_and_b32 s40, s3, 1
    s_lshl_b32 s40, s40, 8
    s_add_u32 s39, s39, s40
    s_add_u32 s39, s39, 4194304
    s_mov_b32 s44, 0x3eb8aa3b
    s_mov_b32 s45, s44
    s_and_b32 s40, s39, 0x7ff
    s_add_u32 s40, s40, 131072
    v_and_b32 v21, 0x1fff, v22
    v_add_u32 v21, s40, v21
    s_lshl_b32 s40, s91, 3
    s_lshl_b32 s46, 0xff, s40
    s_barrier
    ds_read_b128 v[160:163], v20 offset:4096
    ds_read_b128 v[164:167], v20 offset:5120
    ds_read_b128 v[168:171], v20 offset:6144
    ds_read_b128 v[172:175], v20 offset:7168
    s_waitcnt lgkmcnt(3)
    v_pk_add_f32 v[128:129], v[128:129], v[160:161]
    v_pk_add_f32 v[130:131], v[130:131], v[162:163]
    v_pk_mul_f32 v[128:129], v[128:129], s[44:45]
    v_pk_mul_f32 v[130:131], v[130:131], s[44:45]
    v_cvt_pk_bf16_f32 v176, v128, v129
    v_cvt_pk_bf16_f32 v177, v130, v131
    s_waitcnt lgkmcnt(2)
    v_pk_add_f32 v[132:133], v[132:133], v[164:165]
    v_pk_add_f32 v[134:135], v[134:135], v[166:167]
    v_pk_mul_f32 v[132:133], v[132:133], s[44:45]
    v_pk_mul_f32 v[134:135], v[134:135], s[44:45]
    v_cvt_pk_bf16_f32 v178, v132, v133
    v_cvt_pk_bf16_f32 v179, v134, v135
    s_waitcnt lgkmcnt(1)
    v_pk_add_f32 v[136:137], v[136:137], v[168:169]
    v_pk_add_f32 v[138:139], v[138:139], v[170:171]
    v_pk_mul_f32 v[136:137], v[136:137], s[44:45]
    v_pk_mul_f32 v[138:139], v[138:139], s[44:45]
    v_cvt_pk_bf16_f32 v180, v136, v137
    v_cvt_pk_bf16_f32 v181, v138, v139
    s_waitcnt lgkmcnt(0)
    v_pk_add_f32 v[140:141], v[140:141], v[172:173]
    v_pk_add_f32 v[142:143], v[142:143], v[174:175]
    v_pk_mul_f32 v[140:141], v[140:141], s[44:45]
    v_pk_mul_f32 v[142:143], v[142:143], s[44:45]
    v_cvt_pk_bf16_f32 v182, v140, v141
    v_cvt_pk_bf16_f32 v183, v142, v143
    s_mov_b32 exec_lo, s46
    s_mov_b32 exec_hi, s46
    ds_write_b128 v21, v[176:179]
    ds_write_b128 v21, v[180:183] offset:128
    s_mov_b64 exec, -1
    s_mov_b32 s25, s39
    v_mov_b32 v173, v22
    v_dot2_f32_bf16 v174, v176, v176, 0
    v_dot2_f32_bf16 v175, v180, v180, 0
    v_dot2_f32_bf16 v174, v177, v177, v174
    v_dot2_f32_bf16 v175, v181, v181, v175
    v_dot2_f32_bf16 v174, v178, v178, v174
    v_dot2_f32_bf16 v175, v182, v182, v175
    v_dot2_f32_bf16 v174, v179, v179, v174
    v_dot2_f32_bf16 v175, v183, v183, v175
    s_nop 2
    v_permlane32_swap_b32 v174, v175
    v_add_f32 v174, v174, v175
    s_nop 1
    v_max_f32_dpp v174, v174, v174 row_shr:1 row_mask:0xf bank_mask:0xf bound_ctrl:0
    s_nop 1
    v_max_f32_dpp v174, v174, v174 row_shr:2 row_mask:0xf bank_mask:0xf bound_ctrl:0
    s_nop 1
    v_max_f32_dpp v174, v174, v174 row_shr:4 row_mask:0xf bank_mask:0xf bound_ctrl:0
    s_nop 1
    v_max_f32_dpp v174, v174, v174 row_shr:8 row_mask:0xf bank_mask:0xf bound_ctrl:0
    s_nop 1
    v_max_f32_dpp v174, v174, v174 row_bcast:15 row_mask:0xa bank_mask:0xf
    s_nop 1
    v_max_f32_dpp v174, v174, v174 row_bcast:31 row_mask:0xc bank_mask:0xf
    v_mov_b32 v175, s92
L_f_join:
    s_setprio 3
    v_mov_b32 v6, 0
    s_mov_b32 exec_lo, 0x110011
    s_mov_b32 exec_hi, 0x110011
    v_mov_b32 v6, 0x3f803f80
    s_mov_b64 exec, -1
    s_lshl_b32 s23, s3, 13
    s_add_u32 s23, s23, 196608
    s_lshl_b32 s34, s20, 7
    s_lshl3_add_u32 s34, s3, s34
    s_add_u32 s34, s34, 360448
    s_lshl_b32 s33, s91, 1
    s_lshl_b32 s21, s20, 13
    s_add_u32 s21, s21, 4194304
    v_add_u32 v3, 131072, v2
    v_mov_b32 v236, 0
    v_mov_b32 v237, 0
    v_mov_b32 v238, 0
    v_mov_b32 v239, 0
    v_mov_b32 v14, 0xdddd
    s_waitcnt lgkmcnt(0)
    s_barrier
    s_mov_b32 exec_hi, 0
    buffer_load_dwordx4 v[120:123], v12, s[12:15], s47 offen sc1
    s_mov_b64 exec, -1
    ds_read_b128 v[112:115], v3
    ds_read_b128 v[116:119], v3 offset:1024
    v_mfma_f32_32x32x16_bf16 v[216:231], v[236:239], v[236:239], 0
    v_mov_b32 v52, v6
    v_mov_b32 v53, v6
    v_mov_b32 v54, v6
    v_mov_b32 v55, v6
    v_mov_b32 v60, v6
    v_mov_b32 v61, v6
    v_mov_b32 v62, v6
    v_mov_b32 v63, v6
    v_mov_b32 v68, v6
    v_mov_b32 v69, v6
    v_mov_b32 v70, v6
    v_mov_b32 v71, v6
    v_mov_b32 v76, v6
    v_mov_b32 v77, v6
    v_mov_b32 v78, v6
    v_mov_b32 v79, v6
    v_mov_b32 v84, v6
    v_mov_b32 v85, v6
    v_mov_b32 v86, v6
    v_mov_b32 v87, v6
    v_mov_b32 v92, v6
    v_mov_b32 v93, v6
    v_mov_b32 v94, v6
    v_mov_b32 v95, v6
    v_mov_b32 v100, v6
    v_mov_b32 v101, v6
    v_mov_b32 v102, v6
    v_mov_b32 v103, v6
    v_mov_b32 v108, v6
    v_mov_b32 v109, v6
    v_mov_b32 v110, v6
    v_mov_b32 v111, v6
    v_and_b32 v8, 1, v0
    v_mul_u32_u24 v8, 0xaaaa, v8
    v_add_u32 v15, 0x4444, v8
    v_lshlrev_b32 v8, 5, v30
    v_lshl_add_u32 v8, v31, 3, v8
    s_lshr_b32 s53, s3, 2
    s_lshl_b32 s53, s53, 4
    s_and_b32 s54, s3, 3
    s_lshl_b32 s54, s54, 1
    s_add_u32 s53, s53, s54
    v_add_u32 v5, s53, v8
    s_lshl_b32 s50, s3, 8
    v_add_u32 v13, s50, v4
    s_mul_i32 s51, s3, 2304
    v_add_u32 v7, s51, v4
    v_and_b32 v6, 3, v1
    v_lshlrev_b32 v11, 5, v1
    v_and_b32 v11, 0x180, v11
    v_lshl_add_u32 v11, v6, 3, v11
    s_add_u32 s45, s47, 16384
    s_mov_b32 s93, 0x40000000
    s_mov_b32 s94, s93
    s_mov_b32 s60, s93
    s_mov_b32 s61, 0
    s_mov_b32 s95, 0
    s_mov_b32 s56, s76
    s_mov_b32 s57, s77
    s_mov_b32 s58, 1409024
    s_mov_b32 s59, 0x20000
    s_mov_b32 s31, 3
    s_lshl_b32 s39, s3, 8
    s_add_u32 s39, s39, s20
    s_cmp_ge_u32 s3, 4
    s_cbranch_scc1 L_f_prep_mr
    s_cmp_ge_u32 s39, 696
    s_cbranch_scc1 L_f_prep_done
    s_cmp_ge_u32 s39, 352
    s_cbranch_scc1 L_f_prep_w2
    s_mov_b32 s40, 2752
    s_and_b32 s41, s39, 15
    s_lshr_b32 s39, s39, 4
    s_lshl_b32 s93, s39, 16
    s_lshl_b32 s44, s41, 11
    s_add_u32 s93, s93, s44
    s_add_u32 s93, s93, 1048576
    s_cmp_eq_u32 s39, 21
    s_mov_b32 s94, 32768
    s_cselect_b32 s94, 0x40000000, s94
    s_mov_b32 s95, 512
    s_branch L_f_prep_go
L_f_prep_w2:
    s_mov_b32 s56, s78
    s_mov_b32 s57, s79
    s_mov_b32 s40, 1024
    s_sub_u32 s39, s39, 352
    s_lshr_b32 s41, s39, 3
    s_and_b32 s39, s39, 7
    s_mul_i32 s93, s39, 176128
    s_lshl_b32 s44, s41, 11
    s_add_u32 s93, s93, s44
    s_add_u32 s93, s93, 2490368
    s_mov_b32 s94, 88064
    s_mov_b32 s95, 1024
    s_mov_b32 s31, 2
L_f_prep_go:
    s_mul_i32 s60, s41, s40
    s_lshl_b32 s60, s60, 5
    s_lshl_b32 s39, s39, 7
    s_add_u32 s60, s60, s39
    s_mov_b32 s61, s40
    s_add_u32 s94, s94, s93
    s_branch L_f_prep_done
L_f_prep_mr:
    s_mov_b32 s56, s82
    s_mov_b32 s57, s83
    s_mov_b32 s58, 3145728
    s_lshl_b32 s60, s28, 2
    s_and_b32 s39, s3, 3
    s_add_u32 s60, s60, s39
    s_mul_i32 s60, s60, 98304
    s_lshl_b32 s93, s29, 7
    s_add_u32 s60, s60, s93
    s_add_u32 s60, s60, 2048
    s_lshl_b32 s93, s28, 13
    s_lshl_b32 s41, s29, 8
    s_add_u32 s93, s93, s41
    s_lshl_b32 s41, s39, 6
    s_add_u32 s93, s93, s41
    s_add_u32 s93, s93, 65536
L_f_prep_done:
    s_lshl_b32 s40, s3, 12
    s_add_u32 s40, s40, 22528
    s_lshl_b32 s32, s61, 3
    s_cmp_ge_u32 s3, 4
    s_cselect_b32 s61, 6144, s61
    s_cselect_b32 s32, 24576, s32
    s_cselect_b32 s41, 0, -1
    s_max_u32 s32, s32, 1024
    s_sub_u32 s32, s32, 1024
    s_mov_b32 s8, s64
    s_mov_b32 s9, s65
    s_mov_b32 s10, 0x200000
    s_mov_b32 s11, 0x20000
    s_add_u32 s96, s6, 0x100000
    s_addc_u32 s97, s7, 0
    s_mov_b32 s98, 0x158000
    s_mov_b32 s99, 0x20000
    s_lshl_b32 s36, s90, 9
    s_add_u32 s36, s36, 360448
    s_lshl_b32 s30, s20, 13
    s_lshl_b32 s53, s3, 7
    s_add_u32 s30, s30, s53
    s_cmp_ge_u32 s29, 15
    s_cselect_b32 s53, 15, 0
    s_sub_u32 s53, s29, s53
    s_mul_i32 s24, s53, 98304
    s_mul_i32 s26, s3, 12288
    s_add_u32 s24, s24, s26
    s_cmp_ge_u32 s29, 30
    s_cselect_b32 s24, 0x40000000, s24
    s_add_u32 s26, s26, 22528
    s_lshl_b32 s35, s3, 10
    s_add_u32 s35, s35, s21
    s_add_u32 s37, s42, 16384
    s_lshl_b32 s42, s20, 5
    s_add_u32 s42, s42, 65536
    s_lshl_b32 s43, s20, 6
    s_add_u32 s43, s43, 131072
    s_cmp_lg_u32 s3, 0
    s_cselect_b32 s37, 0x40000000, s37
    s_cselect_b32 s42, 0x40000000, s42
    s_add_u32 s38, s30, 6291456
    s_or_b32 s53, s2, s3
    s_mov_b32 s39, 61440
    s_cmp_lg_u32 s53, 0
    s_cselect_b32 s39, 0x40000000, s39
    s_lshl_b32 s44, s3, 11
    s_add_u32 s44, s44, 131072
    s_lshr_b32 s5, s29, 3
    s_lshl_b32 s5, s5, 1
    s_lshl_b32 s53, s28, 3
    s_add_u32 s5, s5, s53
    s_and_b32 s88, s29, 7
    s_lshl_b32 s88, s88, 1
    s_bfe_u32 s53, s3, 0x10001
    s_add_u32 s53, s53, s88
    s_mul_i32 s100, s53, 86
    s_lshr_b32 s53, s3, 2
    s_mul_i32 s53, s53, 43
    s_add_u32 s100, s100, s53
    s_and_b32 s53, s3, 1
    s_lshl_b32 s53, s53, 2
    s_add_u32 s100, s100, s53
    s_lshl_b32 s100, s100, 10
    s_add_u32 s100, s100, 2526208
    s_lshl_b32 s101, s3, 12
    s_add_u32 s101, s101, 120832
    s_and_b32 s53, s3, 1
    s_add_u32 s53, s53, s88
    s_mul_i32 s49, s53, 86
    s_bfe_u32 s53, s3, 0x10001
    s_mul_i32 s89, s53, 43
    s_add_u32 s49, s49, s89
    s_lshl_b32 s49, s49, 10
    s_add_u32 s49, s49, 2490368
    s_waitcnt vmcnt(0)
    s_mov_b32 exec_hi, 0
    s_mov_b32 s53, 0
    s_branch L_pollB_chk
L_pollB:
    buffer_load_dwordx4 v[120:123], v12, s[12:15], s47 offen sc1
    s_add_u32 s53, s53, 1
    s_waitcnt vmcnt(0)
L_pollB_chk:
    v_cmp_ne_u32 vcc, s92, v121
    s_cmp_eq_u64 vcc, 0
    s_cbranch_scc1 L_pollB_out
    s_cmp_gt_u32 s53, 1048576
    s_cbranch_scc1 L_pollB_out
    s_sleep 4
    s_branch L_pollB
L_pollB_out:
    s_mov_b64 exec, -1
    s_add_u32 s53, s29, 0
    s_and_b32 s53, s53, 7
    s_lshl_b32 s53, s53, 10
    s_add_u32 s53, s53, s23
    buffer_load_dwordx4 v[16:19], v2, s[12:15], s53 offen sc1
    s_add_u32 s53, s53, 65536
    buffer_load_dwordx4 v[48:51], v2, s[12:15], s53 offen sc1
    s_add_u32 s53, s29, 1
    s_and_b32 s53, s53, 7
    s_lshl_b32 s53, s53, 10
    s_add_u32 s53, s53, s23
    buffer_load_dwordx4 v[20:23], v2, s[12:15], s53 offen sc1
    s_add_u32 s53, s53, 65536
    buffer_load_dwordx4 v[56:59], v2, s[12:15], s53 offen sc1
    s_add_u32 s53, s29, 2
    s_and_b32 s53, s53, 7
    s_lshl_b32 s53, s53, 10
    s_add_u32 s53, s53, s23
    buffer_load_dwordx4 v[24:27], v2, s[12:15], s53 offen sc1
    s_add_u32 s53, s53, 65536
    buffer_load_dwordx4 v[64:67], v2, s[12:15], s53 offen sc1
    s_add_u32 s53, s29, 3
    s_and_b32 s53, s53, 7
    s_lshl_b32 s53, s53, 10
    s_add_u32 s53, s53, s23
    buffer_load_dwordx4 v[28:31], v2, s[12:15], s53 offen sc1
    s_add_u32 s53, s53, 65536
    buffer_load_dwordx4 v[72:75], v2, s[12:15], s53 offen sc1
    buffer_store_dwordx4 v[176:179], v173, s[12:15], s25 offen offset:0 sc1
    buffer_store_dwordx4 v[180:183], v173, s[12:15], s25 offen offset:128 sc1
    s_cmp_ge_u32 s3, 4
    s_cselect_b32 s34, 0x40000000, s34
    v_cmp_nge_f32 vcc, 0x67800000, v120
    s_and_b32 s46, vcc_lo, 0xcccccccc
    s_cselect_b32 s46, 1, 0
    v_cmp_le_f32 vcc, 0x17800000, v120
    s_and_b32 s47, vcc_lo, 0xcccccccc
    s_cselect_b32 s47, 2, 0
    s_or_b32 s46, s46, s47
    v_cmp_eq_u32 vcc, s4, v122
    s_cmp_eq_u32 vcc_lo, -1
    s_cselect_b32 s47, 4, 0
    s_cmp_eq_u32 s3, s28
    s_cselect_b32 s47, s47, 0
    s_or_b32 s46, s46, s47
    v_max_u32_dpp v120, v120, v120 quad_perm:[1,0,3,2] row_mask:0xf bank_mask:0xf
    s_lshl_b32 s52, s3, 3
    s_add_u32 s52, s52, 57344
    v_max_u32_dpp v120, v120, v120 row_ror:4 row_mask:0xf bank_mask:0xf
    v_mov_b32 v9, s46
    v_mov_b32 v10, s52
    v_max_u32_dpp v120, v120, v120 row_ror:8 row_mask:0xf bank_mask:0xf
    s_nop 0
    v_readlane_b32 s52, v120, 0
    v_readlane_b32 s47, v120, 16
    s_max_u32 s52, s52, s47
    v_mov_b32 v8, s52
    ds_write_b64 v10, v[8:9]
    s_waitcnt lgkmcnt(0)
    v_mfma_f32_32x32x16_bf16 v[152:167], v[236:239], v[236:239], 0
    s_waitcnt vmcnt(9)
    v_mfma_f32_32x32x16_bf16 v[120:135], v[16:19], v[112:115], 0
    s_nop 11
    v_exp_f32 v120, v120
    v_exp_f32 v121, v121
    v_exp_f32 v122, v122
    v_exp_f32 v123, v123
    v_exp_f32 v124, v124
    s_waitcnt vmcnt(7)
    v_mfma_f32_32x32x16_bf16 v[136:151], v[20:23], v[112:115], 0
    v_exp_f32 v125, v125
    v_exp_f32 v126, v126
    s_add_u32 s53, s29, 4
    s_and_b32 s53, s53, 7
    s_lshl_b32 s53, s53, 10
    s_add_u32 s53, s53, s23
    buffer_load_dwordx4 v[32:35], v2, s[12:15], s53 offen sc1
    s_add_u32 s53, s53, 65536
    buffer_load_dwordx4 v[80:83], v2, s[12:15], s53 offen sc1
    v_exp_f32 v127, v127
    v_exp_f32 v128, v128
    v_permlane16_swap_b32 v48, v52
    v_permlane16_swap_b32 v49, v53
    v_permlane16_swap_b32 v50, v54
    v_permlane16_swap_b32 v51, v55
    v_exp_f32 v129, v129
    v_exp_f32 v130, v130
    v_smfmac_f32_32x32x32_bf16 v[152:167], v[48:51], v[120:127], v14
    v_exp_f32 v131, v131
    v_exp_f32 v132, v132
    v_exp_f32 v133, v133
    v_exp_f32 v134, v134
    v_exp_f32 v135, v135
    v_exp_f32 v136, v136
    v_exp_f32 v137, v137
    v_smfmac_f32_32x32x32_bf16 v[152:167], v[52:55], v[128:135], v14
    v_exp_f32 v138, v138
    v_exp_f32 v139, v139
    v_exp_f32 v140, v140
    s_waitcnt vmcnt(7)
    v_mfma_f32_32x32x16_bf16 v[120:135], v[24:27], v[112:115], 0
    v_exp_f32 v141, v141
    v_exp_f32 v142, v142
    s_add_u32 s53, s29, 5
    s_and_b32 s53, s53, 7
    s_lshl_b32 s53, s53, 10
    s_add_u32 s53, s53, s23
    buffer_load_dwordx4 v[36:39], v2, s[12:15], s53 offen sc1
    s_add_u32 s53, s53, 65536
    buffer_load_dwordx4 v[88:91], v2, s[12:15], s53 offen sc1
    v_exp_f32 v143, v143
    v_exp_f32 v144, v144
    v_permlane16_swap_b32 v56, v60
    v_permlane16_swap_b32 v57, v61
    v_permlane16_swap_b32 v58, v62
    v_permlane16_swap_b32 v59, v63
    v_exp_f32 v145, v145
    v_exp_f32 v146, v146
    v_smfmac_f32_32x32x32_bf16 v[152:167], v[56:59], v[136:143], v14
    v_exp_f32 v147, v147
    v_exp_f32 v148, v148
    v_exp_f32 v149, v149
    v_exp_f32 v150, v150
    v_exp_f32 v151, v151
    s_setprio 2
    v_exp_f32 v120, v120
    v_exp_f32 v121, v121
    v_smfmac_f32_32x32x32_bf16 v[152:167], v[60:63], v[144:151], v14
    v_exp_f32 v122, v122
    v_exp_f32 v123, v123
    v_exp_f32 v124, v124
    s_waitcnt vmcnt(7)
    v_mfma_f32_32x32x16_bf16 v[136:151], v[28:31], v[112:115], 0
    v_exp_f32 v125, v125
    v_exp_f32 v126, v126
    s_add_u32 s53, s29, 6
    s_and_b32 s53, s53, 7
    s_lshl_b32 s53, s53, 10
    s_add_u32 s53, s53, s23
    buffer_load_dwordx4 v[40:43], v2, s[12:15], s53 offen sc1
    s_add_u32 s53, s53, 65536
    buffer_load_dwordx4 v[96:99], v2, s[12:15], s53 offen sc1
    v_exp_f32 v127, v127
    v_exp_f32 v128, v128
    v_permlane16_swap_b32 v64, v68
    v_permlane16_swap_b32 v65, v69
    v_permlane16_swap_b32 v66, v70
    v_permlane16_swap_b32 v67, v71
    v_exp_f32 v129, v129
    v_exp_f32 v130, v130
    v_smfmac_f32_32x32x32_bf16 v[152:167], v[64:67], v[120:127], v14
    v_exp_f32 v131, v131
    v_exp_f32 v132, v132
    v_exp_f32 v133, v133
    v_exp_f32 v134, v134
    v_exp_f32 v135, v135
    s_setprio 1
    v_exp_f32 v136, v136
    v_exp_f32 v137, v137
    v_smfmac_f32_32x32x32_bf16 v[152:167], v[68:71], v[128:135], v14
    v_exp_f32 v138, v138
    v_exp_f32 v139, v139
    v_exp_f32 v140, v140
    s_waitcnt vmcnt(5)
    v_mfma_f32_32x32x16_bf16 v[120:135], v[32:35], v[112:115], 0
    v_exp_f32 v141, v141
    v_exp_f32 v142, v142
    s_add_u32 s53, s29, 7
    s_and_b32 s53, s53, 7
    s_lshl_b32 s53, s53, 10
    s_add_u32 s53, s53, s23
    buffer_load_dwordx4 v[44:47], v2, s[12:15], s53 offen sc1
    s_add_u32 s53, s53, 65536
    buffer_load_dwordx4 v[104:107], v2, s[12:15], s53 offen sc1
    v_exp_f32 v143, v143
    v_exp_f32 v144, v144
    v_permlane16_swap_b32 v72, v76
    v_permlane16_swap_b32 v73, v77
    v_permlane16_swap_b32 v74, v78
    v_permlane16_swap_b32 v75, v79
    v_exp_f32 v145, v145
    v_exp_f32 v146, v146
    v_smfmac_f32_32x32x32_bf16 v[152:167], v[72:75], v[136:143], v14
    v_exp_f32 v147, v147
    v_exp_f32 v148, v148
    v_exp_f32 v149, v149
    v_exp_f32 v150, v150
    v_exp_f32 v151, v151
    s_setprio 0
    v_exp_f32 v120, v120
    v_exp_f32 v121, v121
    v_smfmac_f32_32x32x32_bf16 v[152:167], v[76:79], v[144:151], v14
    v_exp_f32 v122, v122
    v_exp_f32 v123, v123
    v_exp_f32 v124, v124
    s_waitcnt vmcnt(5)
    v_mfma_f32_32x32x16_bf16 v[136:151], v[36:39], v[112:115], 0
    v_exp_f32 v125, v125
    v_exp_f32 v126, v126
    v_exp_f32 v127, v127
    v_exp_f32 v128, v128
    v_permlane16_swap_b32 v80, v84
    v_permlane16_swap_b32 v81, v85
    v_permlane16_swap_b32 v82, v86
    v_permlane16_swap_b32 v83, v87
    v_exp_f32 v129, v129
    v_exp_f32 v130, v130
    v_smfmac_f32_32x32x32_bf16 v[152:167], v[80:83], v[120:127], v14
    v_exp_f32 v131, v131
    v_exp_f32 v132, v132
    s_mov_b32 exec_lo, 0
    s_mov_b32 exec_hi, 0x80000000
    buffer_store_dwordx2 v[174:175], v236, s[12:15], s34 offen sc1
    s_mov_b64 exec, -1
    v_exp_f32 v133, v133
    v_exp_f32 v134, v134
    v_exp_f32 v135, v135
    s_setprio 3
    s_waitcnt lgkmcnt(0)
    s_barrier
    v_exp_f32 v136, v136
    v_lshrrev_b32 v3, 3, v1
    v_mul_lo_u32 v3, v3, s61
    v_and_b32 v6, 0x70, v2
    v_add_u32 v3, v3, v6
    s_mov_b32 m0, s40
    s_mov_b32 s53, s60
    s_mov_b32 exec_hi, s41
    buffer_load_dwordx4 v3, s[56:59], s53 offen offset:0 lds
    s_add_u32 s53, s53, s32
    buffer_load_dwordx4 v3, s[56:59], s53 offen offset:1024 lds
    s_add_u32 s53, s53, s32
    buffer_load_dwordx4 v3, s[56:59], s53 offen offset:2048 lds
    s_add_u32 s53, s53, s32
    buffer_load_dwordx4 v3, s[56:59], s53 offen offset:3072 lds
    s_mov_b64 exec, -1
    v_exp_f32 v137, v137
    v_smfmac_f32_32x32x32_bf16 v[152:167], v[84:87], v[128:135], v14
    v_exp_f32 v138, v138
    v_mov_b32 v6, s92
    s_mov_b64 exec, 1
    buffer_store_dword v6, v4, s[12:15], s39 offen sc1
    s_mov_b64 exec, -1
    v_exp_f32 v139, v139
    v_exp_f32 v140, v140
    s_waitcnt vmcnt(9)
    v_mfma_f32_32x32x16_bf16 v[120:135], v[40:43], v[112:115], 0
    v_exp_f32 v141, v141
    v_exp_f32 v142, v142
    v_exp_f32 v143, v143
    v_exp_f32 v144, v144
    v_permlane16_swap_b32 v88, v92
    v_permlane16_swap_b32 v89, v93
    v_permlane16_swap_b32 v90, v94
    v_permlane16_swap_b32 v91, v95
    v_exp_f32 v145, v145
    v_exp_f32 v146, v146
    v_smfmac_f32_32x32x32_bf16 v[152:167], v[88:91], v[136:143], v14
    v_exp_f32 v147, v147
    v_exp_f32 v148, v148
    v_exp_f32 v149, v149
    v_exp_f32 v150, v150
    v_exp_f32 v151, v151
    v_exp_f32 v120, v120
    v_exp_f32 v121, v121
    v_smfmac_f32_32x32x32_bf16 v[152:167], v[92:95], v[144:151], v14
    v_exp_f32 v122, v122
    v_exp_f32 v123, v123
    v_exp_f32 v124, v124
    s_waitcnt vmcnt(7)
    v_mfma_f32_32x32x16_bf16 v[136:151], v[44:47], v[112:115], 0
    v_exp_f32 v125, v125
    v_exp_f32 v126, v126
    v_exp_f32 v127, v127
    v_exp_f32 v128, v128
    v_permlane16_swap_b32 v96, v100
    v_permlane16_swap_b32 v97, v101
    v_permlane16_swap_b32 v98, v102
    v_permlane16_swap_b32 v99, v103
    v_exp_f32 v129, v129
    v_exp_f32 v130, v130
    v_smfmac_f32_32x32x32_bf16 v[152:167], v[96:99], v[120:127], v14
    v_exp_f32 v131, v131
    v_exp_f32 v132, v132
    v_exp_f32 v133, v133
    v_exp_f32 v134, v134
    v_exp_f32 v135, v135
    s_setprio 2
    v_exp_f32 v136, v136
    v_exp_f32 v137, v137
    v_smfmac_f32_32x32x32_bf16 v[152:167], v[100:103], v[128:135], v14
    v_exp_f32 v138, v138
    v_exp_f32 v139, v139
    v_exp_f32 v140, v140
    v_mfma_f32_32x32x16_bf16 v[120:135], v[16:19], v[116:119], 0
    v_exp_f32 v141, v141
    v_exp_f32 v142, v142
    v_exp_f32 v143, v143
    v_exp_f32 v144, v144
    s_waitcnt vmcnt(6)
    v_permlane16_swap_b32 v104, v108
    v_permlane16_swap_b32 v105, v109
    v_permlane16_swap_b32 v106, v110
    v_permlane16_swap_b32 v107, v111
    v_exp_f32 v145, v145
    v_exp_f32 v146, v146
    v_smfmac_f32_32x32x32_bf16 v[152:167], v[104:107], v[136:143], v14
    v_exp_f32 v147, v147
    v_exp_f32 v148, v148
    v_exp_f32 v149, v149
    s_waitcnt lgkmcnt(0)
    v_mfma_f32_32x32x16_bf16 v[168:183], v[236:239], v[236:239], 0
    v_exp_f32 v150, v150
    v_exp_f32 v151, v151
    s_setprio 1
    v_exp_f32 v120, v120
    v_exp_f32 v121, v121
    v_smfmac_f32_32x32x32_bf16 v[152:167], v[108:111], v[144:151], v14
    v_exp_f32 v122, v122
    v_exp_f32 v123, v123
    v_exp_f32 v124, v124
    v_mfma_f32_32x32x16_bf16 v[136:151], v[20:23], v[116:119], 0
    v_exp_f32 v125, v125
    v_exp_f32 v126, v126
    v_exp_f32 v127, v127
    v_exp_f32 v128, v128
    v_exp_f32 v129, v129
    v_exp_f32 v130, v130
    v_smfmac_f32_32x32x32_bf16 v[168:183], v[48:51], v[120:127], v14
    v_exp_f32 v131, v131
    v_exp_f32 v132, v132
    v_exp_f32 v133, v133
    v_exp_f32 v134, v134
    ds_write2st64_b32 v7, v152, v153 offset0:0 offset1:1
    ds_write2st64_b32 v7, v154, v155 offset0:2 offset1:3
    ds_write2st64_b32 v7, v156, v157 offset0:4 offset1:5
    ds_write2st64_b32 v7, v158, v159 offset0:6 offset1:7
    ds_write_b32 v7, v160 offset:2048
    v_exp_f32 v135, v135
    s_setprio 0
    v_exp_f32 v136, v136
    v_exp_f32 v137, v137
    v_smfmac_f32_32x32x32_bf16 v[168:183], v[52:55], v[128:135], v14
    v_exp_f32 v138, v138
    v_exp_f32 v139, v139
    v_exp_f32 v140, v140
    v_mfma_f32_32x32x16_bf16 v[120:135], v[24:27], v[116:119], 0
    v_exp_f32 v141, v141
    v_exp_f32 v142, v142
    v_exp_f32 v143, v143
    v_exp_f32 v144, v144
    v_exp_f32 v145, v145
    v_exp_f32 v146, v146
    v_smfmac_f32_32x32x32_bf16 v[168:183], v[56:59], v[136:143], v14
    v_exp_f32 v147, v147
    v_exp_f32 v148, v148
    v_exp_f32 v149, v149
    v_exp_f32 v150, v150
    v_exp_f32 v151, v151
    s_setprio 3
    s_waitcnt lgkmcnt(0)
    s_barrier
    v_exp_f32 v120, v120
    ds_read2st64_b32 v[160:161], v4 offset0:8 offset1:17
    v_exp_f32 v121, v121
    v_smfmac_f32_32x32x32_bf16 v[168:183], v[60:63], v[144:151], v14
    v_exp_f32 v122, v122
    ds_read2st64_b32 v[162:163], v4 offset0:26 offset1:35
    v_exp_f32 v123, v123
    v_exp_f32 v124, v124
    v_mfma_f32_32x32x16_bf16 v[136:151], v[28:31], v[116:119], 0
    ds_read2st64_b32 v[164:165], v4 offset0:44 offset1:53
    v_exp_f32 v125, v125
    v_exp_f32 v126, v126
    ds_read2st64_b32 v[166:167], v4 offset0:62 offset1:71
    v_exp_f32 v127, v127
    v_exp_f32 v128, v128
    ds_read2st64_b32 v[152:153], v13 offset0:0 offset1:9
    v_exp_f32 v129, v129
    v_exp_f32 v130, v130
    v_smfmac_f32_32x32x32_bf16 v[168:183], v[64:67], v[120:127], v14
    ds_read2st64_b32 v[154:155], v13 offset0:18 offset1:27
    v_exp_f32 v131, v131
    buffer_load_dwordx2 v[8:9], v11, s[12:15], s36 offen sc1
    v_exp_f32 v132, v132
    ds_read2st64_b32 v[156:157], v13 offset0:36 offset1:45
    v_exp_f32 v133, v133
    ds_read2st64_b32 v[158:159], v13 offset0:54 offset1:63
    v_exp_f32 v134, v134
    v_exp_f32 v135, v135
    s_setprio 2
    v_exp_f32 v136, v136
    v_exp_f32 v137, v137
    v_smfmac_f32_32x32x32_bf16 v[168:183], v[68:71], v[128:135], v14
    v_exp_f32 v138, v138
    v_exp_f32 v139, v139
    s_waitcnt lgkmcnt(0)
    v_pk_add_f32 v[160:161], v[160:161], v[162:163]
    v_pk_add_f32 v[164:165], v[164:165], v[166:167]
    v_pk_add_f32 v[152:153], v[152:153], v[154:155]
    v_pk_add_f32 v[156:157], v[156:157], v[158:159]
    v_pk_add_f32 v[160:161], v[160:161], v[164:165]
    v_pk_add_f32 v[152:153], v[152:153], v[156:157]
    v_add_f32 v160, v160, v161
    v_rcp_f32 v160, v160
    v_add_f32 v152, v152, v153
    v_exp_f32 v140, v140
    v_mfma_f32_32x32x16_bf16 v[120:135], v[32:35], v[116:119], 0
    v_mul_f32 v152, v152, v160
    v_cvt_pk_bf16_f32 v152, v152, v152
    ds_write_b16 v5, v152 offset:18432
    v_exp_f32 v141, v141
    v_exp_f32 v142, v142
    v_exp_f32 v143, v143
    v_exp_f32 v144, v144
    v_exp_f32 v145, v145
    v_exp_f32 v146, v146
    v_smfmac_f32_32x32x32_bf16 v[168:183], v[72:75], v[136:143], v14
    v_exp_f32 v147, v147
    v_exp_f32 v148, v148
    v_exp_f32 v149, v149
    v_exp_f32 v150, v150
    v_exp_f32 v151, v151
    s_setprio 3
    s_waitcnt lgkmcnt(0)
    s_barrier
    v_exp_f32 v120, v120
    v_lshlrev_b32 v10, 1, v4
    v_and_b32 v10, 56, v10
    ds_read_b64 v[232:233], v10 offset:57344
    v_exp_f32 v121, v121
    v_smfmac_f32_32x32x32_bf16 v[168:183], v[76:79], v[144:151], v14
    v_exp_f32 v122, v122
    v_exp_f32 v123, v123
    v_exp_f32 v124, v124
    v_mfma_f32_32x32x16_bf16 v[136:151], v[36:39], v[116:119], 0
    v_exp_f32 v125, v125
    v_exp_f32 v126, v126
    v_exp_f32 v127, v127
    v_exp_f32 v128, v128
    v_exp_f32 v129, v129
    v_exp_f32 v130, v130
    v_smfmac_f32_32x32x32_bf16 v[168:183], v[80:83], v[120:127], v14
    v_exp_f32 v131, v131
    s_waitcnt vmcnt(0)
    s_mov_b32 s54, 0
L_rc1:
    v_cmp_ne_u32 vcc, s92, v9
    s_cmp_eq_u64 vcc, 0
    s_cbranch_scc1 L_rc1_ok
    s_add_u32 s54, s54, 1
    s_cmp_gt_u32 s54, 1048576
    s_cbranch_scc1 L_rc1_ok
    s_sleep 4
    buffer_load_dwordx2 v[8:9], v11, s[12:15], s36 offen sc1
    s_waitcnt vmcnt(0)
    s_branch L_rc1
L_rc1_ok:
    s_waitcnt lgkmcnt(0)
    v_cmp_lt_u32 vcc, 3, v233
    v_max_u32_dpp v8, v8, v8 row_ror:1 row_mask:0xf bank_mask:0xf
    s_cmp_lg_u64 vcc, 0
    s_cselect_b32 s55, 1, 0
    v_max_u32_dpp v8, v8, v8 row_ror:2 row_mask:0xf bank_mask:0xf
    v_and_b32 v10, 2, v233
    v_cmp_ne_u32 vcc, 0, v10
    v_max_u32_dpp v8, v8, v8 row_ror:4 row_mask:0xf bank_mask:0xf
    s_cmp_eq_u64 vcc, 0
    s_cbranch_scc1 L_kb_slow
    v_max_u32_dpp v8, v8, v8 row_ror:8 row_mask:0xf bank_mask:0xf
    v_and_b32 v10, 1, v233
    v_cmp_ne_u32 s[46:47], 0, v10
    v_mul_f32 v8, v8, v232
    v_cmp_nge_f32 vcc, 0x45584352, v8
    s_or_b64 vcc, vcc, s[46:47]
    s_cbranch_scc1 L_kb_slow
    v_exp_f32 v132, v132
    s_add_u32 s22, s33, 2
    s_and_b32 s22, s22, 7
    s_lshl_b32 s22, s22, 10
    s_add_u32 s22, s22, s21
    buffer_load_dwordx4 v[112:115], v2, s[12:15], s22 offen sc1
    v_exp_f32 v133, v133
    v_exp_f32 v134, v134
    v_exp_f32 v135, v135
    v_exp_f32 v136, v136
    ds_read_b128 v[232:235], v2 offset:18432
    v_exp_f32 v137, v137
    v_smfmac_f32_32x32x32_bf16 v[168:183], v[84:87], v[128:135], v14
    v_exp_f32 v138, v138
    v_exp_f32 v139, v139
    v_exp_f32 v140, v140
    v_mfma_f32_32x32x16_bf16 v[120:135], v[40:43], v[116:119], 0
    v_exp_f32 v141, v141
    v_exp_f32 v142, v142
    v_exp_f32 v143, v143
    v_bfe_u32 v9, v1, 2, 2
    v_and_b32 v3, 3, v1
    s_cmp_ge_u32 s3, 4
    s_cbranch_scc1 L_pa2
    v_bfe_u32 v8, v1, 5, 1
    v_lshlrev_b32 v8, s31, v8
    v_add_lshl_u32 v8, v8, v9, 7
    v_bfe_u32 v9, v1, 4, 1
    v_lshl_add_u32 v8, v9, 5, v8
    v_lshl_add_u32 v8, v3, 3, v8
    v_add_u32 v3, s40, v8
    v_add_u32 v6, s95, v3
    s_branch L_pa2_e
L_pa2:
    v_lshrrev_b32 v6, 4, v1
    v_lshl_add_u32 v9, v6, 4, v9
    v_lshlrev_b32 v3, 3, v3
    v_lshl_add_u32 v3, v9, 7, v3
    s_lshl_b32 s53, s3, 5
    s_add_u32 s53, s53, 38784
    v_add_u32 v3, s53, v3
    v_lshlrev_b32 v6, 4, v6
    v_add_u32 v8, 152576, v6
L_pa2_e:
    v_exp_f32 v144, v144
    v_exp_f32 v145, v145
    v_exp_f32 v146, v146
    v_smfmac_f32_32x32x32_bf16 v[168:183], v[88:91], v[136:143], v14
    v_exp_f32 v147, v147
    v_exp_f32 v148, v148
    v_exp_f32 v149, v149
    s_waitcnt lgkmcnt(0)
    v_smfmac_f32_16x16x64_bf16 v[216:219], v[232:235], v[184:191], v15
    v_exp_f32 v150, v150
    v_exp_f32 v151, v151
    s_setprio 2
    v_smfmac_f32_16x16x64_bf16 v[220:223], v[232:235], v[192:199], v15
    v_exp_f32 v120, v120
    v_exp_f32 v121, v121
    v_smfmac_f32_32x32x32_bf16 v[168:183], v[92:95], v[144:151], v14
    v_exp_f32 v122, v122
    s_add_u32 s48, s33, 1
    s_and_b32 s48, s48, 7
    s_lshl_b32 s48, s48, 16
    s_add_u32 s48, s48, s27
    buffer_load_dwordx4 v[184:187], v2, s[12:15], s48 offen offset:0 sc1
    v_exp_f32 v123, v123
    v_exp_f32 v124, v124
    v_mfma_f32_32x32x16_bf16 v[136:151], v[44:47], v[116:119], 0
    v_exp_f32 v125, v125
    v_exp_f32 v126, v126
    buffer_load_dwordx4 v[188:191], v2, s[12:15], s48 offen offset:1024 sc1
    v_exp_f32 v127, v127
    v_smfmac_f32_16x16x64_bf16 v[224:227], v[232:235], v[200:207], v15
    v_exp_f32 v128, v128
    v_exp_f32 v129, v129
    v_exp_f32 v130, v130
    v_smfmac_f32_32x32x32_bf16 v[168:183], v[96:99], v[120:127], v14
    v_exp_f32 v131, v131
    buffer_load_dwordx4 v[192:195], v2, s[12:15], s48 offen offset:2048 sc1
    v_exp_f32 v132, v132
    v_exp_f32 v133, v133
    v_smfmac_f32_16x16x64_bf16 v[228:231], v[232:235], v[208:215], v15
    v_exp_f32 v134, v134
    v_exp_f32 v135, v135
    v_exp_f32 v136, v136
    v_exp_f32 v137, v137
    v_smfmac_f32_32x32x32_bf16 v[168:183], v[100:103], v[128:135], v14
    buffer_load_dwordx4 v[196:199], v2, s[12:15], s48 offen offset:3072 sc1
    v_exp_f32 v138, v138
    v_exp_f32 v139, v139
    v_exp_f32 v140, v140
    s_waitcnt vmcnt(4)
    v_mfma_f32_32x32x16_bf16 v[120:135], v[16:19], v[112:115], 0
    v_exp_f32 v141, v141
    v_exp_f32 v142, v142
    s_add_u32 s48, s48, 4096
    buffer_load_dwordx4 v[200:203], v2, s[12:15], s48 offen offset:0 sc1
    v_exp_f32 v143, v143
    v_exp_f32 v144, v144
    v_exp_f32 v145, v145
    s_cmp_ge_u32 s3, 3
    s_cbranch_scc1 L_pp3
    ds_read_b64_tr_b16 v[8:9], v3 offset:0
    ds_read_b64_tr_b16 v[10:11], v6 offset:0
L_pp3:
    v_exp_f32 v146, v146
    v_smfmac_f32_32x32x32_bf16 v[168:183], v[104:107], v[136:143], v14
    v_exp_f32 v147, v147
    buffer_load_dwordx4 v[204:207], v2, s[12:15], s48 offen offset:1024 sc1
    v_exp_f32 v148, v148
    v_exp_f32 v149, v149
    s_waitcnt lgkmcnt(0)
    v_mfma_f32_32x32x16_bf16 v[152:167], v[236:239], v[236:239], 0
    v_exp_f32 v150, v150
    v_exp_f32 v151, v151
    s_setprio 1
    v_exp_f32 v120, v120
    s_cmp_ge_u32 s3, 3
    s_cbranch_scc1 L_pp4
    s_waitcnt lgkmcnt(0)
    buffer_store_dwordx4 v[8:11], v2, s[12:15], s93 offen offset:0 sc1
L_pp4:
    v_exp_f32 v121, v121
    v_smfmac_f32_32x32x32_bf16 v[168:183], v[108:111], v[144:151], v14
    v_exp_f32 v122, v122
    buffer_load_dwordx4 v[208:211], v2, s[12:15], s48 offen offset:2048 sc1
    v_exp_f32 v123, v123
    v_exp_f32 v124, v124
    v_mfma_f32_32x32x16_bf16 v[136:151], v[20:23], v[112:115], 0
    v_exp_f32 v125, v125
    s_cmp_ge_u32 s3, 3
    s_cbranch_scc1 L_pp5
    ds_read_b64_tr_b16 v[8:9], v3 offset:2048
    ds_read_b64_tr_b16 v[10:11], v6 offset:2048
L_pp5:
    v_exp_f32 v126, v126
    v_exp_f32 v127, v127
    buffer_load_dwordx4 v[212:215], v2, s[12:15], s48 offen offset:3072 sc1
    v_exp_f32 v128, v128
    v_exp_f32 v129, v129
    v_exp_f32 v130, v130
    v_smfmac_f32_32x32x32_bf16 v[152:167], v[48:51], v[120:127], v14
    v_exp_f32 v131, v131
    v_exp_f32 v132, v132
    s_cmp_ge_u32 s3, 3
    s_cbranch_scc1 L_pp6
    s_waitcnt lgkmcnt(0)
    buffer_store_dwordx4 v[8:11], v2, s[12:15], s93 offen offset:1024 sc1
L_pp6:
    v_exp_f32 v133, v133
    v_exp_f32 v134, v134
    ds_write2st64_b32 v7, v168, v169 offset0:0 offset1:1
    ds_write2st64_b32 v7, v170, v171 offset0:2 offset1:3
    ds_write2st64_b32 v7, v172, v173 offset0:4 offset1:5
    ds_write2st64_b32 v7, v174, v175 offset0:6 offset1:7
    ds_write_b32 v7, v176 offset:2048
    v_exp_f32 v135, v135
    s_setprio 0
    v_exp_f32 v136, v136
    v_exp_f32 v137, v137
    v_smfmac_f32_32x32x32_bf16 v[152:167], v[52:55], v[128:135], v14
    v_exp_f32 v138, v138
    v_exp_f32 v139, v139
    v_exp_f32 v140, v140
    v_mfma_f32_32x32x16_bf16 v[120:135], v[24:27], v[112:115], 0
    v_exp_f32 v141, v141
    v_exp_f32 v142, v142
    v_exp_f32 v143, v143
    v_exp_f32 v144, v144
    v_exp_f32 v145, v145
    v_exp_f32 v146, v146
    v_smfmac_f32_32x32x32_bf16 v[152:167], v[56:59], v[136:143], v14
    v_exp_f32 v147, v147
    v_exp_f32 v148, v148
    v_exp_f32 v149, v149
    v_exp_f32 v150, v150
    v_exp_f32 v151, v151
    s_setprio 3
    s_waitcnt lgkmcnt(0)
    s_barrier
    v_exp_f32 v120, v120
    ds_read2st64_b32 v[176:177], v4 offset0:8 offset1:17
    v_exp_f32 v121, v121
    v_smfmac_f32_32x32x32_bf16 v[152:167], v[60:63], v[144:151], v14
    v_exp_f32 v122, v122
    ds_read2st64_b32 v[178:179], v4 offset0:26 offset1:35
    v_exp_f32 v123, v123
    v_exp_f32 v124, v124
    v_mfma_f32_32x32x16_bf16 v[136:151], v[28:31], v[112:115], 0
    ds_read2st64_b32 v[180:181], v4 offset0:44 offset1:53
    v_exp_f32 v125, v125
    v_exp_f32 v126, v126
    ds_read2st64_b32 v[182:183], v4 offset0:62 offset1:71
    v_exp_f32 v127, v127
    v_exp_f32 v128, v128
    ds_read2st64_b32 v[168:169], v13 offset0:0 offset1:9
    v_exp_f32 v129, v129
    v_exp_f32 v130, v130
    v_smfmac_f32_32x32x32_bf16 v[152:167], v[64:67], v[120:127], v14
    ds_read2st64_b32 v[170:171], v13 offset0:18 offset1:27
    v_exp_f32 v131, v131
    v_exp_f32 v132, v132
    ds_read2st64_b32 v[172:173], v13 offset0:36 offset1:45
    v_exp_f32 v133, v133
    ds_read2st64_b32 v[174:175], v13 offset0:54 offset1:63
    v_exp_f32 v134, v134
    v_exp_f32 v135, v135
    s_setprio 2
    v_exp_f32 v136, v136
    v_exp_f32 v137, v137
    v_smfmac_f32_32x32x32_bf16 v[152:167], v[68:71], v[128:135], v14
    v_exp_f32 v138, v138
    v_exp_f32 v139, v139
    s_waitcnt lgkmcnt(0)
    v_pk_add_f32 v[176:177], v[176:177], v[178:179]
    v_pk_add_f32 v[180:181], v[180:181], v[182:183]
    v_pk_add_f32 v[168:169], v[168:169], v[170:171]
    v_pk_add_f32 v[172:173], v[172:173], v[174:175]
    v_pk_add_f32 v[176:177], v[176:177], v[180:181]
    v_pk_add_f32 v[168:169], v[168:169], v[172:173]
    v_add_f32 v176, v176, v177
    v_rcp_f32 v176, v176
    v_add_f32 v168, v168, v169
    v_exp_f32 v140, v140
    v_mfma_f32_32x32x16_bf16 v[120:135], v[32:35], v[112:115], 0
    v_mul_f32 v168, v168, v176
    v_cvt_pk_bf16_f32 v168, v168, v168
    ds_write_b16 v5, v168 offset:19456
    v_exp_f32 v141, v141
    v_exp_f32 v142, v142
    v_exp_f32 v143, v143
    v_exp_f32 v144, v144
    v_exp_f32 v145, v145
    v_exp_f32 v146, v146
    v_smfmac_f32_32x32x32_bf16 v[152:167], v[72:75], v[136:143], v14
    v_exp_f32 v147, v147
    v_exp_f32 v148, v148
    v_exp_f32 v149, v149
    v_exp_f32 v150, v150
    v_exp_f32 v151, v151
    s_setprio 3
    s_waitcnt lgkmcnt(0)
    s_barrier
    v_exp_f32 v120, v120
    s_add_u32 s22, s33, 3
    s_and_b32 s22, s22, 7
    s_lshl_b32 s22, s22, 10
    s_add_u32 s22, s22, s21
    buffer_load_dwordx4 v[116:119], v2, s[12:15], s22 offen sc1
    v_exp_f32 v121, v121
    v_smfmac_f32_32x32x32_bf16 v[152:167], v[76:79], v[144:151], v14
    v_exp_f32 v122, v122
    ds_read_b128 v[232:235], v2 offset:19456
    v_exp_f32 v123, v123
    v_exp_f32 v124, v124
    v_mfma_f32_32x32x16_bf16 v[136:151], v[36:39], v[112:115], 0
    v_exp_f32 v125, v125
    s_cmp_ge_u32 s3, 3
    s_cbranch_scc1 L_pp7
    ds_read_b64_tr_b16 v[8:9], v3 offset:64
    ds_read_b64_tr_b16 v[10:11], v6 offset:64
L_pp7:
    v_exp_f32 v126, v126
    v_exp_f32 v127, v127
    s_cmp_lt_u32 s3, 4
    s_cbranch_scc1 L_mq8
    ds_read_b64_tr_b16 v[168:169], v3 offset:0
    ds_read_b64_tr_b16 v[170:171], v3 offset:1024
    ds_read_b64_tr_b16 v[172:173], v3 offset:8192
    ds_read_b64_tr_b16 v[174:175], v3 offset:9216
    ds_read_b128 v[176:179], v8
    ds_read_b128 v[8:11], v8 offset:64
L_mq8:
    v_exp_f32 v128, v128
    v_exp_f32 v129, v129
    v_exp_f32 v130, v130
    v_smfmac_f32_32x32x32_bf16 v[152:167], v[80:83], v[120:127], v14
    v_exp_f32 v131, v131
    v_exp_f32 v132, v132
    v_exp_f32 v133, v133
    s_waitcnt lgkmcnt(0)
    s_waitcnt vmcnt(7)
    v_smfmac_f32_16x16x64_bf16 v[216:219], v[232:235], v[184:191], v15
    v_exp_f32 v134, v134
    v_exp_f32 v135, v135
    s_waitcnt vmcnt(5)
    v_smfmac_f32_16x16x64_bf16 v[220:223], v[232:235], v[192:199], v15
    v_exp_f32 v136, v136
    v_exp_f32 v137, v137
    v_smfmac_f32_32x32x32_bf16 v[152:167], v[84:87], v[128:135], v14
    s_cmp_ge_u32 s3, 3
    s_cbranch_scc1 L_pp9
    s_waitcnt lgkmcnt(0)
    buffer_store_dwordx4 v[8:11], v2, s[12:15], s94 offen offset:0 sc1
L_pp9:
    v_exp_f32 v138, v138
    v_exp_f32 v139, v139
    s_cmp_lt_u32 s3, 4
    s_cbranch_scc1 L_mq10
    s_waitcnt lgkmcnt(0)
    v_mfma_f32_16x16x32_bf16 v[180:183], v[168:171], v[176:179], 0
    v_mfma_f32_16x16x32_bf16 v[180:183], v[172:175], v[8:11], v[180:183]
L_mq10:
    s_add_u32 s48, s33, 2
    s_and_b32 s48, s48, 7
    s_lshl_b32 s48, s48, 16
    s_add_u32 s48, s48, s27
    buffer_load_dwordx4 v[184:187], v2, s[12:15], s48 offen offset:0 sc1
    v_exp_f32 v140, v140
    v_mfma_f32_32x32x16_bf16 v[120:135], v[40:43], v[112:115], 0
    v_exp_f32 v141, v141
    v_exp_f32 v142, v142
    v_exp_f32 v143, v143
    s_waitcnt vmcnt(4)
    v_smfmac_f32_16x16x64_bf16 v[224:227], v[232:235], v[200:207], v15
    v_exp_f32 v144, v144
    v_exp_f32 v145, v145
    s_cmp_ge_u32 s3, 3
    s_cbranch_scc1 L_pp11
    ds_read_b64_tr_b16 v[8:9], v3 offset:2112
    ds_read_b64_tr_b16 v[10:11], v6 offset:2112
L_pp11:
    v_exp_f32 v146, v146
    v_smfmac_f32_32x32x32_bf16 v[152:167], v[88:91], v[136:143], v14
    v_exp_f32 v147, v147
    buffer_load_dwordx4 v[188:191], v2, s[12:15], s48 offen offset:1024 sc1
    v_exp_f32 v148, v148
    v_exp_f32 v149, v149
    s_waitcnt vmcnt(3)
    v_smfmac_f32_16x16x64_bf16 v[228:231], v[232:235], v[208:215], v15
    v_exp_f32 v150, v150
    v_exp_f32 v151, v151
    s_setprio 2
    v_exp_f32 v120, v120
    s_cmp_lt_u32 s3, 4
    s_cbranch_scc1 L_mq12
    s_mov_b32 exec_lo, 0x10001
    s_mov_b32 exec_hi, 0x10001
    buffer_store_dwordx4 v[180:183], v6, s[12:15], s93 offen sc1
    s_mov_b64 exec, -1
L_mq12:
    v_exp_f32 v121, v121
    v_smfmac_f32_32x32x32_bf16 v[152:167], v[92:95], v[144:151], v14
    s_cmp_ge_u32 s3, 3
    s_cbranch_scc1 L_pp13
    s_waitcnt lgkmcnt(0)
    buffer_store_dwordx4 v[8:11], v2, s[12:15], s94 offen offset:1024 sc1
L_pp13:
    v_exp_f32 v122, v122
    v_exp_f32 v123, v123
    buffer_load_dwordx4 v[192:195], v2, s[12:15], s48 offen offset:2048 sc1
    v_exp_f32 v124, v124
    v_mfma_f32_32x32x16_bf16 v[136:151], v[44:47], v[112:115], 0
    v_exp_f32 v125, v125
    v_exp_f32 v126, v126
    v_exp_f32 v127, v127
    v_exp_f32 v128, v128
    v_exp_f32 v129, v129
    v_exp_f32 v130, v130
    v_smfmac_f32_32x32x32_bf16 v[152:167], v[96:99], v[120:127], v14
    v_exp_f32 v131, v131
    v_exp_f32 v132, v132
    buffer_load_dwordx4 v[196:199], v2, s[12:15], s48 offen offset:3072 sc1
    v_exp_f32 v133, v133
    v_exp_f32 v134, v134
    v_exp_f32 v135, v135
    v_exp_f32 v136, v136
    v_exp_f32 v137, v137
    v_smfmac_f32_32x32x32_bf16 v[152:167], v[100:103], v[128:135], v14
    v_exp_f32 v138, v138
    v_exp_f32 v139, v139
    s_add_u32 s48, s48, 4096
    buffer_load_dwordx4 v[200:203], v2, s[12:15], s48 offen offset:0 sc1
    v_exp_f32 v140, v140
    s_waitcnt vmcnt(5)
    v_mfma_f32_32x32x16_bf16 v[120:135], v[16:19], v[116:119], 0
    v_exp_f32 v141, v141
    v_exp_f32 v142, v142
    v_exp_f32 v143, v143
    v_exp_f32 v144, v144
    v_exp_f32 v145, v145
    v_exp_f32 v146, v146
    v_smfmac_f32_32x32x32_bf16 v[152:167], v[104:107], v[136:143], v14
    v_exp_f32 v147, v147
    buffer_load_dwordx4 v[204:207], v2, s[12:15], s48 offen offset:1024 sc1
    v_exp_f32 v148, v148
    v_exp_f32 v149, v149
    s_waitcnt lgkmcnt(0)
    v_mfma_f32_32x32x16_bf16 v[168:183], v[236:239], v[236:239], 0
    v_exp_f32 v150, v150
    v_exp_f32 v151, v151
    s_setprio 1
    v_exp_f32 v120, v120
    v_exp_f32 v121, v121
    v_smfmac_f32_32x32x32_bf16 v[152:167], v[108:111], v[144:151], v14
    v_exp_f32 v122, v122
    buffer_load_dwordx4 v[208:211], v2, s[12:15], s48 offen offset:2048 sc1
    v_exp_f32 v123, v123
    v_exp_f32 v124, v124
    v_mfma_f32_32x32x16_bf16 v[136:151], v[20:23], v[116:119], 0
    v_exp_f32 v125, v125
    v_exp_f32 v126, v126
    v_exp_f32 v127, v127
    buffer_load_dwordx4 v[212:215], v2, s[12:15], s48 offen offset:3072 sc1
    v_exp_f32 v128, v128
    v_exp_f32 v129, v129
    v_exp_f32 v130, v130
    v_smfmac_f32_32x32x32_bf16 v[168:183], v[48:51], v[120:127], v14
    v_exp_f32 v131, v131
    v_exp_f32 v132, v132
    v_exp_f32 v133, v133
    v_exp_f32 v134, v134
    ds_write2st64_b32 v7, v152, v153 offset0:0 offset1:1
    ds_write2st64_b32 v7, v154, v155 offset0:2 offset1:3
    ds_write2st64_b32 v7, v156, v157 offset0:4 offset1:5
    ds_write2st64_b32 v7, v158, v159 offset0:6 offset1:7
    ds_write_b32 v7, v160 offset:2048
    v_exp_f32 v135, v135
    s_setprio 0
    v_exp_f32 v136, v136
    v_exp_f32 v137, v137
    v_smfmac_f32_32x32x32_bf16 v[168:183], v[52:55], v[128:135], v14
    v_exp_f32 v138, v138
    v_exp_f32 v139, v139
    v_exp_f32 v140, v140
    v_mfma_f32_32x32x16_bf16 v[120:135], v[24:27], v[116:119], 0
    v_exp_f32 v141, v141
    v_exp_f32 v142, v142
    v_exp_f32 v143, v143
    v_exp_f32 v144, v144
    v_exp_f32 v145, v145
    v_exp_f32 v146, v146
    v_smfmac_f32_32x32x32_bf16 v[168:183], v[56:59], v[136:143], v14
    v_exp_f32 v147, v147
    v_exp_f32 v148, v148
    s_waitcnt vmcnt(4)
    v_exp_f32 v149, v149
    v_exp_f32 v150, v150
    v_exp_f32 v151, v151
    s_setprio 3
    s_waitcnt lgkmcnt(0)
    s_barrier
    v_exp_f32 v120, v120
    ds_read2st64_b32 v[160:161], v4 offset0:8 offset1:17
    v_exp_f32 v121, v121
    v_smfmac_f32_32x32x32_bf16 v[168:183], v[60:63], v[144:151], v14
    v_mov_b32 v6, s92
    v_and_b32 v11, 7, v1
    v_lshlrev_b32 v10, 10, v11
    v_lshrrev_b32 v3, 3, v1
    v_lshl_add_u32 v3, v3, 4, v10
    s_mov_b64 exec, 1
    buffer_store_dword v6, v4, s[12:15], s37 offen sc1
    s_mov_b64 exec, -1
    v_exp_f32 v122, v122
    ds_read2st64_b32 v[162:163], v4 offset0:26 offset1:35
    v_exp_f32 v123, v123
    v_exp_f32 v124, v124
    v_mfma_f32_32x32x16_bf16 v[136:151], v[28:31], v[116:119], 0
    ds_read2st64_b32 v[164:165], v4 offset0:44 offset1:53
    v_exp_f32 v125, v125
    v_exp_f32 v126, v126
    ds_read2st64_b32 v[166:167], v4 offset0:62 offset1:71
    v_exp_f32 v127, v127
    v_exp_f32 v128, v128
    ds_read2st64_b32 v[152:153], v13 offset0:0 offset1:9
    v_exp_f32 v129, v129
    v_exp_f32 v130, v130
    v_smfmac_f32_32x32x32_bf16 v[168:183], v[64:67], v[120:127], v14
    ds_read2st64_b32 v[154:155], v13 offset0:18 offset1:27
    v_exp_f32 v131, v131
    v_exp_f32 v132, v132
    ds_read2st64_b32 v[156:157], v13 offset0:36 offset1:45
    v_exp_f32 v133, v133
    ds_read2st64_b32 v[158:159], v13 offset0:54 offset1:63
    v_exp_f32 v134, v134
    v_exp_f32 v135, v135
    s_setprio 2
    v_exp_f32 v136, v136
    v_exp_f32 v137, v137
    v_smfmac_f32_32x32x32_bf16 v[168:183], v[68:71], v[128:135], v14
    v_exp_f32 v138, v138
    v_exp_f32 v139, v139
    s_waitcnt lgkmcnt(0)
    v_pk_add_f32 v[160:161], v[160:161], v[162:163]
    v_pk_add_f32 v[164:165], v[164:165], v[166:167]
    v_pk_add_f32 v[152:153], v[152:153], v[154:155]
    v_pk_add_f32 v[156:157], v[156:157], v[158:159]
    v_pk_add_f32 v[160:161], v[160:161], v[164:165]
    v_pk_add_f32 v[152:153], v[152:153], v[156:157]
    v_add_f32 v160, v160, v161
    v_rcp_f32 v160, v160
    v_add_f32 v152, v152, v153
    v_exp_f32 v140, v140
    v_mfma_f32_32x32x16_bf16 v[120:135], v[32:35], v[116:119], 0
    v_mul_f32 v152, v152, v160
    v_cvt_pk_bf16_f32 v152, v152, v152
    ds_write_b16 v5, v152 offset:18432
    v_exp_f32 v141, v141
    v_exp_f32 v142, v142
    v_exp_f32 v143, v143
    v_exp_f32 v144, v144
    v_exp_f32 v145, v145
    v_exp_f32 v146, v146
    v_smfmac_f32_32x32x32_bf16 v[168:183], v[72:75], v[136:143], v14
    v_exp_f32 v147, v147
    v_exp_f32 v148, v148
    v_exp_f32 v149, v149
    v_exp_f32 v150, v150
    v_exp_f32 v151, v151
    s_setprio 3
    s_waitcnt lgkmcnt(0)
    s_barrier
    v_exp_f32 v120, v120
    s_add_u32 s22, s33, 4
    s_and_b32 s22, s22, 7
    s_lshl_b32 s22, s22, 10
    s_add_u32 s22, s22, s21
    buffer_load_dwordx4 v[112:115], v2, s[12:15], s22 offen sc1
    v_exp_f32 v121, v121
    v_smfmac_f32_32x32x32_bf16 v[168:183], v[76:79], v[144:151], v14
    v_exp_f32 v122, v122
    ds_read_b128 v[232:235], v2 offset:18432
    v_exp_f32 v123, v123
    v_exp_f32 v124, v124
    v_mfma_f32_32x32x16_bf16 v[136:151], v[36:39], v[116:119], 0
    v_exp_f32 v125, v125
    v_exp_f32 v126, v126
    v_exp_f32 v127, v127
    v_exp_f32 v128, v128
    v_exp_f32 v129, v129
    v_exp_f32 v130, v130
    v_smfmac_f32_32x32x32_bf16 v[168:183], v[80:83], v[120:127], v14
    v_exp_f32 v131, v131
    v_exp_f32 v132, v132
    v_exp_f32 v133, v133
    s_waitcnt lgkmcnt(0)
    v_smfmac_f32_16x16x64_bf16 v[216:219], v[232:235], v[184:191], v15
    v_exp_f32 v134, v134
    v_exp_f32 v135, v135
    v_smfmac_f32_16x16x64_bf16 v[220:223], v[232:235], v[192:199], v15
    v_exp_f32 v136, v136
    v_exp_f32 v137, v137
    v_smfmac_f32_32x32x32_bf16 v[168:183], v[84:87], v[128:135], v14
    v_exp_f32 v138, v138
    v_exp_f32 v139, v139
    s_add_u32 s48, s33, 3
    s_and_b32 s48, s48, 7
    s_lshl_b32 s48, s48, 16
    s_add_u32 s48, s48, s27
    buffer_load_dwordx4 v[184:187], v2, s[12:15], s48 offen offset:0 sc1
    v_exp_f32 v140, v140
    v_mfma_f32_32x32x16_bf16 v[120:135], v[40:43], v[116:119], 0
    v_exp_f32 v141, v141
    v_exp_f32 v142, v142
    v_exp_f32 v143, v143
    s_waitcnt vmcnt(5)
    v_smfmac_f32_16x16x64_bf16 v[224:227], v[232:235], v[200:207], v15
    v_exp_f32 v144, v144
    v_exp_f32 v145, v145
    v_exp_f32 v146, v146
    v_smfmac_f32_32x32x32_bf16 v[168:183], v[88:91], v[136:143], v14
    v_exp_f32 v147, v147
    buffer_load_dwordx4 v[188:191], v2, s[12:15], s48 offen offset:1024 sc1
    v_exp_f32 v148, v148
    v_exp_f32 v149, v149
    s_waitcnt vmcnt(4)
    v_smfmac_f32_16x16x64_bf16 v[228:231], v[232:235], v[208:215], v15
    v_exp_f32 v150, v150
    v_exp_f32 v151, v151
    s_setprio 2
    v_exp_f32 v120, v120
    v_exp_f32 v121, v121
    v_smfmac_f32_32x32x32_bf16 v[168:183], v[92:95], v[144:151], v14
    v_exp_f32 v122, v122
    v_exp_f32 v123, v123
    buffer_load_dwordx4 v[192:195], v2, s[12:15], s48 offen offset:2048 sc1
    v_exp_f32 v124, v124
    v_mfma_f32_32x32x16_bf16 v[136:151], v[44:47], v[116:119], 0
    v_exp_f32 v125, v125
    v_exp_f32 v126, v126
    v_exp_f32 v127, v127
    v_exp_f32 v128, v128
    v_exp_f32 v129, v129
    v_exp_f32 v130, v130
    v_smfmac_f32_32x32x32_bf16 v[168:183], v[96:99], v[120:127], v14
    v_exp_f32 v131, v131
    v_exp_f32 v132, v132
    buffer_load_dwordx4 v[196:199], v2, s[12:15], s48 offen offset:3072 sc1
    v_exp_f32 v133, v133
    v_exp_f32 v134, v134
    v_exp_f32 v135, v135
    v_exp_f32 v136, v136
    v_exp_f32 v137, v137
    v_smfmac_f32_32x32x32_bf16 v[168:183], v[100:103], v[128:135], v14
    v_exp_f32 v138, v138
    v_exp_f32 v139, v139
    s_add_u32 s48, s48, 4096
    buffer_load_dwordx4 v[200:203], v2, s[12:15], s48 offen offset:0 sc1
    v_exp_f32 v140, v140
    s_waitcnt vmcnt(5)
    v_mfma_f32_32x32x16_bf16 v[120:135], v[16:19], v[112:115], 0
    v_exp_f32 v141, v141
    v_exp_f32 v142, v142
    v_exp_f32 v143, v143
    v_exp_f32 v144, v144
    v_exp_f32 v145, v145
    v_exp_f32 v146, v146
    v_smfmac_f32_32x32x32_bf16 v[168:183], v[104:107], v[136:143], v14
    v_exp_f32 v147, v147
    buffer_load_dwordx4 v[204:207], v2, s[12:15], s48 offen offset:1024 sc1
    v_exp_f32 v148, v148
    v_exp_f32 v149, v149
    s_waitcnt lgkmcnt(0)
    v_mfma_f32_32x32x16_bf16 v[152:167], v[236:239], v[236:239], 0
    v_exp_f32 v150, v150
    v_exp_f32 v151, v151
    s_setprio 1
    v_exp_f32 v120, v120
    v_exp_f32 v121, v121
    v_smfmac_f32_32x32x32_bf16 v[168:183], v[108:111], v[144:151], v14
    v_exp_f32 v122, v122
    buffer_load_dwordx4 v[208:211], v2, s[12:15], s48 offen offset:2048 sc1
    v_exp_f32 v123, v123
    v_exp_f32 v124, v124
    v_mfma_f32_32x32x16_bf16 v[136:151], v[20:23], v[112:115], 0
    v_exp_f32 v125, v125
    v_exp_f32 v126, v126
    v_exp_f32 v127, v127
    buffer_load_dwordx4 v[212:215], v2, s[12:15], s48 offen offset:3072 sc1
    v_exp_f32 v128, v128
    v_exp_f32 v129, v129
    v_exp_f32 v130, v130
    v_smfmac_f32_32x32x32_bf16 v[152:167], v[48:51], v[120:127], v14
    v_exp_f32 v131, v131
    v_exp_f32 v132, v132
    v_lshlrev_b32 v8, 5, v1
    v_and_b32 v8, 0x3e0, v8
    s_mov_b32 exec_hi, 0
    buffer_load_dword v9, v8, s[12:15], s45 offen sc1
    s_mov_b64 exec, -1
    v_exp_f32 v133, v133
    v_exp_f32 v134, v134
    ds_write2st64_b32 v7, v168, v169 offset0:0 offset1:1
    ds_write2st64_b32 v7, v170, v171 offset0:2 offset1:3
    ds_write2st64_b32 v7, v172, v173 offset0:4 offset1:5
    ds_write2st64_b32 v7, v174, v175 offset0:6 offset1:7
    ds_write_b32 v7, v176 offset:2048
    v_exp_f32 v135, v135
    s_setprio 0
    v_exp_f32 v136, v136
    v_exp_f32 v137, v137
    v_smfmac_f32_32x32x32_bf16 v[152:167], v[52:55], v[128:135], v14
    v_exp_f32 v138, v138
    v_exp_f32 v139, v139
    v_exp_f32 v140, v140
    v_mfma_f32_32x32x16_bf16 v[120:135], v[24:27], v[112:115], 0
    v_exp_f32 v141, v141
    v_exp_f32 v142, v142
    v_exp_f32 v143, v143
    v_exp_f32 v144, v144
    v_exp_f32 v145, v145
    v_exp_f32 v146, v146
    v_smfmac_f32_32x32x32_bf16 v[152:167], v[56:59], v[136:143], v14
    v_exp_f32 v147, v147
    v_exp_f32 v148, v148
    v_exp_f32 v149, v149
    v_exp_f32 v150, v150
    v_exp_f32 v151, v151
    s_setprio 3
    s_waitcnt lgkmcnt(0)
    s_barrier
    v_exp_f32 v120, v120
    ds_read2st64_b32 v[176:177], v4 offset0:8 offset1:17
    v_exp_f32 v121, v121
    v_smfmac_f32_32x32x32_bf16 v[152:167], v[60:63], v[144:151], v14
    v_exp_f32 v122, v122
    ds_read2st64_b32 v[178:179], v4 offset0:26 offset1:35
    v_exp_f32 v123, v123
    v_exp_f32 v124, v124
    v_mfma_f32_32x32x16_bf16 v[136:151], v[28:31], v[112:115], 0
    ds_read2st64_b32 v[180:181], v4 offset0:44 offset1:53
    v_exp_f32 v125, v125
    v_exp_f32 v126, v126
    ds_read2st64_b32 v[182:183], v4 offset0:62 offset1:71
    v_exp_f32 v127, v127
    v_exp_f32 v128, v128
    ds_read2st64_b32 v[168:169], v13 offset0:0 offset1:9
    v_exp_f32 v129, v129
    v_exp_f32 v130, v130
    v_smfmac_f32_32x32x32_bf16 v[152:167], v[64:67], v[120:127], v14
    ds_read2st64_b32 v[170:171], v13 offset0:18 offset1:27
    v_exp_f32 v131, v131
    v_exp_f32 v132, v132
    ds_read2st64_b32 v[172:173], v13 offset0:36 offset1:45
    v_exp_f32 v133, v133
    ds_read2st64_b32 v[174:175], v13 offset0:54 offset1:63
    v_exp_f32 v134, v134
    v_exp_f32 v135, v135
    s_setprio 2
    v_exp_f32 v136, v136
    v_exp_f32 v137, v137
    v_smfmac_f32_32x32x32_bf16 v[152:167], v[68:71], v[128:135], v14
    v_exp_f32 v138, v138
    v_exp_f32 v139, v139
    s_waitcnt lgkmcnt(0)
    v_pk_add_f32 v[176:177], v[176:177], v[178:179]
    v_pk_add_f32 v[180:181], v[180:181], v[182:183]
    v_pk_add_f32 v[168:169], v[168:169], v[170:171]
    v_pk_add_f32 v[172:173], v[172:173], v[174:175]
    v_pk_add_f32 v[176:177], v[176:177], v[180:181]
    v_pk_add_f32 v[168:169], v[168:169], v[172:173]
    v_add_f32 v176, v176, v177
    v_rcp_f32 v176, v176
    v_add_f32 v168, v168, v169
    v_exp_f32 v140, v140
    v_mfma_f32_32x32x16_bf16 v[120:135], v[32:35], v[112:115], 0
    v_mul_f32 v168, v168, v176
    v_cvt_pk_bf16_f32 v168, v168, v168
    ds_write_b16 v5, v168 offset:19456
    v_exp_f32 v141, v141
    v_exp_f32 v142, v142
    v_exp_f32 v143, v143
    v_exp_f32 v144, v144
    v_exp_f32 v145, v145
    v_exp_f32 v146, v146
    v_smfmac_f32_32x32x32_bf16 v[152:167], v[72:75], v[136:143], v14
    v_exp_f32 v147, v147
    s_waitcnt vmcnt(0)
    s_mov_b32 s54, 0
L_rc14:
    v_cmp_eq_u32 vcc, s92, v9
    s_cmp_eq_u32 vcc_lo, -1
    s_cbranch_scc1 L_rc14_ok
    s_add_u32 s54, s54, 1
    s_cmp_gt_u32 s54, 1048576
    s_cbranch_scc1 L_rc14_ok
    s_sleep 4
    buffer_load_dword v9, v8, s[12:15], s45 offen sc1
    s_waitcnt vmcnt(0)
    s_branch L_rc14
L_rc14_ok:
    v_exp_f32 v148, v148
    v_exp_f32 v149, v149
    v_exp_f32 v150, v150
    v_exp_f32 v151, v151
    s_setprio 3
    s_waitcnt lgkmcnt(0)
    s_barrier
    v_exp_f32 v120, v120
    s_add_u32 s22, s33, 5
    s_and_b32 s22, s22, 7
    s_lshl_b32 s22, s22, 10
    s_add_u32 s22, s22, s21
    buffer_load_dwordx4 v[116:119], v2, s[12:15], s22 offen sc1
    v_exp_f32 v121, v121
    v_smfmac_f32_32x32x32_bf16 v[152:167], v[76:79], v[144:151], v14
    v_exp_f32 v122, v122
    ds_read_b128 v[232:235], v2 offset:19456
    v_exp_f32 v123, v123
    v_lshrrev_b32 v8, 3, v1
    v_and_b32 v9, 28, v4
    v_lshl_add_u32 v8, v8, 13, v9
    buffer_load_dword v10, v8, s[12:15], s42 offen sc1
    v_exp_f32 v124, v124
    v_mfma_f32_32x32x16_bf16 v[136:151], v[36:39], v[112:115], 0
    v_exp_f32 v125, v125
    v_exp_f32 v126, v126
    s_add_u32 m0, s26, 0
    s_add_u32 s53, s24, 0
    buffer_load_dwordx4 v2, s[96:99], s53 offen sc1 lds
    v_exp_f32 v127, v127
    v_exp_f32 v128, v128
    v_exp_f32 v129, v129
    v_exp_f32 v130, v130
    v_smfmac_f32_32x32x32_bf16 v[152:167], v[80:83], v[120:127], v14
    s_add_u32 m0, s26, 1024
    s_add_u32 s53, s24, 1024
    buffer_load_dwordx4 v2, s[96:99], s53 offen sc1 lds
    v_exp_f32 v131, v131
    v_exp_f32 v132, v132
    v_exp_f32 v133, v133
    s_waitcnt lgkmcnt(0)
    v_smfmac_f32_16x16x64_bf16 v[216:219], v[232:235], v[184:191], v15
    v_exp_f32 v134, v134
    v_exp_f32 v135, v135
    v_smfmac_f32_16x16x64_bf16 v[220:223], v[232:235], v[192:199], v15
    v_exp_f32 v136, v136
    v_exp_f32 v137, v137
    v_smfmac_f32_32x32x32_bf16 v[152:167], v[84:87], v[128:135], v14
    v_exp_f32 v138, v138
    v_exp_f32 v139, v139
    s_add_u32 s48, s33, 4
    s_and_b32 s48, s48, 7
    s_lshl_b32 s48, s48, 16
    s_add_u32 s48, s48, s27
    buffer_load_dwordx4 v[184:187], v2, s[12:15], s48 offen offset:0 sc1
    v_exp_f32 v140, v140
    v_mfma_f32_32x32x16_bf16 v[120:135], v[40:43], v[112:115], 0
    v_exp_f32 v141, v141
    v_exp_f32 v142, v142
    v_exp_f32 v143, v143
    v_smfmac_f32_16x16x64_bf16 v[224:227], v[232:235], v[200:207], v15
    v_exp_f32 v144, v144
    v_exp_f32 v145, v145
    v_exp_f32 v146, v146
    v_smfmac_f32_32x32x32_bf16 v[152:167], v[88:91], v[136:143], v14
    v_exp_f32 v147, v147
    buffer_load_dwordx4 v[188:191], v2, s[12:15], s48 offen offset:1024 sc1
    v_exp_f32 v148, v148
    v_exp_f32 v149, v149
    v_smfmac_f32_16x16x64_bf16 v[228:231], v[232:235], v[208:215], v15
    v_exp_f32 v150, v150
    v_exp_f32 v151, v151
    s_setprio 2
    v_exp_f32 v120, v120
    v_exp_f32 v121, v121
    v_smfmac_f32_32x32x32_bf16 v[152:167], v[92:95], v[144:151], v14
    v_exp_f32 v122, v122
    v_exp_f32 v123, v123
    buffer_load_dwordx4 v[192:195], v2, s[12:15], s48 offen offset:2048 sc1
    v_exp_f32 v124, v124
    v_mfma_f32_32x32x16_bf16 v[136:151], v[44:47], v[112:115], 0
    v_exp_f32 v125, v125
    v_exp_f32 v126, v126
    v_exp_f32 v127, v127
    s_add_u32 m0, s26, 2048
    s_add_u32 s53, s24, 2048
    buffer_load_dwordx4 v2, s[96:99], s53 offen sc1 lds
    v_exp_f32 v128, v128
    v_exp_f32 v129, v129
    s_waitcnt vmcnt(6)
    s_cmp_lg_u32 s3, 0
    s_cbranch_scc1 L_mp15
    v_add_f32_dpp v10, v10, v10 row_ror:8 row_mask:0xf bank_mask:0xf
    s_lshr_b32 s53, s20, 6
    v_mov_b32 v11, v10
    s_cmp_eq_u32 s53, 2
    s_cselect_b32 s53, 1.0, 0
    v_permlane16_swap_b32 v10, v11
    v_add_f32 v10, v10, v11
    v_mov_b32 v11, v10
    s_nop 1
    v_permlane32_swap_b32 v10, v11
    v_add_f32 v10, v10, v11
    v_cvt_pk_bf16_f32 v10, v10, v10
    v_lshlrev_b32 v10, 16, v10
    v_add_f32 v10, s53, v10
    v_cvt_pk_bf16_f32 v10, v10, v10
    v_lshlrev_b32 v10, 16, v10
    v_mov_b32 v11, s92
    v_lshlrev_b32 v9, 1, v9
    s_mov_b64 exec, 0xff
    buffer_store_dwordx2 v[10:11], v9, s[12:15], s43 offen sc1
    s_mov_b64 exec, -1
L_mp15:
    v_exp_f32 v130, v130
    v_smfmac_f32_32x32x32_bf16 v[152:167], v[96:99], v[120:127], v14
    v_exp_f32 v131, v131
    v_exp_f32 v132, v132
    buffer_load_dwordx4 v[196:199], v2, s[12:15], s48 offen offset:3072 sc1
    v_exp_f32 v133, v133
    v_exp_f32 v134, v134
    v_exp_f32 v135, v135
    v_exp_f32 v136, v136
    v_exp_f32 v137, v137
    v_smfmac_f32_32x32x32_bf16 v[152:167], v[100:103], v[128:135], v14
    v_exp_f32 v138, v138
    v_exp_f32 v139, v139
    s_add_u32 s48, s48, 4096
    buffer_load_dwordx4 v[200:203], v2, s[12:15], s48 offen offset:0 sc1
    v_exp_f32 v140, v140
    v_mfma_f32_32x32x16_bf16 v[120:135], v[16:19], v[116:119], 0
    v_exp_f32 v141, v141
    v_exp_f32 v142, v142
    v_exp_f32 v143, v143
    s_add_u32 m0, s26, 3072
    s_add_u32 s53, s24, 3072
    buffer_load_dwordx4 v2, s[96:99], s53 offen sc1 lds
    v_exp_f32 v144, v144
    v_exp_f32 v145, v145
    v_exp_f32 v146, v146
    v_smfmac_f32_32x32x32_bf16 v[152:167], v[104:107], v[136:143], v14
    v_exp_f32 v147, v147
    buffer_load_dwordx4 v[204:207], v2, s[12:15], s48 offen offset:1024 sc1
    v_exp_f32 v148, v148
    v_exp_f32 v149, v149
    s_waitcnt lgkmcnt(0)
    v_mfma_f32_32x32x16_bf16 v[168:183], v[236:239], v[236:239], 0
    v_exp_f32 v150, v150
    v_exp_f32 v151, v151
    s_setprio 1
    v_exp_f32 v120, v120
    v_exp_f32 v121, v121
    v_smfmac_f32_32x32x32_bf16 v[152:167], v[108:111], v[144:151], v14
    v_exp_f32 v122, v122
    buffer_load_dwordx4 v[208:211], v2, s[12:15], s48 offen offset:2048 sc1
    v_exp_f32 v123, v123
    v_exp_f32 v124, v124
    v_mfma_f32_32x32x16_bf16 v[136:151], v[20:23], v[116:119], 0
    v_exp_f32 v125, v125
    v_exp_f32 v126, v126
    v_exp_f32 v127, v127
    buffer_load_dwordx4 v[212:215], v2, s[12:15], s48 offen offset:3072 sc1
    v_exp_f32 v128, v128
    v_exp_f32 v129, v129
    v_exp_f32 v130, v130
    v_smfmac_f32_32x32x32_bf16 v[168:183], v[48:51], v[120:127], v14
    s_add_u32 m0, s26, 4096
    s_add_u32 s53, s24, 4096
    buffer_load_dwordx4 v2, s[96:99], s53 offen sc1 lds
    v_exp_f32 v131, v131
    v_exp_f32 v132, v132
    v_lshlrev_b32 v8, 7, v1
    s_mov_b64 exec, 0xff
    buffer_load_dword v9, v8, s[12:15], s35 offen sc1
    s_mov_b64 exec, -1
    v_exp_f32 v133, v133
    v_exp_f32 v134, v134
    ds_write2st64_b32 v7, v152, v153 offset0:0 offset1:1
    ds_write2st64_b32 v7, v154, v155 offset0:2 offset1:3
    ds_write2st64_b32 v7, v156, v157 offset0:4 offset1:5
    ds_write2st64_b32 v7, v158, v159 offset0:6 offset1:7
    ds_write_b32 v7, v160 offset:2048
    v_exp_f32 v135, v135
    s_setprio 0
    v_exp_f32 v136, v136
    v_exp_f32 v137, v137
    v_smfmac_f32_32x32x32_bf16 v[168:183], v[52:55], v[128:135], v14
    v_exp_f32 v138, v138
    v_exp_f32 v139, v139
    v_exp_f32 v140, v140
    v_mfma_f32_32x32x16_bf16 v[120:135], v[24:27], v[116:119], 0
    v_exp_f32 v141, v141
    v_exp_f32 v142, v142
    v_exp_f32 v143, v143
    v_exp_f32 v144, v144
    v_exp_f32 v145, v145
    v_exp_f32 v146, v146
    v_smfmac_f32_32x32x32_bf16 v[168:183], v[56:59], v[136:143], v14
    v_exp_f32 v147, v147
    v_exp_f32 v148, v148
    v_exp_f32 v149, v149
    v_exp_f32 v150, v150
    v_exp_f32 v151, v151
    s_setprio 3
    s_waitcnt lgkmcnt(0)
    s_barrier
    v_exp_f32 v120, v120
    ds_read2st64_b32 v[160:161], v4 offset0:8 offset1:17
    v_exp_f32 v121, v121
    v_smfmac_f32_32x32x32_bf16 v[168:183], v[60:63], v[144:151], v14
    v_exp_f32 v122, v122
    ds_read2st64_b32 v[162:163], v4 offset0:26 offset1:35
    v_exp_f32 v123, v123
    v_exp_f32 v124, v124
    v_mfma_f32_32x32x16_bf16 v[136:151], v[28:31], v[116:119], 0
    ds_read2st64_b32 v[164:165], v4 offset0:44 offset1:53
    v_exp_f32 v125, v125
    v_exp_f32 v126, v126
    ds_read2st64_b32 v[166:167], v4 offset0:62 offset1:71
    v_exp_f32 v127, v127
    v_exp_f32 v128, v128
    ds_read2st64_b32 v[152:153], v13 offset0:0 offset1:9
    v_exp_f32 v129, v129
    v_exp_f32 v130, v130
    v_smfmac_f32_32x32x32_bf16 v[168:183], v[64:67], v[120:127], v14
    ds_read2st64_b32 v[154:155], v13 offset0:18 offset1:27
    v_exp_f32 v131, v131
    v_exp_f32 v132, v132
    ds_read2st64_b32 v[156:157], v13 offset0:36 offset1:45
    v_exp_f32 v133, v133
    ds_read2st64_b32 v[158:159], v13 offset0:54 offset1:63
    v_exp_f32 v134, v134
    v_exp_f32 v135, v135
    s_setprio 2
    v_exp_f32 v136, v136
    v_exp_f32 v137, v137
    v_smfmac_f32_32x32x32_bf16 v[168:183], v[68:71], v[128:135], v14
    v_exp_f32 v138, v138
    v_exp_f32 v139, v139
    s_waitcnt lgkmcnt(0)
    v_pk_add_f32 v[160:161], v[160:161], v[162:163]
    v_pk_add_f32 v[164:165], v[164:165], v[166:167]
    v_pk_add_f32 v[152:153], v[152:153], v[154:155]
    v_pk_add_f32 v[156:157], v[156:157], v[158:159]
    v_pk_add_f32 v[160:161], v[160:161], v[164:165]
    v_pk_add_f32 v[152:153], v[152:153], v[156:157]
    v_add_f32 v160, v160, v161
    v_rcp_f32 v160, v160
    v_add_f32 v152, v152, v153
    v_exp_f32 v140, v140
    v_mfma_f32_32x32x16_bf16 v[120:135], v[32:35], v[116:119], 0
    v_mul_f32 v152, v152, v160
    v_cvt_pk_bf16_f32 v152, v152, v152
    ds_write_b16 v5, v152 offset:18432
    v_exp_f32 v141, v141
    v_exp_f32 v142, v142
    v_exp_f32 v143, v143
    v_exp_f32 v144, v144
    v_exp_f32 v145, v145
    v_exp_f32 v146, v146
    v_smfmac_f32_32x32x32_bf16 v[168:183], v[72:75], v[136:143], v14
    v_exp_f32 v147, v147
    v_exp_f32 v148, v148
    v_exp_f32 v149, v149
    v_exp_f32 v150, v150
    v_exp_f32 v151, v151
    s_setprio 3
    s_waitcnt lgkmcnt(0)
    s_barrier
    v_exp_f32 v120, v120
    s_add_u32 s22, s33, 6
    s_and_b32 s22, s22, 7
    s_lshl_b32 s22, s22, 10
    s_add_u32 s22, s22, s21
    buffer_load_dwordx4 v[112:115], v2, s[12:15], s22 offen sc1
    v_exp_f32 v121, v121
    v_smfmac_f32_32x32x32_bf16 v[168:183], v[76:79], v[144:151], v14
    v_exp_f32 v122, v122
    ds_read_b128 v[232:235], v2 offset:18432
    v_exp_f32 v123, v123
    v_exp_f32 v124, v124
    v_mfma_f32_32x32x16_bf16 v[136:151], v[36:39], v[116:119], 0
    v_exp_f32 v125, v125
    v_exp_f32 v126, v126
    s_add_u32 m0, s26, 5120
    s_add_u32 s53, s24, 5120
    buffer_load_dwordx4 v2, s[96:99], s53 offen sc1 lds
    v_exp_f32 v127, v127
    v_exp_f32 v128, v128
    v_exp_f32 v129, v129
    v_exp_f32 v130, v130
    v_smfmac_f32_32x32x32_bf16 v[168:183], v[80:83], v[120:127], v14
    s_add_u32 m0, s26, 6144
    s_add_u32 s53, s24, 6144
    buffer_load_dwordx4 v2, s[96:99], s53 offen sc1 lds
    v_exp_f32 v131, v131
    v_exp_f32 v132, v132
    v_exp_f32 v133, v133
    s_waitcnt lgkmcnt(0)
    s_waitcnt vmcnt(13)
    v_smfmac_f32_16x16x64_bf16 v[216:219], v[232:235], v[184:191], v15
    v_exp_f32 v134, v134
    v_exp_f32 v135, v135
    s_waitcnt vmcnt(10)
    v_smfmac_f32_16x16x64_bf16 v[220:223], v[232:235], v[192:199], v15
    v_exp_f32 v136, v136
    v_exp_f32 v137, v137
    v_smfmac_f32_32x32x32_bf16 v[168:183], v[84:87], v[128:135], v14
    v_exp_f32 v138, v138
    v_exp_f32 v139, v139
    s_add_u32 s48, s33, 5
    s_and_b32 s48, s48, 7
    s_lshl_b32 s48, s48, 16
    s_add_u32 s48, s48, s27
    buffer_load_dwordx4 v[184:187], v2, s[12:15], s48 offen offset:0 sc1
    v_exp_f32 v140, v140
    v_mfma_f32_32x32x16_bf16 v[120:135], v[40:43], v[116:119], 0
    v_exp_f32 v141, v141
    v_exp_f32 v142, v142
    v_exp_f32 v143, v143
    s_waitcnt vmcnt(8)
    v_smfmac_f32_16x16x64_bf16 v[224:227], v[232:235], v[200:207], v15
    v_exp_f32 v144, v144
    v_exp_f32 v145, v145
    v_exp_f32 v146, v146
    v_smfmac_f32_32x32x32_bf16 v[168:183], v[88:91], v[136:143], v14
    v_exp_f32 v147, v147
    buffer_load_dwordx4 v[188:191], v2, s[12:15], s48 offen offset:1024 sc1
    v_exp_f32 v148, v148
    v_exp_f32 v149, v149
    s_waitcnt vmcnt(7)
    v_smfmac_f32_16x16x64_bf16 v[228:231], v[232:235], v[208:215], v15
    v_exp_f32 v150, v150
    v_exp_f32 v151, v151
    s_setprio 2
    v_exp_f32 v120, v120
    v_exp_f32 v121, v121
    v_smfmac_f32_32x32x32_bf16 v[168:183], v[92:95], v[144:151], v14
    v_exp_f32 v122, v122
    v_exp_f32 v123, v123
    buffer_load_dwordx4 v[192:195], v2, s[12:15], s48 offen offset:2048 sc1
    v_exp_f32 v124, v124
    v_mfma_f32_32x32x16_bf16 v[136:151], v[44:47], v[116:119], 0
    v_exp_f32 v125, v125
    v_exp_f32 v126, v126
    v_exp_f32 v127, v127
    s_add_u32 m0, s26, 7168
    s_add_u32 s53, s24, 7168
    buffer_load_dwordx4 v2, s[96:99], s53 offen sc1 lds
    v_exp_f32 v128, v128
    v_exp_f32 v129, v129
    v_exp_f32 v130, v130
    v_smfmac_f32_32x32x32_bf16 v[168:183], v[96:99], v[120:127], v14
    v_exp_f32 v131, v131
    v_exp_f32 v132, v132
    buffer_load_dwordx4 v[196:199], v2, s[12:15], s48 offen offset:3072 sc1
    v_exp_f32 v133, v133
    v_exp_f32 v134, v134
    v_exp_f32 v135, v135
    v_exp_f32 v136, v136
    v_exp_f32 v137, v137
    v_smfmac_f32_32x32x32_bf16 v[168:183], v[100:103], v[128:135], v14
    v_exp_f32 v138, v138
    v_exp_f32 v139, v139
    s_add_u32 s48, s48, 4096
    buffer_load_dwordx4 v[200:203], v2, s[12:15], s48 offen offset:0 sc1
    v_exp_f32 v140, v140
    s_waitcnt vmcnt(8)
    v_mfma_f32_32x32x16_bf16 v[120:135], v[16:19], v[112:115], 0
    v_exp_f32 v141, v141
    v_exp_f32 v142, v142
    v_exp_f32 v143, v143
    s_add_u32 m0, s26, 8192
    s_add_u32 s53, s24, 8192
    buffer_load_dwordx4 v2, s[96:99], s53 offen sc1 lds
    v_exp_f32 v144, v144
    v_exp_f32 v145, v145
    v_exp_f32 v146, v146
    v_smfmac_f32_32x32x32_bf16 v[168:183], v[104:107], v[136:143], v14
    v_exp_f32 v147, v147
    buffer_load_dwordx4 v[204:207], v2, s[12:15], s48 offen offset:1024 sc1
    v_exp_f32 v148, v148
    v_exp_f32 v149, v149
    s_waitcnt lgkmcnt(0)
    v_mfma_f32_32x32x16_bf16 v[152:167], v[236:239], v[236:239], 0
    v_exp_f32 v150, v150
    v_exp_f32 v151, v151
    s_setprio 1
    v_exp_f32 v120, v120
    v_exp_f32 v121, v121
    v_smfmac_f32_32x32x32_bf16 v[168:183], v[108:111], v[144:151], v14
    v_exp_f32 v122, v122
    buffer_load_dwordx4 v[208:211], v2, s[12:15], s48 offen offset:2048 sc1
    v_exp_f32 v123, v123
    v_exp_f32 v124, v124
    v_mfma_f32_32x32x16_bf16 v[136:151], v[20:23], v[112:115], 0
    v_exp_f32 v125, v125
    v_exp_f32 v126, v126
    v_exp_f32 v127, v127
    buffer_load_dwordx4 v[212:215], v2, s[12:15], s48 offen offset:3072 sc1
    v_exp_f32 v128, v128
    v_exp_f32 v129, v129
    v_exp_f32 v130, v130
    v_smfmac_f32_32x32x32_bf16 v[152:167], v[48:51], v[120:127], v14
    s_add_u32 m0, s26, 9216
    s_add_u32 s53, s24, 9216
    buffer_load_dwordx4 v2, s[96:99], s53 offen sc1 lds
    v_exp_f32 v131, v131
    v_exp_f32 v132, v132
    buffer_load_dwordx4 v[8:11], v2, s[12:15], s44 offen offset:0 sc1
    v_exp_f32 v133, v133
    v_exp_f32 v134, v134
    ds_write2st64_b32 v7, v168, v169 offset0:0 offset1:1
    ds_write2st64_b32 v7, v170, v171 offset0:2 offset1:3
    ds_write2st64_b32 v7, v172, v173 offset0:4 offset1:5
    ds_write2st64_b32 v7, v174, v175 offset0:6 offset1:7
    ds_write_b32 v7, v176 offset:2048
    v_exp_f32 v135, v135
    s_setprio 0
    v_exp_f32 v136, v136
    v_exp_f32 v137, v137
    v_smfmac_f32_32x32x32_bf16 v[152:167], v[52:55], v[128:135], v14
    v_exp_f32 v138, v138
    v_exp_f32 v139, v139
    v_exp_f32 v140, v140
    v_mfma_f32_32x32x16_bf16 v[120:135], v[24:27], v[112:115], 0
    v_exp_f32 v141, v141
    v_exp_f32 v142, v142
    v_exp_f32 v143, v143
    v_exp_f32 v144, v144
    v_exp_f32 v145, v145
    v_exp_f32 v146, v146
    v_smfmac_f32_32x32x32_bf16 v[152:167], v[56:59], v[136:143], v14
    v_exp_f32 v147, v147
    v_exp_f32 v148, v148
    v_exp_f32 v149, v149
    v_exp_f32 v150, v150
    v_exp_f32 v151, v151
    s_setprio 3
    s_waitcnt lgkmcnt(0)
    s_barrier
    v_exp_f32 v120, v120
    ds_read2st64_b32 v[176:177], v4 offset0:8 offset1:17
    v_exp_f32 v121, v121
    v_smfmac_f32_32x32x32_bf16 v[152:167], v[60:63], v[144:151], v14
    v_exp_f32 v122, v122
    ds_read2st64_b32 v[178:179], v4 offset0:26 offset1:35
    v_exp_f32 v123, v123
    v_exp_f32 v124, v124
    v_mfma_f32_32x32x16_bf16 v[136:151], v[28:31], v[112:115], 0
    ds_read2st64_b32 v[180:181], v4 offset0:44 offset1:53
    v_exp_f32 v125, v125
    v_exp_f32 v126, v126
    ds_read2st64_b32 v[182:183], v4 offset0:62 offset1:71
    v_exp_f32 v127, v127
    v_exp_f32 v128, v128
    ds_read2st64_b32 v[168:169], v13 offset0:0 offset1:9
    v_exp_f32 v129, v129
    v_exp_f32 v130, v130
    v_smfmac_f32_32x32x32_bf16 v[152:167], v[64:67], v[120:127], v14
    ds_read2st64_b32 v[170:171], v13 offset0:18 offset1:27
    v_exp_f32 v131, v131
    v_exp_f32 v132, v132
    ds_read2st64_b32 v[172:173], v13 offset0:36 offset1:45
    v_exp_f32 v133, v133
    ds_read2st64_b32 v[174:175], v13 offset0:54 offset1:63
    v_exp_f32 v134, v134
    v_exp_f32 v135, v135
    s_setprio 2
    v_exp_f32 v136, v136
    v_exp_f32 v137, v137
    v_smfmac_f32_32x32x32_bf16 v[152:167], v[68:71], v[128:135], v14
    v_exp_f32 v138, v138
    v_exp_f32 v139, v139
    s_waitcnt lgkmcnt(0)
    v_pk_add_f32 v[176:177], v[176:177], v[178:179]
    v_pk_add_f32 v[180:181], v[180:181], v[182:183]
    v_pk_add_f32 v[168:169], v[168:169], v[170:171]
    v_pk_add_f32 v[172:173], v[172:173], v[174:175]
    v_pk_add_f32 v[176:177], v[176:177], v[180:181]
    v_pk_add_f32 v[168:169], v[168:169], v[172:173]
    v_add_f32 v176, v176, v177
    v_rcp_f32 v176, v176
    v_add_f32 v168, v168, v169
    v_exp_f32 v140, v140
    v_mfma_f32_32x32x16_bf16 v[120:135], v[32:35], v[112:115], 0
    v_mul_f32 v168, v168, v176
    v_cvt_pk_bf16_f32 v168, v168, v168
    ds_write_b16 v5, v168 offset:19456
    v_exp_f32 v141, v141
    v_exp_f32 v142, v142
    v_exp_f32 v143, v143
    v_exp_f32 v144, v144
    v_exp_f32 v145, v145
    v_exp_f32 v146, v146
    v_smfmac_f32_32x32x32_bf16 v[152:167], v[72:75], v[136:143], v14
    v_exp_f32 v147, v147
    v_exp_f32 v148, v148
    v_exp_f32 v149, v149
    v_exp_f32 v150, v150
    v_exp_f32 v151, v151
    s_setprio 3
    s_waitcnt lgkmcnt(0)
    s_barrier
    v_exp_f32 v120, v120
    s_add_u32 s22, s33, 7
    s_and_b32 s22, s22, 7
    s_lshl_b32 s22, s22, 10
    s_add_u32 s22, s22, s21
    buffer_load_dwordx4 v[116:119], v2, s[12:15], s22 offen sc1
    v_exp_f32 v121, v121
    v_smfmac_f32_32x32x32_bf16 v[152:167], v[76:79], v[144:151], v14
    v_exp_f32 v122, v122
    ds_read_b128 v[232:235], v2 offset:19456
    v_exp_f32 v123, v123
    v_exp_f32 v124, v124
    v_mfma_f32_32x32x16_bf16 v[136:151], v[36:39], v[112:115], 0
    v_exp_f32 v125, v125
    v_exp_f32 v126, v126
    s_add_u32 m0, s26, 10240
    s_add_u32 s53, s24, 10240
    buffer_load_dwordx4 v2, s[96:99], s53 offen sc1 lds
    v_exp_f32 v127, v127
    v_exp_f32 v128, v128
    s_waitcnt vmcnt(2)
    s_mov_b32 s54, 0
L_rc16:
    v_cmp_eq_u32 vcc, s92, v9
    v_cmp_eq_u32 s[46:47], s92, v11
    s_and_b64 vcc, vcc, s[46:47]
    s_cmp_eq_u64 vcc, -1
    s_cbranch_scc1 L_rc16_ok
    s_add_u32 s54, s54, 1
    s_cmp_gt_u32 s54, 1048576
    s_cbranch_scc1 L_rc16_ok
    s_sleep 4
    buffer_load_dwordx4 v[8:11], v2, s[12:15], s44 offen offset:0 sc1
    s_waitcnt vmcnt(0)
    s_branch L_rc16
L_rc16_ok:
    s_lshl_b32 s53, s3, 10
    s_add_u32 s53, s53, 155648
    v_lshl_add_u32 v9, v1, 3, s53
    s_cmp_ge_u32 s3, 2
    s_cselect_b32 s53, 0x3fb8aa3b, 1.0
    s_cmp_ge_u32 s3, 6
    s_cselect_b32 s53, 0x3f317218, s53
    v_mul_f32 v8, s53, v8
    v_mul_f32 v10, s53, v10
    ds_write2_b32 v9, v8, v10 offset0:0 offset1:1
    v_exp_f32 v129, v129
    v_exp_f32 v130, v130
    v_smfmac_f32_32x32x32_bf16 v[152:167], v[80:83], v[120:127], v14
    s_add_u32 m0, s26, 11264
    s_add_u32 s53, s24, 11264
    buffer_load_dwordx4 v2, s[96:99], s53 offen sc1 lds
    v_exp_f32 v131, v131
    v_exp_f32 v132, v132
    v_exp_f32 v133, v133
    s_waitcnt lgkmcnt(1)
    v_smfmac_f32_16x16x64_bf16 v[216:219], v[232:235], v[184:191], v15
    v_exp_f32 v134, v134
    v_exp_f32 v135, v135
    v_smfmac_f32_16x16x64_bf16 v[220:223], v[232:235], v[192:199], v15
    v_exp_f32 v136, v136
    v_exp_f32 v137, v137
    v_smfmac_f32_32x32x32_bf16 v[152:167], v[84:87], v[128:135], v14
    v_exp_f32 v138, v138
    v_exp_f32 v139, v139
    s_add_u32 s48, s33, 6
    s_and_b32 s48, s48, 7
    s_lshl_b32 s48, s48, 16
    s_add_u32 s48, s48, s27
    buffer_load_dwordx4 v[184:187], v2, s[12:15], s48 offen offset:0 sc1
    v_exp_f32 v140, v140
    v_mfma_f32_32x32x16_bf16 v[120:135], v[40:43], v[112:115], 0
    v_exp_f32 v141, v141
    s_waitcnt lgkmcnt(0)
    buffer_load_dwordx4 v[8:11], v2, s[12:15], s44 offen offset:1024 sc1
    v_exp_f32 v142, v142
    v_exp_f32 v143, v143
    v_smfmac_f32_16x16x64_bf16 v[224:227], v[232:235], v[200:207], v15
    v_exp_f32 v144, v144
    v_exp_f32 v145, v145
    v_exp_f32 v146, v146
    v_smfmac_f32_32x32x32_bf16 v[152:167], v[88:91], v[136:143], v14
    v_exp_f32 v147, v147
    buffer_load_dwordx4 v[188:191], v2, s[12:15], s48 offen offset:1024 sc1
    v_exp_f32 v148, v148
    v_exp_f32 v149, v149
    v_smfmac_f32_16x16x64_bf16 v[228:231], v[232:235], v[208:215], v15
    v_exp_f32 v150, v150
    v_exp_f32 v151, v151
    s_setprio 2
    v_exp_f32 v120, v120
    v_exp_f32 v121, v121
    v_smfmac_f32_32x32x32_bf16 v[152:167], v[92:95], v[144:151], v14
    v_exp_f32 v122, v122
    v_exp_f32 v123, v123
    buffer_load_dwordx4 v[192:195], v2, s[12:15], s48 offen offset:2048 sc1
    v_exp_f32 v124, v124
    v_mfma_f32_32x32x16_bf16 v[136:151], v[44:47], v[112:115], 0
    v_exp_f32 v125, v125
    v_exp_f32 v126, v126
    v_exp_f32 v127, v127
    s_add_u32 m0, s101, 0
    s_add_u32 s53, s100, 0
    buffer_load_dwordx4 v2, s[12:15], s53 offen sc1 lds
    v_exp_f32 v128, v128
    v_exp_f32 v129, v129
    v_exp_f32 v130, v130
    v_smfmac_f32_32x32x32_bf16 v[152:167], v[96:99], v[120:127], v14
    v_exp_f32 v131, v131
    v_exp_f32 v132, v132
    buffer_load_dwordx4 v[196:199], v2, s[12:15], s48 offen offset:3072 sc1
    v_exp_f32 v133, v133
    v_exp_f32 v134, v134
    v_exp_f32 v135, v135
    v_exp_f32 v136, v136
    v_exp_f32 v137, v137
    v_smfmac_f32_32x32x32_bf16 v[152:167], v[100:103], v[128:135], v14
    v_exp_f32 v138, v138
    v_exp_f32 v139, v139
    s_add_u32 s48, s48, 4096
    buffer_load_dwordx4 v[200:203], v2, s[12:15], s48 offen offset:0 sc1
    v_exp_f32 v140, v140
    s_waitcnt vmcnt(9)
    v_mfma_f32_32x32x16_bf16 v[120:135], v[16:19], v[116:119], 0
    v_exp_f32 v141, v141
    v_exp_f32 v142, v142
    v_exp_f32 v143, v143
    s_add_u32 m0, s101, 1024
    s_add_u32 s53, s100, 1024
    buffer_load_dwordx4 v2, s[12:15], s53 offen sc1 lds
    v_exp_f32 v144, v144
    v_exp_f32 v145, v145
    v_exp_f32 v146, v146
    v_smfmac_f32_32x32x32_bf16 v[152:167], v[104:107], v[136:143], v14
    v_exp_f32 v147, v147
    buffer_load_dwordx4 v[204:207], v2, s[12:15], s48 offen offset:1024 sc1
    v_exp_f32 v148, v148
    v_exp_f32 v149, v149
    s_waitcnt lgkmcnt(0)
    v_mfma_f32_32x32x16_bf16 v[168:183], v[236:239], v[236:239], 0
    v_exp_f32 v150, v150
    v_exp_f32 v151, v151
    s_setprio 1
    v_exp_f32 v120, v120
    v_exp_f32 v121, v121
    v_smfmac_f32_32x32x32_bf16 v[152:167], v[108:111], v[144:151], v14
    v_exp_f32 v122, v122
    buffer_load_dwordx4 v[208:211], v2, s[12:15], s48 offen offset:2048 sc1
    v_exp_f32 v123, v123
    v_exp_f32 v124, v124
    v_mfma_f32_32x32x16_bf16 v[136:151], v[20:23], v[116:119], 0
    s_waitcnt vmcnt(8)
    s_mov_b32 s54, 0
L_rc17:
    v_cmp_eq_u32 vcc, s92, v9
    v_cmp_eq_u32 s[46:47], s92, v11
    s_and_b64 vcc, vcc, s[46:47]
    s_cmp_eq_u64 vcc, -1
    s_cbranch_scc1 L_rc17_ok
    s_add_u32 s54, s54, 1
    s_cmp_gt_u32 s54, 1048576
    s_cbranch_scc1 L_rc17_ok
    s_sleep 4
    buffer_load_dwordx4 v[8:11], v2, s[12:15], s44 offen offset:1024 sc1
    s_waitcnt vmcnt(0)
    s_branch L_rc17
L_rc17_ok:
    s_lshl_b32 s53, s3, 10
    s_add_u32 s53, s53, 156160
    v_lshl_add_u32 v9, v1, 3, s53
    s_cmp_ge_u32 s3, 2
    s_cselect_b32 s53, 0x3fb8aa3b, 1.0
    s_cmp_ge_u32 s3, 6
    s_cselect_b32 s53, 0x3f317218, s53
    v_mul_f32 v8, s53, v8
    v_mul_f32 v10, s53, v10
    ds_write2_b32 v9, v8, v10 offset0:0 offset1:1
    v_exp_f32 v125, v125
    v_exp_f32 v126, v126
    v_exp_f32 v127, v127
    buffer_load_dwordx4 v[212:215], v2, s[12:15], s48 offen offset:3072 sc1
    v_exp_f32 v128, v128
    v_exp_f32 v129, v129
    v_exp_f32 v130, v130
    v_smfmac_f32_32x32x32_bf16 v[168:183], v[48:51], v[120:127], v14
    s_add_u32 m0, s101, 2048
    s_add_u32 s53, s100, 2048
    buffer_load_dwordx4 v2, s[12:15], s53 offen sc1 lds
    v_exp_f32 v131, v131
    v_exp_f32 v132, v132
    v_exp_f32 v133, v133
    s_waitcnt lgkmcnt(0)
    buffer_load_dwordx4 v[8:11], v3, s[8:11], s30 offen
    v_lshrrev_b32 v6, 3, v1
    s_add_u32 s53, s50, 155648
    v_lshl_add_u32 v6, v6, 5, s53
    v_exp_f32 v134, v134
    ds_write2st64_b32 v7, v152, v153 offset0:0 offset1:1
    ds_write2st64_b32 v7, v154, v155 offset0:2 offset1:3
    ds_write2st64_b32 v7, v156, v157 offset0:4 offset1:5
    ds_write2st64_b32 v7, v158, v159 offset0:6 offset1:7
    ds_write_b32 v7, v160 offset:2048
    v_exp_f32 v135, v135
    s_setprio 0
    v_exp_f32 v136, v136
    v_exp_f32 v137, v137
    v_smfmac_f32_32x32x32_bf16 v[168:183], v[52:55], v[128:135], v14
    v_exp_f32 v138, v138
    v_exp_f32 v139, v139
    v_exp_f32 v140, v140
    v_mfma_f32_32x32x16_bf16 v[120:135], v[24:27], v[116:119], 0
    v_exp_f32 v141, v141
    v_exp_f32 v142, v142
    v_exp_f32 v143, v143
    v_exp_f32 v144, v144
    v_exp_f32 v145, v145
    v_exp_f32 v146, v146
    v_smfmac_f32_32x32x32_bf16 v[168:183], v[56:59], v[136:143], v14
    v_exp_f32 v147, v147
    v_exp_f32 v148, v148
    v_exp_f32 v149, v149
    v_exp_f32 v150, v150
    v_exp_f32 v151, v151
    s_setprio 3
    s_waitcnt lgkmcnt(0)
    s_barrier
    v_exp_f32 v120, v120
    ds_read2st64_b32 v[160:161], v4 offset0:8 offset1:17
    v_exp_f32 v121, v121
    v_smfmac_f32_32x32x32_bf16 v[168:183], v[60:63], v[144:151], v14
    v_exp_f32 v122, v122
    ds_read2st64_b32 v[162:163], v4 offset0:26 offset1:35
    v_exp_f32 v123, v123
    v_exp_f32 v124, v124
    v_mfma_f32_32x32x16_bf16 v[136:151], v[28:31], v[116:119], 0
    ds_read2st64_b32 v[164:165], v4 offset0:44 offset1:53
    v_exp_f32 v125, v125
    v_exp_f32 v126, v126
    ds_read2st64_b32 v[166:167], v4 offset0:62 offset1:71
    v_exp_f32 v127, v127
    v_exp_f32 v128, v128
    ds_read2st64_b32 v[152:153], v13 offset0:0 offset1:9
    v_exp_f32 v129, v129
    v_exp_f32 v130, v130
    v_smfmac_f32_32x32x32_bf16 v[168:183], v[64:67], v[120:127], v14
    ds_read2st64_b32 v[154:155], v13 offset0:18 offset1:27
    v_exp_f32 v131, v131
    v_exp_f32 v132, v132
    ds_read2st64_b32 v[156:157], v13 offset0:36 offset1:45
    v_exp_f32 v133, v133
    ds_read2st64_b32 v[158:159], v13 offset0:54 offset1:63
    v_exp_f32 v134, v134
    v_exp_f32 v135, v135
    s_setprio 2
    v_exp_f32 v136, v136
    v_exp_f32 v137, v137
    v_smfmac_f32_32x32x32_bf16 v[168:183], v[68:71], v[128:135], v14
    v_exp_f32 v138, v138
    v_exp_f32 v139, v139
    s_waitcnt lgkmcnt(0)
    v_pk_add_f32 v[160:161], v[160:161], v[162:163]
    v_pk_add_f32 v[164:165], v[164:165], v[166:167]
    v_pk_add_f32 v[152:153], v[152:153], v[154:155]
    v_pk_add_f32 v[156:157], v[156:157], v[158:159]
    v_pk_add_f32 v[160:161], v[160:161], v[164:165]
    v_pk_add_f32 v[152:153], v[152:153], v[156:157]
    v_add_f32 v160, v160, v161
    v_rcp_f32 v160, v160
    v_add_f32 v152, v152, v153
    v_exp_f32 v140, v140
    v_mfma_f32_32x32x16_bf16 v[120:135], v[32:35], v[116:119], 0
    v_mul_f32 v152, v152, v160
    v_cvt_pk_bf16_f32 v152, v152, v152
    ds_write_b16 v5, v152 offset:18432
    v_exp_f32 v141, v141
    v_exp_f32 v142, v142
    v_exp_f32 v143, v143
    v_exp_f32 v144, v144
    v_exp_f32 v145, v145
    v_exp_f32 v146, v146
    v_smfmac_f32_32x32x32_bf16 v[168:183], v[72:75], v[136:143], v14
    v_exp_f32 v147, v147
    v_exp_f32 v148, v148
    v_exp_f32 v149, v149
    v_exp_f32 v150, v150
    v_exp_f32 v151, v151
    s_setprio 3
    s_waitcnt lgkmcnt(0)
    s_barrier
    v_exp_f32 v120, v120
    v_exp_f32 v121, v121
    v_smfmac_f32_32x32x32_bf16 v[168:183], v[76:79], v[144:151], v14
    v_exp_f32 v122, v122
    ds_read_b128 v[232:235], v2 offset:18432
    v_exp_f32 v123, v123
    v_exp_f32 v124, v124
    v_mfma_f32_32x32x16_bf16 v[136:151], v[36:39], v[116:119], 0
    v_exp_f32 v125, v125
    v_exp_f32 v126, v126
    s_add_u32 m0, s101, 3072
    s_add_u32 s53, s100, 3072
    buffer_load_dwordx4 v2, s[12:15], s53 offen sc1 lds
    v_exp_f32 v127, v127
    v_exp_f32 v128, v128
    v_exp_f32 v129, v129
    v_exp_f32 v130, v130
    v_smfmac_f32_32x32x32_bf16 v[168:183], v[80:83], v[120:127], v14
    v_exp_f32 v131, v131
    v_exp_f32 v132, v132
    v_exp_f32 v133, v133
    s_waitcnt lgkmcnt(0)
    s_waitcnt vmcnt(11)
    v_smfmac_f32_16x16x64_bf16 v[216:219], v[232:235], v[184:191], v15
    v_exp_f32 v134, v134
    v_exp_f32 v135, v135
    s_setprio 2
    s_waitcnt vmcnt(8)
    v_smfmac_f32_16x16x64_bf16 v[220:223], v[232:235], v[192:199], v15
    v_exp_f32 v136, v136
    v_exp_f32 v137, v137
    v_smfmac_f32_32x32x32_bf16 v[168:183], v[84:87], v[128:135], v14
    v_exp_f32 v138, v138
    s_add_u32 s48, s33, 7
    s_and_b32 s48, s48, 7
    s_lshl_b32 s48, s48, 16
    s_add_u32 s48, s48, s27
    buffer_load_dwordx4 v[184:187], v2, s[12:15], s48 offen offset:0 sc1
    v_exp_f32 v139, v139
    v_exp_f32 v140, v140
    v_mfma_f32_32x32x16_bf16 v[120:135], v[40:43], v[116:119], 0
    v_exp_f32 v141, v141
    buffer_load_dwordx4 v[188:191], v2, s[12:15], s48 offen offset:1024 sc1
    v_exp_f32 v142, v142
    v_exp_f32 v143, v143
    s_waitcnt vmcnt(7)
    v_smfmac_f32_16x16x64_bf16 v[224:227], v[232:235], v[200:207], v15
    v_exp_f32 v144, v144
    v_exp_f32 v145, v145
    buffer_load_dwordx4 v[192:195], v2, s[12:15], s48 offen offset:2048 sc1
    v_exp_f32 v146, v146
    v_smfmac_f32_32x32x32_bf16 v[168:183], v[88:91], v[136:143], v14
    v_exp_f32 v147, v147
    v_exp_f32 v148, v148
    buffer_load_dwordx4 v[196:199], v2, s[12:15], s48 offen offset:3072 sc1
    v_exp_f32 v149, v149
    s_waitcnt vmcnt(7)
    v_smfmac_f32_16x16x64_bf16 v[228:231], v[232:235], v[208:215], v15
    v_exp_f32 v150, v150
    v_exp_f32 v151, v151
    s_setprio 1
    ds_read_b128 v[152:155], v6 offset:0
    v_exp_f32 v120, v120
    s_add_u32 s48, s48, 4096
    buffer_load_dwordx4 v[200:203], v2, s[12:15], s48 offen offset:0 sc1
    v_exp_f32 v121, v121
    v_smfmac_f32_32x32x32_bf16 v[168:183], v[92:95], v[144:151], v14
    v_exp_f32 v122, v122
    ds_read_b128 v[156:159], v6 offset:16
    v_exp_f32 v123, v123
    buffer_load_dwordx4 v[204:207], v2, s[12:15], s48 offen offset:1024 sc1
    v_exp_f32 v124, v124
    v_mfma_f32_32x32x16_bf16 v[136:151], v[44:47], v[116:119], 0
    v_exp_f32 v125, v125
    ds_read_b128 v[160:163], v6 offset:2048
    v_exp_f32 v126, v126
    v_exp_f32 v127, v127
    buffer_load_dwordx4 v[208:211], v2, s[12:15], s48 offen offset:2048 sc1
    v_exp_f32 v128, v128
    ds_read_b128 v[164:167], v6 offset:2064
    v_exp_f32 v129, v129
    v_exp_f32 v130, v130
    v_smfmac_f32_32x32x32_bf16 v[168:183], v[96:99], v[120:127], v14
    v_exp_f32 v131, v131
    ds_read_b128 v[112:115], v6 offset:4096
    v_exp_f32 v132, v132
    buffer_load_dwordx4 v[212:215], v2, s[12:15], s48 offen offset:3072 sc1
    v_exp_f32 v133, v133
    ds_read_b128 v[236:239], v6 offset:4112
    v_exp_f32 v134, v134
    v_exp_f32 v135, v135
    s_setprio 0
    v_exp_f32 v136, v136
    v_exp_f32 v137, v137
    v_smfmac_f32_32x32x32_bf16 v[168:183], v[100:103], v[128:135], v14
    v_exp_f32 v138, v138
    v_exp_f32 v139, v139
    v_exp_f32 v140, v140
    v_exp_f32 v141, v141
    v_exp_f32 v142, v142
    v_exp_f32 v143, v143
    v_exp_f32 v144, v144
    v_exp_f32 v145, v145
    v_exp_f32 v146, v146
    v_smfmac_f32_32x32x32_bf16 v[168:183], v[104:107], v[136:143], v14
    v_exp_f32 v147, v147
    v_exp_f32 v148, v148
    v_exp_f32 v149, v149
    v_exp_f32 v150, v150
    v_exp_f32 v151, v151
    s_nop 1
    v_smfmac_f32_32x32x32_bf16 v[168:183], v[108:111], v[144:151], v14
L_kb_tail:
    v_and_b32 v12, 15, v0
    v_lshlrev_b32 v12, 2, v12
    v_bfe_u32 v6, v0, 4, 2
    v_mul_u32_u24 v6, 576, v6
    s_mul_i32 s51, s3, 2304
    v_add3_u32 v12, v12, v6, s51
    s_nop 5
    ds_write2st64_b32 v7, v168, v169 offset0:0 offset1:1
    ds_write2st64_b32 v7, v170, v171 offset0:2 offset1:3
    ds_write2st64_b32 v7, v172, v173 offset0:4 offset1:5
    ds_write2st64_b32 v7, v174, v175 offset0:6 offset1:7
    ds_write_b32 v7, v176 offset:2048
    v_not_b32 v6, s92
    v_and_b32 v14, 12, v4
    ds_write_b32 v14, v6 offset:22016
    s_waitcnt vmcnt(0)
    s_cmp_lt_u32 s3, 4
    s_cbranch_scc1 L_ew18
    s_add_u32 s53, s49, 0
    buffer_load_dwordx4 v[16:19], v2, s[12:15], s53 offen sc1
    s_add_u32 s53, s49, 1024
    buffer_load_dwordx4 v[20:23], v2, s[12:15], s53 offen sc1
    s_add_u32 s53, s49, 2048
    buffer_load_dwordx4 v[24:27], v2, s[12:15], s53 offen sc1
    s_add_u32 s53, s49, 3072
    buffer_load_dwordx4 v[28:31], v2, s[12:15], s53 offen sc1
L_ew18:
    s_waitcnt lgkmcnt(0)
    s_barrier
    ds_read2st64_b32 v[176:177], v4 offset0:8 offset1:17
    ds_read2st64_b32 v[178:179], v4 offset0:26 offset1:35
    ds_read2st64_b32 v[180:181], v4 offset0:44 offset1:53
    ds_read2st64_b32 v[182:183], v4 offset0:62 offset1:71
    ds_read2st64_b32 v[168:169], v13 offset0:0 offset1:9
    ds_read2st64_b32 v[170:171], v13 offset0:18 offset1:27
    ds_read2st64_b32 v[172:173], v13 offset0:36 offset1:45
    ds_read2st64_b32 v[174:175], v13 offset0:54 offset1:63
    s_cmp_lt_u32 s3, 4
    s_cbranch_scc1 L_ew19
    s_add_u32 s53, s49, 4096
    buffer_load_dwordx4 v[32:35], v2, s[12:15], s53 offen sc1
    s_add_u32 s53, s49, 5120
    buffer_load_dwordx4 v[36:39], v2, s[12:15], s53 offen sc1
    s_add_u32 s53, s49, 6144
    buffer_load_dwordx4 v[40:43], v2, s[12:15], s53 offen sc1
    s_add_u32 s53, s49, 7168
    buffer_load_dwordx4 v[44:47], v2, s[12:15], s53 offen sc1
L_ew19:
    v_and_b32 v14, 7, v1
    v_mul_u32_u24 v6, 288, v14
    v_lshrrev_b32 v7, 3, v1
    v_lshl_add_u32 v6, v7, 5, v6
    v_add_u32 v6, s51, v6
    s_waitcnt lgkmcnt(0)
    v_pk_add_f32 v[176:177], v[176:177], v[178:179]
    v_pk_add_f32 v[180:181], v[180:181], v[182:183]
    v_pk_add_f32 v[168:169], v[168:169], v[170:171]
    v_pk_add_f32 v[172:173], v[172:173], v[174:175]
    v_pk_add_f32 v[176:177], v[176:177], v[180:181]
    v_pk_add_f32 v[168:169], v[168:169], v[172:173]
    v_add_f32 v176, v176, v177
    v_rcp_f32 v176, v176
    v_add_f32 v168, v168, v169
    v_mul_f32 v168, v168, v176
    v_cvt_pk_bf16_f32 v168, v168, v168
    ds_write_b16 v5, v168 offset:19456
    s_cmp_lt_u32 s3, 4
    s_cbranch_scc1 L_ew20
    s_add_u32 s53, s49, 8192
    buffer_load_dwordx4 v[48:51], v2, s[12:15], s53 offen sc1
    s_add_u32 s53, s49, 9216
    buffer_load_dwordx4 v[52:55], v2, s[12:15], s53 offen sc1
    s_add_u32 s53, s49, 10240
    buffer_load_dwordx4 v[56:59], v2, s[12:15], s53 offen sc1
L_ew20:
    s_waitcnt lgkmcnt(0)
    s_barrier
    ds_read_b128 v[232:235], v2 offset:19456
    s_cmp_lt_u32 s3, 4
    s_cbranch_scc1 L_ew21
    s_add_u32 s53, s49, 11264
    buffer_load_dwordx4 v[60:63], v2, s[12:15], s53 offen sc1
    s_add_u32 s53, s49, 12288
    buffer_load_dwordx4 v[64:67], v2, s[12:15], s53 offen sc1
    s_add_u32 s53, s49, 13312
    buffer_load_dwordx4 v[68:71], v2, s[12:15], s53 offen sc1
L_ew21:
    v_lshlrev_b32 v128, 16, v8
    v_and_b32 v129, 0xffff0000, v8
    v_lshlrev_b32 v130, 16, v9
    v_and_b32 v131, 0xffff0000, v9
    v_lshlrev_b32 v132, 16, v10
    v_and_b32 v133, 0xffff0000, v10
    v_lshlrev_b32 v134, 16, v11
    v_and_b32 v135, 0xffff0000, v11
    s_waitcnt lgkmcnt(0)
    v_smfmac_f32_16x16x64_bf16 v[216:219], v[232:235], v[184:191], v15
    v_smfmac_f32_16x16x64_bf16 v[220:223], v[232:235], v[192:199], v15
    v_smfmac_f32_16x16x64_bf16 v[224:227], v[232:235], v[200:207], v15
    v_smfmac_f32_16x16x64_bf16 v[228:231], v[232:235], v[208:215], v15
    v_lshlrev_b32 v14, 6, v14
    s_lshl_b32 s53, s3, 3
    v_add_u32 v13, s53, v14
    s_nop 1
    v_add_f32 v216, v216, v217
    v_add_f32 v218, v218, v219
    ds_write2_b32 v12, v216, v218 offset0:0 offset1:72
    v_add_f32 v220, v220, v221
    v_add_f32 v222, v222, v223
    ds_write2_b32 v12, v220, v222 offset0:16 offset1:88
    v_add_f32 v224, v224, v225
    v_add_f32 v226, v226, v227
    ds_write2_b32 v12, v224, v226 offset0:32 offset1:104
    v_add_f32 v228, v228, v229
    v_add_f32 v230, v230, v231
    ds_write2_b32 v12, v228, v230 offset0:48 offset1:120
    s_waitcnt lgkmcnt(0)
    ds_read_b128 v[120:123], v6 offset:0
    ds_read_b128 v[124:127], v6 offset:16
    s_waitcnt lgkmcnt(0)
    v_pk_fma_f32 v[120:121], v[120:121], v[152:153], v[128:129]
    v_pk_fma_f32 v[122:123], v[122:123], v[154:155], v[130:131]
    v_pk_fma_f32 v[124:125], v[124:125], v[156:157], v[132:133]
    v_pk_fma_f32 v[126:127], v[126:127], v[158:159], v[134:135]
    v_cvt_pk_bf16_f32 v8, v120, v121
    v_cvt_pk_bf16_f32 v9, v122, v123
    v_cvt_pk_bf16_f32 v10, v124, v125
    v_cvt_pk_bf16_f32 v11, v126, v127
    buffer_store_dwordx4 v[8:11], v3, s[12:15], s38 offen sc1
    v_mov_b32 v15, 0x3f803f80
    v_dot2_f32_bf16 v6, v8, v15, 0
    v_dot2_f32_bf16 v7, v8, v8, 0
    v_dot2_f32_bf16 v6, v9, v15, v6
    v_dot2_f32_bf16 v7, v9, v9, v7
    v_dot2_f32_bf16 v6, v10, v15, v6
    v_dot2_f32_bf16 v7, v10, v10, v7
    v_dot2_f32_bf16 v6, v11, v15, v6
    v_dot2_f32_bf16 v7, v11, v11, v7
    v_lshlrev_b32 v120, 16, v8
    v_and_b32 v121, 0xffff0000, v8
    v_lshlrev_b32 v122, 16, v9
    v_and_b32 v123, 0xffff0000, v9
    v_add_f32_dpp v6, v6, v6 row_ror:8 row_mask:0xf bank_mask:0xf
    v_add_f32_dpp v7, v7, v7 row_ror:8 row_mask:0xf bank_mask:0xf
    v_lshlrev_b32 v124, 16, v10
    v_and_b32 v125, 0xffff0000, v10
    v_lshlrev_b32 v126, 16, v11
    v_and_b32 v127, 0xffff0000, v11
    v_permlane16_swap_b32 v6, v7
    v_add_f32 v6, v6, v7
    v_mov_b32 v7, v6
    v_bfe_u32 v15, v0, 4, 1
    v_lshl_add_u32 v13, v15, 2, v13
    v_permlane32_swap_b32 v6, v7
    v_add_f32 v6, v6, v7
    ds_write_b32 v13, v6 offset:21504
    s_waitcnt lgkmcnt(0)
    s_barrier
    ds_read_b128 v[216:219], v14 offset:21504
    ds_read_b128 v[220:223], v14 offset:21520
    ds_read_b128 v[224:227], v14 offset:21536
    ds_read_b128 v[228:231], v14 offset:21552
    s_lshl_b32 s54, s20, 5
    s_lshl_b32 s53, s3, 2
    s_add_u32 s54, s54, s53
    s_add_u32 s54, s54, 40960
    s_waitcnt lgkmcnt(0)
    v_pk_add_f32 v[216:217], v[216:217], v[218:219]
    v_pk_add_f32 v[220:221], v[220:221], v[222:223]
    v_pk_add_f32 v[224:225], v[224:225], v[226:227]
    v_pk_add_f32 v[228:229], v[228:229], v[230:231]
    v_pk_add_f32 v[216:217], v[216:217], v[220:221]
    v_pk_add_f32 v[224:225], v[224:225], v[228:229]
    v_pk_add_f32 v[216:217], v[216:217], v[224:225]
    v_mul_f32 v216, 0x3b000000, v216
    v_mul_f32 v217, 0x3b000000, v217
    v_fma_f32 v217, -v216, v216, v217
    v_max_f32 v217, 0, v217
    v_cvt_pk_bf16_f32 v217, v217, v216
    v_and_b32 v216, 0xffff0000, v217
    v_lshlrev_b32 v217, 16, v217
    v_add_f32 v217, 0x3727c5ac, v217
    v_cvt_pk_bf16_f32 v217, v217, v217
    v_lshlrev_b32 v217, 16, v217
    v_sqrt_f32 v217, v217
    s_nop 0
    v_cvt_pk_bf16_f32 v217, v217, v217
    v_lshlrev_b32 v217, 16, v217
    v_rcp_f32 v217, v217
    s_nop 0
    v_mul_f32 v216, -v216, v217
    v_pk_fma_f32 v[120:121], v[120:121], v[216:217], v[216:217] op_sel:[0,1,0] op_sel_hi:[1,1,0]
    v_pk_fma_f32 v[122:123], v[122:123], v[216:217], v[216:217] op_sel:[0,1,0] op_sel_hi:[1,1,0]
    v_pk_fma_f32 v[124:125], v[124:125], v[216:217], v[216:217] op_sel:[0,1,0] op_sel_hi:[1,1,0]
    v_pk_fma_f32 v[126:127], v[126:127], v[216:217], v[216:217] op_sel:[0,1,0] op_sel_hi:[1,1,0]
    v_pk_fma_f32 v[120:121], v[120:121], v[112:113], v[160:161]
    v_pk_fma_f32 v[122:123], v[122:123], v[114:115], v[162:163]
    v_pk_fma_f32 v[124:125], v[124:125], v[236:237], v[164:165]
    v_pk_fma_f32 v[126:127], v[126:127], v[238:239], v[166:167]
    v_cvt_pk_bf16_f32 v128, v120, v121
    v_cvt_pk_bf16_f32 v129, v122, v123
    v_cvt_pk_bf16_f32 v130, v124, v125
    v_cvt_pk_bf16_f32 v131, v126, v127
    v_mov_b32 v6, s92
    v_mov_b32 v7, 0
    s_cmp_eq_u32 s55, 0
    s_cbranch_scc1 L_kb_h2wt
    buffer_store_dwordx4 v[128:131], v2, s[12:15], s35 offen
    s_waitcnt vmcnt(0)
    s_mov_b64 exec, 1
    buffer_store_dword v6, v7, s[12:15], s54 offen
    s_mov_b64 exec, -1
    s_branch L_kb_h2done
L_kb_h2wt:
    buffer_store_dwordx4 v[128:131], v2, s[12:15], s35 offen sc1
    s_waitcnt vmcnt(0)
    s_mov_b64 exec, 1
    buffer_store_dword v6, v7, s[12:15], s54 offen sc1
    s_mov_b64 exec, -1
L_kb_h2done:
    s_cmp_ge_u32 s3, 4
    s_cbranch_scc1 L_kb_p5
    s_lshl_b32 s53, s3, 2
    v_mov_b32 v10, s53
    v_mov_b32 v11, s92
    s_cmp_ge_u32 s29, 30
    s_cbranch_scc1 L_kb_nop4
    s_cmp_ge_u32 s29, 15
    s_cselect_b32 s33, 4, 0
    s_cselect_b32 s34, 15, 0
    s_sub_u32 s34, s29, s34
    s_lshl_b32 s35, s28, 3
    s_add_u32 s33, s33, s35
    s_add_u32 s33, s33, s3
    s_lshl_b32 s35, s33, 7
    s_add_u32 s35, s35, 40960
    s_lshl_b32 s36, s33, 15
    s_add_u32 s36, s36, 4194304
    s_mul_i32 s37, s33, 88064
    s_mul_i32 s38, s34, 6144
    s_add_u32 s37, s37, s38
    s_add_u32 s37, s37, 8388608
    s_lshl_b32 s38, s33, 6
    s_lshl_b32 s39, s34, 2
    s_add_u32 s38, s38, s39
    s_add_u32 s38, s38, 49152
    s_mov_b32 s40, 0xbfb8aa3b
    s_mov_b32 s41, s40
    s_mov_b32 s42, -1
    v_add_u32 v3, 22528, v2
    v_add_u32 v5, 88064, v2
    v_bfe_u32 v8, v1, 3, 2
    v_lshlrev_b32 v8, 13, v8
    v_bfe_u32 v9, v1, 5, 1
    v_lshl_add_u32 v8, v9, 7, v8
    v_and_b32 v9, 7, v1
    v_lshl_add_u32 v8, v9, 4, v8
    ds_read_b128 v[192:195], v3 offset:0
    ds_read_b128 v[196:199], v3 offset:32768
    ds_read_b128 v[200:203], v3 offset:1024
    ds_read_b128 v[204:207], v3 offset:33792
    ds_read_b128 v[208:211], v5 offset:0
    ds_read_b128 v[212:215], v3 offset:2048
    ds_read_b128 v[216:219], v3 offset:34816
    s_lshl_b32 s43, s34, 9
    v_and_b32 v6, 0x7c, v4
    s_mov_b32 s53, 0
L_kb_poll1:
    buffer_load_dword v7, v6, s[12:15], s35 offen sc1
    s_add_u32 s53, s53, 1
    s_waitcnt vmcnt(0)
    v_cmp_eq_u32 vcc, s92, v7
    s_cmp_gt_u32 s53, 1048576
    s_cbranch_scc1 L_kb_poll1_out
    s_and_b32 s32, vcc_lo, s42
    s_cmp_eq_u32 s32, s42
    s_cbranch_scc0 L_kb_poll1
L_kb_poll1_out:
    buffer_load_dwordx4 v[16:19], v8, s[12:15], s36 offen offset:0 sc1
    buffer_load_dwordx4 v[20:23], v8, s[12:15], s36 offen offset:256 sc1
    buffer_load_dwordx4 v[24:27], v8, s[12:15], s36 offen offset:512 sc1
    buffer_load_dwordx4 v[28:31], v8, s[12:15], s36 offen offset:768 sc1
    buffer_load_dwordx4 v[32:35], v8, s[12:15], s36 offen offset:1024 sc1
    buffer_load_dwordx4 v[36:39], v8, s[12:15], s36 offen offset:1280 sc1
    buffer_load_dwordx4 v[40:43], v8, s[12:15], s36 offen offset:1536 sc1
    buffer_load_dwordx4 v[44:47], v8, s[12:15], s36 offen offset:1792 sc1
    s_waitcnt vmcnt(7)
    s_waitcnt lgkmcnt(6)
    v_mfma_f32_32x32x16_bf16 v[144:159], v[192:195], v[16:19], 0
    ds_read_b128 v[220:223], v3 offset:3072
    buffer_load_dwordx4 v[48:51], v8, s[12:15], s36 offen offset:2048 sc1
    s_waitcnt lgkmcnt(6)
    v_mfma_f32_32x32x16_bf16 v[160:175], v[196:199], v[16:19], 0
    ds_read_b128 v[192:195], v3 offset:35840
    s_waitcnt vmcnt(7)
    s_waitcnt lgkmcnt(6)
    v_mfma_f32_32x32x16_bf16 v[144:159], v[200:203], v[20:23], v[144:159]
    ds_read_b128 v[196:199], v5 offset:1024
    buffer_load_dwordx4 v[52:55], v8, s[12:15], s36 offen offset:2304 sc1
    s_waitcnt lgkmcnt(6)
    v_mfma_f32_32x32x16_bf16 v[160:175], v[204:207], v[20:23], v[160:175]
    ds_read_b128 v[200:203], v3 offset:4096
    s_waitcnt lgkmcnt(6)
    v_mfma_f32_32x32x16_bf16 v[176:191], v[208:211], v[16:19], 0
    ds_read_b128 v[204:207], v3 offset:36864
    s_waitcnt vmcnt(7)
    s_waitcnt lgkmcnt(6)
    v_mfma_f32_32x32x16_bf16 v[144:159], v[212:215], v[24:27], v[144:159]
    ds_read_b128 v[208:211], v3 offset:5120
    buffer_load_dwordx4 v[56:59], v8, s[12:15], s36 offen offset:2560 sc1
    s_waitcnt lgkmcnt(6)
    v_mfma_f32_32x32x16_bf16 v[160:175], v[216:219], v[24:27], v[160:175]
    ds_read_b128 v[212:215], v3 offset:37888
    s_waitcnt vmcnt(7)
    s_waitcnt lgkmcnt(6)
    v_mfma_f32_32x32x16_bf16 v[144:159], v[220:223], v[28:31], v[144:159]
    ds_read_b128 v[216:219], v5 offset:2048
    buffer_load_dwordx4 v[60:63], v8, s[12:15], s36 offen offset:2816 sc1
    s_waitcnt lgkmcnt(6)
    v_mfma_f32_32x32x16_bf16 v[160:175], v[192:195], v[28:31], v[160:175]
    ds_read_b128 v[220:223], v3 offset:6144
    s_waitcnt lgkmcnt(6)
    v_mfma_f32_32x32x16_bf16 v[176:191], v[196:199], v[20:23], v[176:191]
    ds_read_b128 v[192:195], v3 offset:38912
    s_waitcnt vmcnt(7)
    s_waitcnt lgkmcnt(6)
    v_mfma_f32_32x32x16_bf16 v[144:159], v[200:203], v[32:35], v[144:159]
    ds_read_b128 v[196:199], v3 offset:7168
    buffer_load_dwordx4 v[64:67], v8, s[12:15], s36 offen offset:3072 sc1
    s_waitcnt lgkmcnt(6)
    v_mfma_f32_32x32x16_bf16 v[160:175], v[204:207], v[32:35], v[160:175]
    ds_read_b128 v[200:203], v3 offset:39936
    s_waitcnt vmcnt(7)
    s_waitcnt lgkmcnt(6)
    v_mfma_f32_32x32x16_bf16 v[144:159], v[208:211], v[36:39], v[144:159]
    ds_read_b128 v[204:207], v5 offset:3072
    buffer_load_dwordx4 v[68:71], v8, s[12:15], s36 offen offset:3328 sc1
    s_waitcnt lgkmcnt(6)
    v_mfma_f32_32x32x16_bf16 v[160:175], v[212:215], v[36:39], v[160:175]
    ds_read_b128 v[208:211], v3 offset:8192
    s_waitcnt lgkmcnt(6)
    v_mfma_f32_32x32x16_bf16 v[176:191], v[216:219], v[24:27], v[176:191]
    ds_read_b128 v[212:215], v3 offset:40960
    s_waitcnt vmcnt(7)
    s_waitcnt lgkmcnt(6)
    v_mfma_f32_32x32x16_bf16 v[144:159], v[220:223], v[40:43], v[144:159]
    ds_read_b128 v[216:219], v3 offset:9216
    buffer_load_dwordx4 v[72:75], v8, s[12:15], s36 offen offset:3584 sc1
    s_waitcnt lgkmcnt(6)
    v_mfma_f32_32x32x16_bf16 v[160:175], v[192:195], v[40:43], v[160:175]
    ds_read_b128 v[220:223], v3 offset:41984
    s_waitcnt vmcnt(7)
    s_waitcnt lgkmcnt(6)
    v_mfma_f32_32x32x16_bf16 v[144:159], v[196:199], v[44:47], v[144:159]
    ds_read_b128 v[192:195], v5 offset:4096
    buffer_load_dwordx4 v[76:79], v8, s[12:15], s36 offen offset:3840 sc1
    s_waitcnt lgkmcnt(6)
    v_mfma_f32_32x32x16_bf16 v[160:175], v[200:203], v[44:47], v[160:175]
    ds_read_b128 v[196:199], v3 offset:10240
    s_waitcnt lgkmcnt(6)
    v_mfma_f32_32x32x16_bf16 v[176:191], v[204:207], v[28:31], v[176:191]
    ds_read_b128 v[200:203], v3 offset:43008
    s_waitcnt vmcnt(7)
    s_waitcnt lgkmcnt(6)
    v_mfma_f32_32x32x16_bf16 v[144:159], v[208:211], v[48:51], v[144:159]
    ds_read_b128 v[204:207], v3 offset:11264
    s_add_u32 s36, s36, 4096
    buffer_load_dwordx4 v[80:83], v8, s[12:15], s36 offen offset:0 sc1
    s_waitcnt lgkmcnt(6)
    v_mfma_f32_32x32x16_bf16 v[160:175], v[212:215], v[48:51], v[160:175]
    ds_read_b128 v[208:211], v3 offset:44032
    s_waitcnt vmcnt(7)
    s_waitcnt lgkmcnt(6)
    v_mfma_f32_32x32x16_bf16 v[144:159], v[216:219], v[52:55], v[144:159]
    ds_read_b128 v[212:215], v5 offset:5120
    buffer_load_dwordx4 v[84:87], v8, s[12:15], s36 offen offset:256 sc1
    s_waitcnt lgkmcnt(6)
    v_mfma_f32_32x32x16_bf16 v[160:175], v[220:223], v[52:55], v[160:175]
    ds_read_b128 v[216:219], v3 offset:12288
    s_waitcnt lgkmcnt(6)
    v_mfma_f32_32x32x16_bf16 v[176:191], v[192:195], v[32:35], v[176:191]
    ds_read_b128 v[220:223], v3 offset:45056
    s_waitcnt vmcnt(7)
    s_waitcnt lgkmcnt(6)
    v_mfma_f32_32x32x16_bf16 v[144:159], v[196:199], v[56:59], v[144:159]
    ds_read_b128 v[192:195], v3 offset:13312
    buffer_load_dwordx4 v[88:91], v8, s[12:15], s36 offen offset:512 sc1
    s_waitcnt lgkmcnt(6)
    v_mfma_f32_32x32x16_bf16 v[160:175], v[200:203], v[56:59], v[160:175]
    ds_read_b128 v[196:199], v3 offset:46080
    s_waitcnt vmcnt(7)
    s_waitcnt lgkmcnt(6)
    v_mfma_f32_32x32x16_bf16 v[144:159], v[204:207], v[60:63], v[144:159]
    ds_read_b128 v[200:203], v5 offset:6144
    buffer_load_dwordx4 v[92:95], v8, s[12:15], s36 offen offset:768 sc1
    s_waitcnt lgkmcnt(6)
    v_mfma_f32_32x32x16_bf16 v[160:175], v[208:211], v[60:63], v[160:175]
    ds_read_b128 v[204:207], v3 offset:14336
    s_waitcnt lgkmcnt(6)
    v_mfma_f32_32x32x16_bf16 v[176:191], v[212:215], v[36:39], v[176:191]
    ds_read_b128 v[208:211], v3 offset:47104
    s_waitcnt vmcnt(7)
    s_waitcnt lgkmcnt(6)
    v_mfma_f32_32x32x16_bf16 v[144:159], v[216:219], v[64:67], v[144:159]
    ds_read_b128 v[212:215], v3 offset:15360
    buffer_load_dwordx4 v[96:99], v8, s[12:15], s36 offen offset:1024 sc1
    s_waitcnt lgkmcnt(6)
    v_mfma_f32_32x32x16_bf16 v[160:175], v[220:223], v[64:67], v[160:175]
    ds_read_b128 v[216:219], v3 offset:48128
    s_waitcnt vmcnt(7)
    s_waitcnt lgkmcnt(6)
    v_mfma_f32_32x32x16_bf16 v[144:159], v[192:195], v[68:71], v[144:159]
    ds_read_b128 v[220:223], v5 offset:7168
    buffer_load_dwordx4 v[100:103], v8, s[12:15], s36 offen offset:1280 sc1
    s_waitcnt lgkmcnt(6)
    v_mfma_f32_32x32x16_bf16 v[160:175], v[196:199], v[68:71], v[160:175]
    ds_read_b128 v[192:195], v3 offset:16384
    s_waitcnt lgkmcnt(6)
    v_mfma_f32_32x32x16_bf16 v[176:191], v[200:203], v[40:43], v[176:191]
    ds_read_b128 v[196:199], v3 offset:49152
    s_waitcnt vmcnt(7)
    s_waitcnt lgkmcnt(6)
    v_mfma_f32_32x32x16_bf16 v[144:159], v[204:207], v[72:75], v[144:159]
    ds_read_b128 v[200:203], v3 offset:17408
    buffer_load_dwordx4 v[104:107], v8, s[12:15], s36 offen offset:1536 sc1
    s_waitcnt lgkmcnt(6)
    v_mfma_f32_32x32x16_bf16 v[160:175], v[208:211], v[72:75], v[160:175]
    ds_read_b128 v[204:207], v3 offset:50176
    s_waitcnt vmcnt(7)
    s_waitcnt lgkmcnt(6)
    v_mfma_f32_32x32x16_bf16 v[144:159], v[212:215], v[76:79], v[144:159]
    ds_read_b128 v[208:211], v5 offset:8192
    buffer_load_dwordx4 v[108:111], v8, s[12:15], s36 offen offset:1792 sc1
    s_waitcnt lgkmcnt(6)
    v_mfma_f32_32x32x16_bf16 v[160:175], v[216:219], v[76:79], v[160:175]
    ds_read_b128 v[212:215], v3 offset:18432
    s_waitcnt lgkmcnt(6)
    v_mfma_f32_32x32x16_bf16 v[176:191], v[220:223], v[44:47], v[176:191]
    ds_read_b128 v[216:219], v3 offset:51200
    s_waitcnt vmcnt(7)
    s_waitcnt lgkmcnt(6)
    v_mfma_f32_32x32x16_bf16 v[144:159], v[192:195], v[80:83], v[144:159]
    ds_read_b128 v[220:223], v3 offset:19456
    buffer_load_dwordx4 v[112:115], v8, s[12:15], s36 offen offset:2048 sc1
    s_waitcnt lgkmcnt(6)
    v_mfma_f32_32x32x16_bf16 v[160:175], v[196:199], v[80:83], v[160:175]
    ds_read_b128 v[192:195], v3 offset:52224
    s_waitcnt vmcnt(7)
    s_waitcnt lgkmcnt(6)
    v_mfma_f32_32x32x16_bf16 v[144:159], v[200:203], v[84:87], v[144:159]
    ds_read_b128 v[196:199], v5 offset:9216
    buffer_load_dwordx4 v[116:119], v8, s[12:15], s36 offen offset:2304 sc1
    s_waitcnt lgkmcnt(6)
    v_mfma_f32_32x32x16_bf16 v[160:175], v[204:207], v[84:87], v[160:175]
    ds_read_b128 v[200:203], v3 offset:20480
    s_waitcnt lgkmcnt(6)
    v_mfma_f32_32x32x16_bf16 v[176:191], v[208:211], v[48:51], v[176:191]
    ds_read_b128 v[204:207], v3 offset:53248
    s_waitcnt vmcnt(7)
    s_waitcnt lgkmcnt(6)
    v_mfma_f32_32x32x16_bf16 v[144:159], v[212:215], v[88:91], v[144:159]
    ds_read_b128 v[208:211], v3 offset:21504
    buffer_load_dwordx4 v[120:123], v8, s[12:15], s36 offen offset:2560 sc1
    s_waitcnt lgkmcnt(6)
    v_mfma_f32_32x32x16_bf16 v[160:175], v[216:219], v[88:91], v[160:175]
    ds_read_b128 v[212:215], v3 offset:54272
    s_waitcnt vmcnt(7)
    s_waitcnt lgkmcnt(6)
    v_mfma_f32_32x32x16_bf16 v[144:159], v[220:223], v[92:95], v[144:159]
    ds_read_b128 v[216:219], v5 offset:10240
    buffer_load_dwordx4 v[124:127], v8, s[12:15], s36 offen offset:2816 sc1
    s_waitcnt lgkmcnt(6)
    v_mfma_f32_32x32x16_bf16 v[160:175], v[192:195], v[92:95], v[160:175]
    ds_read_b128 v[220:223], v3 offset:22528
    s_waitcnt lgkmcnt(6)
    v_mfma_f32_32x32x16_bf16 v[176:191], v[196:199], v[52:55], v[176:191]
    ds_read_b128 v[192:195], v3 offset:55296
    s_waitcnt vmcnt(7)
    s_waitcnt lgkmcnt(6)
    v_mfma_f32_32x32x16_bf16 v[144:159], v[200:203], v[96:99], v[144:159]
    ds_read_b128 v[196:199], v3 offset:23552
    buffer_load_dwordx4 v[128:131], v8, s[12:15], s36 offen offset:3072 sc1
    s_waitcnt lgkmcnt(6)
    v_mfma_f32_32x32x16_bf16 v[160:175], v[204:207], v[96:99], v[160:175]
    ds_read_b128 v[200:203], v3 offset:56320
    s_waitcnt vmcnt(7)
    s_waitcnt lgkmcnt(6)
    v_mfma_f32_32x32x16_bf16 v[144:159], v[208:211], v[100:103], v[144:159]
    ds_read_b128 v[204:207], v5 offset:11264
    buffer_load_dwordx4 v[132:135], v8, s[12:15], s36 offen offset:3328 sc1
    s_waitcnt lgkmcnt(6)
    v_mfma_f32_32x32x16_bf16 v[160:175], v[212:215], v[100:103], v[160:175]
    ds_read_b128 v[208:211], v3 offset:24576
    s_waitcnt lgkmcnt(6)
    v_mfma_f32_32x32x16_bf16 v[176:191], v[216:219], v[56:59], v[176:191]
    ds_read_b128 v[212:215], v3 offset:57344
    s_waitcnt vmcnt(7)
    s_waitcnt lgkmcnt(6)
    v_mfma_f32_32x32x16_bf16 v[144:159], v[220:223], v[104:107], v[144:159]
    ds_read_b128 v[216:219], v3 offset:25600
    buffer_load_dwordx4 v[136:139], v8, s[12:15], s36 offen offset:3584 sc1
    s_waitcnt lgkmcnt(6)
    v_mfma_f32_32x32x16_bf16 v[160:175], v[192:195], v[104:107], v[160:175]
    ds_read_b128 v[220:223], v3 offset:58368
    s_waitcnt vmcnt(7)
    s_waitcnt lgkmcnt(6)
    v_mfma_f32_32x32x16_bf16 v[144:159], v[196:199], v[108:111], v[144:159]
    ds_read_b128 v[192:195], v5 offset:12288
    buffer_load_dwordx4 v[140:143], v8, s[12:15], s36 offen offset:3840 sc1
    ds_write_b32 v10, v11 offset:22016
    s_waitcnt lgkmcnt(7)
    v_mfma_f32_32x32x16_bf16 v[160:175], v[200:203], v[108:111], v[160:175]
    ds_read_b128 v[196:199], v3 offset:26624
    s_waitcnt lgkmcnt(7)
    v_mfma_f32_32x32x16_bf16 v[176:191], v[204:207], v[60:63], v[176:191]
    ds_read_b128 v[200:203], v3 offset:59392
    s_waitcnt vmcnt(7)
    s_waitcnt lgkmcnt(7)
    v_mfma_f32_32x32x16_bf16 v[144:159], v[208:211], v[112:115], v[144:159]
    ds_read_b128 v[204:207], v3 offset:27648
    s_waitcnt lgkmcnt(7)
    v_mfma_f32_32x32x16_bf16 v[160:175], v[212:215], v[112:115], v[160:175]
    ds_read_b128 v[208:211], v3 offset:60416
    s_waitcnt vmcnt(6)
    s_waitcnt lgkmcnt(7)
    v_mfma_f32_32x32x16_bf16 v[144:159], v[216:219], v[116:119], v[144:159]
    ds_read_b128 v[212:215], v5 offset:13312
    s_waitcnt lgkmcnt(7)
    v_mfma_f32_32x32x16_bf16 v[160:175], v[220:223], v[116:119], v[160:175]
    ds_read_b128 v[216:219], v3 offset:28672
    s_waitcnt lgkmcnt(7)
    v_mfma_f32_32x32x16_bf16 v[176:191], v[192:195], v[64:67], v[176:191]
    ds_read_b128 v[220:223], v3 offset:61440
    s_waitcnt vmcnt(5)
    s_waitcnt lgkmcnt(6)
    v_mfma_f32_32x32x16_bf16 v[144:159], v[196:199], v[120:123], v[144:159]
    ds_read_b128 v[192:195], v3 offset:29696
    s_waitcnt lgkmcnt(6)
    v_mfma_f32_32x32x16_bf16 v[160:175], v[200:203], v[120:123], v[160:175]
    ds_read_b128 v[196:199], v3 offset:62464
    s_waitcnt vmcnt(4)
    s_waitcnt lgkmcnt(6)
    v_mfma_f32_32x32x16_bf16 v[144:159], v[204:207], v[124:127], v[144:159]
    ds_read_b128 v[200:203], v5 offset:14336
    s_waitcnt lgkmcnt(6)
    v_mfma_f32_32x32x16_bf16 v[160:175], v[208:211], v[124:127], v[160:175]
    ds_read_b128 v[204:207], v3 offset:30720
    s_waitcnt lgkmcnt(6)
    v_mfma_f32_32x32x16_bf16 v[176:191], v[212:215], v[68:71], v[176:191]
    ds_read_b128 v[208:211], v3 offset:63488
    s_waitcnt vmcnt(3)
    s_waitcnt lgkmcnt(6)
    v_mfma_f32_32x32x16_bf16 v[144:159], v[216:219], v[128:131], v[144:159]
    ds_read_b128 v[212:215], v3 offset:31744
    s_waitcnt lgkmcnt(6)
    v_mfma_f32_32x32x16_bf16 v[160:175], v[220:223], v[128:131], v[160:175]
    ds_read_b128 v[216:219], v3 offset:64512
    s_waitcnt vmcnt(2)
    s_waitcnt lgkmcnt(6)
    v_mfma_f32_32x32x16_bf16 v[144:159], v[192:195], v[132:135], v[144:159]
    ds_read_b128 v[220:223], v5 offset:15360
    s_waitcnt lgkmcnt(6)
    v_mfma_f32_32x32x16_bf16 v[160:175], v[196:199], v[132:135], v[160:175]
    ds_read_b128 v[192:195], v5 offset:16384
    s_waitcnt lgkmcnt(6)
    v_mfma_f32_32x32x16_bf16 v[176:191], v[200:203], v[72:75], v[176:191]
    ds_read_b128 v[196:199], v5 offset:17408
    s_waitcnt vmcnt(1)
    s_waitcnt lgkmcnt(6)
    v_mfma_f32_32x32x16_bf16 v[144:159], v[204:207], v[136:139], v[144:159]
    ds_read_b128 v[200:203], v5 offset:18432
    s_waitcnt lgkmcnt(6)
    v_mfma_f32_32x32x16_bf16 v[160:175], v[208:211], v[136:139], v[160:175]
    ds_read_b128 v[204:207], v5 offset:19456
    s_waitcnt vmcnt(0)
    s_waitcnt lgkmcnt(6)
    v_mfma_f32_32x32x16_bf16 v[144:159], v[212:215], v[140:143], v[144:159]
    ds_read_b128 v[208:211], v5 offset:20480
    s_waitcnt lgkmcnt(6)
    v_mfma_f32_32x32x16_bf16 v[160:175], v[216:219], v[140:143], v[160:175]
    ds_read_b128 v[212:215], v5 offset:21504
    s_waitcnt lgkmcnt(6)
    v_mfma_f32_32x32x16_bf16 v[176:191], v[220:223], v[76:79], v[176:191]
    ds_read_b128 v[216:219], v5 offset:22528
    s_waitcnt lgkmcnt(6)
    v_mfma_f32_32x32x16_bf16 v[176:191], v[192:195], v[80:83], v[176:191]
    ds_read_b128 v[220:223], v5 offset:23552
    s_waitcnt lgkmcnt(6)
    v_mfma_f32_32x32x16_bf16 v[176:191], v[196:199], v[84:87], v[176:191]
    ds_read_b128 v[192:195], v5 offset:24576
    s_waitcnt lgkmcnt(6)
    v_mfma_f32_32x32x16_bf16 v[176:191], v[200:203], v[88:91], v[176:191]
    ds_read_b128 v[196:199], v5 offset:25600
    v_exp_f32_e64 v224, -v144
    v_exp_f32_e64 v225, -v145
    v_exp_f32_e64 v226, -v146
    s_waitcnt lgkmcnt(6)
    v_mfma_f32_32x32x16_bf16 v[176:191], v[204:207], v[92:95], v[176:191]
    ds_read_b128 v[200:203], v5 offset:26624
    v_exp_f32_e64 v227, -v147
    v_exp_f32_e64 v228, -v148
    v_exp_f32_e64 v229, -v149
    s_waitcnt lgkmcnt(6)
    v_mfma_f32_32x32x16_bf16 v[176:191], v[208:211], v[96:99], v[176:191]
    ds_read_b128 v[204:207], v5 offset:27648
    v_exp_f32_e64 v230, -v150
    v_exp_f32_e64 v231, -v151
    v_add_f32 v224, 1.0, v224
    v_add_f32 v225, 1.0, v225
    s_waitcnt lgkmcnt(6)
    v_mfma_f32_32x32x16_bf16 v[176:191], v[212:215], v[100:103], v[176:191]
    ds_read_b128 v[208:211], v5 offset:28672
    v_add_f32 v226, 1.0, v226
    v_add_f32 v227, 1.0, v227
    v_add_f32 v228, 1.0, v228
    v_add_f32 v229, 1.0, v229
    v_add_f32 v230, 1.0, v230
    v_add_f32 v231, 1.0, v231
    s_waitcnt lgkmcnt(6)
    v_mfma_f32_32x32x16_bf16 v[176:191], v[216:219], v[104:107], v[176:191]
    ds_read_b128 v[212:215], v5 offset:29696
    v_rcp_f32 v224, v224
    v_rcp_f32 v225, v225
    v_rcp_f32 v226, v226
    s_waitcnt lgkmcnt(6)
    v_mfma_f32_32x32x16_bf16 v[176:191], v[220:223], v[108:111], v[176:191]
    ds_read_b128 v[216:219], v5 offset:30720
    v_rcp_f32 v227, v227
    v_rcp_f32 v228, v228
    v_rcp_f32 v229, v229
    s_waitcnt lgkmcnt(6)
    v_mfma_f32_32x32x16_bf16 v[176:191], v[192:195], v[112:115], v[176:191]
    ds_read_b128 v[220:223], v5 offset:31744
    v_rcp_f32 v230, v230
    v_rcp_f32 v231, v231
    v_mul_f32 v224, v224, v144
    v_mul_f32 v225, v225, v145
    s_waitcnt lgkmcnt(6)
    v_mfma_f32_32x32x16_bf16 v[176:191], v[196:199], v[116:119], v[176:191]
    v_mul_f32 v226, v226, v146
    v_mul_f32 v227, v227, v147
    v_mul_f32 v228, v228, v148
    v_mul_f32 v229, v229, v149
    v_mul_f32 v230, v230, v150
    v_mul_f32 v231, v231, v151
    s_waitcnt lgkmcnt(5)
    v_mfma_f32_32x32x16_bf16 v[176:191], v[200:203], v[120:123], v[176:191]
    v_cvt_pk_bf16_f32 v144, v224, v225
    v_cvt_pk_bf16_f32 v145, v226, v227
    v_cvt_pk_bf16_f32 v146, v228, v229
    v_cvt_pk_bf16_f32 v147, v230, v231
    buffer_store_dwordx4 v[144:147], v2, s[12:15], s37 offen offset:0 sc1
    v_exp_f32_e64 v232, -v152
    s_waitcnt lgkmcnt(4)
    v_mfma_f32_32x32x16_bf16 v[176:191], v[204:207], v[124:127], v[176:191]
    v_exp_f32_e64 v233, -v153
    v_exp_f32_e64 v234, -v154
    v_exp_f32_e64 v235, -v155
    s_waitcnt lgkmcnt(3)
    v_mfma_f32_32x32x16_bf16 v[176:191], v[208:211], v[128:131], v[176:191]
    v_exp_f32_e64 v236, -v156
    v_exp_f32_e64 v237, -v157
    v_exp_f32_e64 v238, -v158
    s_waitcnt lgkmcnt(2)
    v_mfma_f32_32x32x16_bf16 v[176:191], v[212:215], v[132:135], v[176:191]
    v_exp_f32_e64 v239, -v159
    v_add_f32 v232, 1.0, v232
    v_add_f32 v233, 1.0, v233
    v_add_f32 v234, 1.0, v234
    v_add_f32 v235, 1.0, v235
    s_waitcnt lgkmcnt(1)
    v_mfma_f32_32x32x16_bf16 v[176:191], v[216:219], v[136:139], v[176:191]
    v_add_f32 v236, 1.0, v236
    v_add_f32 v237, 1.0, v237
    v_add_f32 v238, 1.0, v238
    v_add_f32 v239, 1.0, v239
    v_rcp_f32 v232, v232
    s_waitcnt lgkmcnt(0)
    v_mfma_f32_32x32x16_bf16 v[176:191], v[220:223], v[140:143], v[176:191]
    v_rcp_f32 v233, v233
    v_rcp_f32 v234, v234
    v_rcp_f32 v235, v235
    v_mov_b32 v6, s92
    v_mov_b32 v7, 0
    v_lshlrev_b32 v9, 7, v1
    s_mov_b32 s39, s37
    v_rcp_f32 v236, v236
    v_rcp_f32 v237, v237
    v_rcp_f32 v238, v238
    v_rcp_f32 v239, v239
    v_mul_f32 v232, v232, v152
    v_mul_f32 v233, v233, v153
    v_mul_f32 v234, v234, v154
    v_mul_f32 v235, v235, v155
    v_mul_f32 v236, v236, v156
    v_mul_f32 v237, v237, v157
    v_mul_f32 v238, v238, v158
    v_mul_f32 v239, v239, v159
    v_cvt_pk_bf16_f32 v152, v232, v233
    v_cvt_pk_bf16_f32 v153, v234, v235
    v_cvt_pk_bf16_f32 v154, v236, v237
    v_cvt_pk_bf16_f32 v155, v238, v239
    buffer_store_dwordx4 v[152:155], v2, s[12:15], s37 offen offset:1024 sc1
    s_cmp_eq_u32 s34, 14
    s_cselect_b32 s37, 0x40000000, s37
    v_exp_f32_e64 v224, -v160
    v_exp_f32_e64 v225, -v161
    v_exp_f32_e64 v226, -v162
    v_exp_f32_e64 v227, -v163
    v_exp_f32_e64 v228, -v164
    v_exp_f32_e64 v229, -v165
    v_exp_f32_e64 v230, -v166
    v_exp_f32_e64 v231, -v167
    v_pk_add_f32 v[224:225], v[224:225], 1.0 op_sel_hi:[1,0]
    v_pk_add_f32 v[226:227], v[226:227], 1.0 op_sel_hi:[1,0]
    v_pk_add_f32 v[228:229], v[228:229], 1.0 op_sel_hi:[1,0]
    v_pk_add_f32 v[230:231], v[230:231], 1.0 op_sel_hi:[1,0]
    v_rcp_f32 v224, v224
    v_rcp_f32 v225, v225
    v_rcp_f32 v226, v226
    v_rcp_f32 v227, v227
    v_rcp_f32 v228, v228
    v_rcp_f32 v229, v229
    v_rcp_f32 v230, v230
    v_rcp_f32 v231, v231
    v_pk_mul_f32 v[224:225], v[224:225], v[160:161]
    v_pk_mul_f32 v[226:227], v[226:227], v[162:163]
    v_pk_mul_f32 v[228:229], v[228:229], v[164:165]
    v_pk_mul_f32 v[230:231], v[230:231], v[166:167]
    v_cvt_pk_bf16_f32 v160, v224, v225
    v_cvt_pk_bf16_f32 v161, v226, v227
    v_cvt_pk_bf16_f32 v162, v228, v229
    v_cvt_pk_bf16_f32 v163, v230, v231
    buffer_store_dwordx4 v[160:163], v2, s[12:15], s37 offen offset:2048 sc1
    v_exp_f32_e64 v232, -v168
    v_exp_f32_e64 v233, -v169
    v_exp_f32_e64 v234, -v170
    v_exp_f32_e64 v235, -v171
    v_exp_f32_e64 v236, -v172
    v_exp_f32_e64 v237, -v173
    v_exp_f32_e64 v238, -v174
    v_exp_f32_e64 v239, -v175
    v_pk_add_f32 v[232:233], v[232:233], 1.0 op_sel_hi:[1,0]
    v_pk_add_f32 v[234:235], v[234:235], 1.0 op_sel_hi:[1,0]
    v_pk_add_f32 v[236:237], v[236:237], 1.0 op_sel_hi:[1,0]
    v_pk_add_f32 v[238:239], v[238:239], 1.0 op_sel_hi:[1,0]
    v_rcp_f32 v232, v232
    v_rcp_f32 v233, v233
    v_rcp_f32 v234, v234
    v_rcp_f32 v235, v235
    v_rcp_f32 v236, v236
    v_rcp_f32 v237, v237
    v_rcp_f32 v238, v238
    v_rcp_f32 v239, v239
    v_pk_mul_f32 v[232:233], v[232:233], v[168:169]
    v_pk_mul_f32 v[234:235], v[234:235], v[170:171]
    v_pk_mul_f32 v[236:237], v[236:237], v[172:173]
    v_pk_mul_f32 v[238:239], v[238:239], v[174:175]
    v_cvt_pk_bf16_f32 v168, v232, v233
    v_cvt_pk_bf16_f32 v169, v234, v235
    v_cvt_pk_bf16_f32 v170, v236, v237
    v_cvt_pk_bf16_f32 v171, v238, v239
    buffer_store_dwordx4 v[168:171], v2, s[12:15], s37 offen offset:3072 sc1
    s_add_u32 s37, s37, 4096
    v_exp_f32_e64 v224, -v176
    v_exp_f32_e64 v225, -v177
    v_exp_f32_e64 v226, -v178
    v_exp_f32_e64 v227, -v179
    v_exp_f32_e64 v228, -v180
    v_exp_f32_e64 v229, -v181
    v_exp_f32_e64 v230, -v182
    v_exp_f32_e64 v231, -v183
    v_pk_add_f32 v[224:225], v[224:225], 1.0 op_sel_hi:[1,0]
    v_pk_add_f32 v[226:227], v[226:227], 1.0 op_sel_hi:[1,0]
    v_pk_add_f32 v[228:229], v[228:229], 1.0 op_sel_hi:[1,0]
    v_pk_add_f32 v[230:231], v[230:231], 1.0 op_sel_hi:[1,0]
    v_rcp_f32 v224, v224
    v_rcp_f32 v225, v225
    v_rcp_f32 v226, v226
    v_rcp_f32 v227, v227
    v_rcp_f32 v228, v228
    v_rcp_f32 v229, v229
    v_rcp_f32 v230, v230
    v_rcp_f32 v231, v231
    v_pk_mul_f32 v[224:225], v[224:225], v[176:177]
    v_pk_mul_f32 v[226:227], v[226:227], v[178:179]
    v_pk_mul_f32 v[228:229], v[228:229], v[180:181]
    v_pk_mul_f32 v[230:231], v[230:231], v[182:183]
    v_cvt_pk_bf16_f32 v176, v224, v225
    v_cvt_pk_bf16_f32 v177, v226, v227
    v_cvt_pk_bf16_f32 v178, v228, v229
    v_cvt_pk_bf16_f32 v179, v230, v231
    buffer_store_dwordx4 v[176:179], v2, s[12:15], s37 offen offset:0 sc1
    v_exp_f32_e64 v232, -v184
    v_exp_f32_e64 v233, -v185
    v_exp_f32_e64 v234, -v186
    v_exp_f32_e64 v235, -v187
    v_exp_f32_e64 v236, -v188
    v_exp_f32_e64 v237, -v189
    v_exp_f32_e64 v238, -v190
    v_exp_f32_e64 v239, -v191
    v_pk_add_f32 v[232:233], v[232:233], 1.0 op_sel_hi:[1,0]
    v_pk_add_f32 v[234:235], v[234:235], 1.0 op_sel_hi:[1,0]
    v_pk_add_f32 v[236:237], v[236:237], 1.0 op_sel_hi:[1,0]
    v_pk_add_f32 v[238:239], v[238:239], 1.0 op_sel_hi:[1,0]
    v_rcp_f32 v232, v232
    v_rcp_f32 v233, v233
    v_rcp_f32 v234, v234
    v_rcp_f32 v235, v235
    v_rcp_f32 v236, v236
    v_rcp_f32 v237, v237
    v_rcp_f32 v238, v238
    v_rcp_f32 v239, v239
    v_pk_mul_f32 v[232:233], v[232:233], v[184:185]
    v_pk_mul_f32 v[234:235], v[234:235], v[186:187]
    v_pk_mul_f32 v[236:237], v[236:237], v[188:189]
    v_pk_mul_f32 v[238:239], v[238:239], v[190:191]
    v_cvt_pk_bf16_f32 v184, v232, v233
    v_cvt_pk_bf16_f32 v185, v234, v235
    v_cvt_pk_bf16_f32 v186, v236, v237
    v_cvt_pk_bf16_f32 v187, v238, v239
    buffer_store_dwordx4 v[184:187], v2, s[12:15], s37 offen offset:1024 sc1
    s_waitcnt vmcnt(0)
    s_mov_b64 exec, 1
    s_cmp_eq_u32 s55, 0
    s_cbranch_scc1 L_kb_gwt
    buffer_store_dword v6, v7, s[12:15], s38 offen
    s_branch L_kb_gdone
L_kb_gwt:
    buffer_store_dword v6, v7, s[12:15], s38 offen sc1
L_kb_gdone:
    s_mov_b64 exec, -1
    s_branch L_kb_loader
L_kb_nop4:
    ds_write_b32 v10, v11 offset:22016
L_kb_loader:
    s_and_b32 s33, s3, 1
    s_add_u32 s33, s33, s5
    s_lshl_b32 s35, s33, 6
    s_add_u32 s35, s35, 49152
    s_mul_i32 s36, s33, 86
    s_add_u32 s36, s36, s89
    s_lshl_b32 s36, s36, 10
    s_add_u32 s36, s36, 8388608
    s_mul_i32 s37, s3, 36864
    s_mov_b32 s42, 0xff
    s_cmp_ge_u32 s3, 2
    s_cselect_b32 s42, 0x7f80, s42
    s_lshr_b32 s38, s3, 1
    s_add_u32 s38, s38, s5
    s_lshl_b32 s38, s38, 15
    s_and_b32 s39, s3, 1
    s_add_u32 s39, s39, s88
    s_lshl_b32 s39, s39, 6
    s_add_u32 s38, s38, s39
    s_add_u32 s38, s38, 6291456
    s_lshl_b32 s39, s3, 11
    s_add_u32 s39, s39, 147456
    v_lshrrev_b32 v8, 2, v1
    v_lshlrev_b32 v8, 10, v8
    v_and_b32 v9, 3, v1
    v_lshl_add_u32 v8, v9, 4, v8
    s_barrier
    v_and_b32 v6, 0x7c, v4
    s_mov_b32 s53, 0
L_kb_poll2:
    buffer_load_dword v7, v6, s[12:15], s35 offen sc1
    s_add_u32 s53, s53, 1
    s_waitcnt vmcnt(0)
    v_cmp_eq_u32 vcc, s92, v7
    s_cmp_gt_u32 s53, 1048576
    s_cbranch_scc1 L_kb_poll2_out
    s_and_b32 s32, vcc_lo, s42
    s_cmp_eq_u32 s32, s42
    s_cbranch_scc0 L_kb_poll2
L_kb_poll2_out:
    s_add_u32 m0, s37, 0
    s_add_u32 s53, s36, 0
    buffer_load_dwordx4 v2, s[12:15], s53 offen offset:0 sc1 lds
    buffer_load_dwordx4 v2, s[12:15], s53 offen offset:1024 sc1 lds
    buffer_load_dwordx4 v2, s[12:15], s53 offen offset:2048 sc1 lds
    buffer_load_dwordx4 v2, s[12:15], s53 offen offset:3072 sc1 lds
    s_add_u32 m0, s37, 4096
    s_add_u32 s53, s36, 4096
    buffer_load_dwordx4 v2, s[12:15], s53 offen offset:0 sc1 lds
    buffer_load_dwordx4 v2, s[12:15], s53 offen offset:1024 sc1 lds
    buffer_load_dwordx4 v2, s[12:15], s53 offen offset:2048 sc1 lds
    buffer_load_dwordx4 v2, s[12:15], s53 offen offset:3072 sc1 lds
    s_add_u32 m0, s37, 8192
    s_add_u32 s53, s36, 8192
    buffer_load_dwordx4 v2, s[12:15], s53 offen offset:0 sc1 lds
    buffer_load_dwordx4 v2, s[12:15], s53 offen offset:1024 sc1 lds
    buffer_load_dwordx4 v2, s[12:15], s53 offen offset:2048 sc1 lds
    buffer_load_dwordx4 v2, s[12:15], s53 offen offset:3072 sc1 lds
    s_waitcnt vmcnt(8)
    s_barrier
    s_add_u32 m0, s37, 12288
    s_add_u32 s53, s36, 12288
    buffer_load_dwordx4 v2, s[12:15], s53 offen offset:0 sc1 lds
    buffer_load_dwordx4 v2, s[12:15], s53 offen offset:1024 sc1 lds
    buffer_load_dwordx4 v2, s[12:15], s53 offen offset:2048 sc1 lds
    buffer_load_dwordx4 v2, s[12:15], s53 offen offset:3072 sc1 lds
    s_waitcnt vmcnt(8)
    s_barrier
    s_add_u32 m0, s37, 16384
    s_add_u32 s53, s36, 16384
    buffer_load_dwordx4 v2, s[12:15], s53 offen offset:0 sc1 lds
    buffer_load_dwordx4 v2, s[12:15], s53 offen offset:1024 sc1 lds
    buffer_load_dwordx4 v2, s[12:15], s53 offen offset:2048 sc1 lds
    buffer_load_dwordx4 v2, s[12:15], s53 offen offset:3072 sc1 lds
    s_waitcnt vmcnt(8)
    s_barrier
    s_add_u32 m0, s37, 20480
    s_add_u32 s53, s36, 20480
    buffer_load_dwordx4 v2, s[12:15], s53 offen offset:0 sc1 lds
    buffer_load_dwordx4 v2, s[12:15], s53 offen offset:1024 sc1 lds
    buffer_load_dwordx4 v2, s[12:15], s53 offen offset:2048 sc1 lds
    buffer_load_dwordx4 v2, s[12:15], s53 offen offset:3072 sc1 lds
    s_waitcnt vmcnt(8)
    s_barrier
    s_add_u32 m0, s37, 24576
    s_add_u32 s53, s36, 24576
    buffer_load_dwordx4 v2, s[12:15], s53 offen offset:0 sc1 lds
    buffer_load_dwordx4 v2, s[12:15], s53 offen offset:1024 sc1 lds
    buffer_load_dwordx4 v2, s[12:15], s53 offen offset:2048 sc1 lds
    buffer_load_dwordx4 v2, s[12:15], s53 offen offset:3072 sc1 lds
    s_waitcnt vmcnt(8)
    s_barrier
    s_add_u32 m0, s37, 28672
    s_add_u32 s53, s36, 28672
    buffer_load_dwordx4 v2, s[12:15], s53 offen offset:0 sc1 lds
    buffer_load_dwordx4 v2, s[12:15], s53 offen offset:1024 sc1 lds
    buffer_load_dwordx4 v2, s[12:15], s53 offen offset:2048 sc1 lds
    buffer_load_dwordx4 v2, s[12:15], s53 offen offset:3072 sc1 lds
    s_waitcnt vmcnt(8)
    s_barrier
    s_add_u32 m0, s37, 32768
    s_add_u32 s53, s36, 32768
    buffer_load_dwordx4 v2, s[12:15], s53 offen offset:0 sc1 lds
    buffer_load_dwordx4 v2, s[12:15], s53 offen offset:1024 sc1 lds
    buffer_load_dwordx4 v2, s[12:15], s53 offen offset:2048 sc1 lds
    buffer_load_dwordx4 v2, s[12:15], s53 offen offset:3072 sc1 lds
    s_waitcnt vmcnt(8)
    s_barrier
    s_add_u32 m0, s37, 0
    s_add_u32 s53, s36, 36864
    buffer_load_dwordx4 v2, s[12:15], s53 offen offset:0 sc1 lds
    buffer_load_dwordx4 v2, s[12:15], s53 offen offset:1024 sc1 lds
    buffer_load_dwordx4 v2, s[12:15], s53 offen offset:2048 sc1 lds
    buffer_load_dwordx4 v2, s[12:15], s53 offen offset:3072 sc1 lds
    s_waitcnt vmcnt(8)
    s_barrier
    s_add_u32 m0, s37, 4096
    s_add_u32 s53, s36, 40960
    buffer_load_dwordx4 v2, s[12:15], s53 offen offset:0 sc1 lds
    buffer_load_dwordx4 v2, s[12:15], s53 offen offset:1024 sc1 lds
    buffer_load_dwordx4 v2, s[12:15], s53 offen offset:2048 sc1 lds
    s_add_u32 m0, s39, 0
    s_add_u32 s53, s38, 0
    buffer_load_dwordx4 v8, s[12:15], s53 offen sc1 lds
    s_add_u32 m0, s39, 1024
    s_add_u32 s53, s38, 16384
    buffer_load_dwordx4 v8, s[12:15], s53 offen sc1 lds
    s_waitcnt vmcnt(9)
    s_barrier
    s_waitcnt vmcnt(5)
    s_barrier
    s_waitcnt vmcnt(0)
    s_barrier
    s_endpgm
L_kb_p5:
    s_and_b32 s36, s3, 3
    s_lshl_b32 s37, s36, 13
    s_add_u32 s37, s37, 120832
    v_add_u32 v3, s37, v2
    ds_read_b128 v[156:159], v3 offset:0
    ds_read_b128 v[160:163], v3 offset:1024
    ds_read_b128 v[164:167], v3 offset:2048
    ds_read_b128 v[168:171], v3 offset:3072
    ds_read_b128 v[172:175], v3 offset:4096
    ds_read_b128 v[176:179], v3 offset:5120
    ds_read_b128 v[180:183], v3 offset:6144
    ds_read_b128 v[184:187], v3 offset:7168
    s_lshr_b32 s38, s36, 1
    s_mul_i32 s43, s38, 110592
    v_add_u32 v3, s43, v2
    s_mul_i32 s43, s38, 36864
    s_add_u32 s43, s43, 36864
    v_add_u32 v5, s43, v2
    s_add_u32 s38, s38, s5
    s_and_b32 s39, s36, 1
    s_add_u32 s39, s39, s88
    s_lshl_b32 s40, s38, 15
    s_lshl_b32 s41, s39, 6
    s_add_u32 s40, s40, s41
    s_lshl_b32 s42, s39, 7
    s_add_u32 s42, s42, 161792
    s_lshl_b32 s41, s36, 11
    s_add_u32 s41, s41, 147456
    v_and_b32 v12, 31, v0
    v_lshlrev_b32 v8, 10, v12
    v_bfe_u32 v9, v0, 5, 1
    v_lshl_add_u32 v8, v9, 4, v8
    v_lshlrev_b32 v12, 6, v12
    v_lshl_add_u32 v12, v9, 3, v12
    v_add_u32 v12, s41, v12
    v_lshl_add_u32 v9, v9, 4, s42
    s_lshl_b32 s43, s36, 12
    s_add_u32 s43, s43, 8192
    v_add_u32 v10, s43, v2
    s_xor_b32 s43, s43, 8192 + 16384
    v_add_u32 v11, s43, v2
    s_mov_b32 s8, s84
    s_mov_b32 s9, s85
    s_mov_b32 s10, 0x200000
    s_mov_b32 s11, 0x20000
    s_lshl_b32 s53, s36, 2
    v_mov_b32 v13, s53
    s_mov_b32 s53, 0
L_sig:
    s_sleep 2
    ds_read_b32 v14, v13 offset:22016
    s_add_u32 s53, s53, 1
    s_waitcnt lgkmcnt(0)
    v_cmp_eq_u32 vcc, s92, v14
    s_cmp_gt_u32 s53, 8388608
    s_cbranch_scc1 L_sig_out
    s_cbranch_vccz L_sig
L_sig_out:
    s_add_u32 s53, s49, 0
    s_add_u32 s53, s49, 4096
    s_add_u32 s53, s49, 8192
    s_add_u32 s53, s49, 12288
    buffer_load_dwordx4 v[72:75], v2, s[12:15], s53 offen offset:2048 sc1
    buffer_load_dwordx4 v[76:79], v2, s[12:15], s53 offen offset:3072 sc1
    s_add_u32 s53, s49, 16384
    buffer_load_dwordx4 v[80:83], v2, s[12:15], s53 offen offset:0 sc1
    buffer_load_dwordx4 v[84:87], v2, s[12:15], s53 offen offset:1024 sc1
    buffer_load_dwordx4 v[88:91], v2, s[12:15], s53 offen offset:2048 sc1
    buffer_load_dwordx4 v[92:95], v2, s[12:15], s53 offen offset:3072 sc1
    s_add_u32 s53, s49, 20480
    buffer_load_dwordx4 v[96:99], v2, s[12:15], s53 offen offset:0 sc1
    buffer_load_dwordx4 v[100:103], v2, s[12:15], s53 offen offset:1024 sc1
    buffer_load_dwordx4 v[104:107], v2, s[12:15], s53 offen offset:2048 sc1
    buffer_load_dwordx4 v[108:111], v2, s[12:15], s53 offen offset:3072 sc1
    s_add_u32 s53, s49, 24576
    buffer_load_dwordx4 v[112:115], v2, s[12:15], s53 offen offset:0 sc1
    buffer_load_dwordx4 v[116:119], v2, s[12:15], s53 offen offset:1024 sc1
    buffer_load_dwordx4 v[120:123], v2, s[12:15], s53 offen offset:2048 sc1
    buffer_load_dwordx4 v[124:127], v2, s[12:15], s53 offen offset:3072 sc1
    s_add_u32 s53, s49, 28672
    buffer_load_dwordx4 v[128:131], v2, s[12:15], s53 offen offset:0 sc1
    buffer_load_dwordx4 v[132:135], v2, s[12:15], s53 offen offset:1024 sc1
    buffer_load_dwordx4 v[136:139], v2, s[12:15], s53 offen offset:2048 sc1
    buffer_load_dwordx4 v[140:143], v2, s[12:15], s53 offen offset:3072 sc1
    s_add_u32 s53, s49, 32768
    buffer_load_dwordx4 v[144:147], v2, s[12:15], s53 offen offset:0 sc1
    buffer_load_dwordx4 v[148:151], v2, s[12:15], s53 offen offset:1024 sc1
    buffer_load_dwordx4 v[152:155], v2, s[12:15], s53 offen offset:2048 sc1
    s_waitcnt lgkmcnt(0)
    s_barrier
    s_waitcnt vmcnt(0)
    s_barrier
    ds_read_b128 v[220:223], v3 offset:0
    ds_read_b128 v[224:227], v5 offset:0
    ds_read_b128 v[228:231], v3 offset:1024
    ds_read_b128 v[232:235], v5 offset:1024
    ds_read_b128 v[236:239], v3 offset:2048
    ds_read_b128 v[240:243], v5 offset:2048
    ds_read_b128 v[244:247], v3 offset:3072
    s_waitcnt lgkmcnt(6)
    v_mfma_f32_32x32x16_bf16 v[188:203], v[16:19], v[220:223], 0
    ds_read_b128 v[248:251], v5 offset:3072
    s_waitcnt lgkmcnt(6)
    v_mfma_f32_32x32x16_bf16 v[204:219], v[16:19], v[224:227], 0
    s_barrier
    ds_read_b128 v[220:223], v3 offset:4096
    s_waitcnt lgkmcnt(6)
    v_mfma_f32_32x32x16_bf16 v[188:203], v[20:23], v[228:231], v[188:203]
    ds_read_b128 v[224:227], v5 offset:4096
    s_waitcnt lgkmcnt(6)
    v_mfma_f32_32x32x16_bf16 v[204:219], v[20:23], v[232:235], v[204:219]
    ds_read_b128 v[228:231], v3 offset:5120
    s_waitcnt lgkmcnt(6)
    v_mfma_f32_32x32x16_bf16 v[188:203], v[24:27], v[236:239], v[188:203]
    ds_read_b128 v[232:235], v5 offset:5120
    s_waitcnt lgkmcnt(6)
    v_mfma_f32_32x32x16_bf16 v[204:219], v[24:27], v[240:243], v[204:219]
    ds_read_b128 v[236:239], v3 offset:6144
    s_waitcnt lgkmcnt(6)
    v_mfma_f32_32x32x16_bf16 v[188:203], v[28:31], v[244:247], v[188:203]
    ds_read_b128 v[240:243], v5 offset:6144
    s_waitcnt lgkmcnt(6)
    v_mfma_f32_32x32x16_bf16 v[204:219], v[28:31], v[248:251], v[204:219]
    ds_read_b128 v[244:247], v3 offset:7168
    s_waitcnt lgkmcnt(6)
    v_mfma_f32_32x32x16_bf16 v[188:203], v[32:35], v[220:223], v[188:203]
    ds_read_b128 v[248:251], v5 offset:7168
    s_waitcnt lgkmcnt(6)
    v_mfma_f32_32x32x16_bf16 v[204:219], v[32:35], v[224:227], v[204:219]
    s_barrier
    ds_read_b128 v[220:223], v3 offset:8192
    s_waitcnt lgkmcnt(6)
    v_mfma_f32_32x32x16_bf16 v[188:203], v[36:39], v[228:231], v[188:203]
    ds_read_b128 v[224:227], v5 offset:8192
    s_waitcnt lgkmcnt(6)
    v_mfma_f32_32x32x16_bf16 v[204:219], v[36:39], v[232:235], v[204:219]
    ds_read_b128 v[228:231], v3 offset:9216
    s_waitcnt lgkmcnt(6)
    v_mfma_f32_32x32x16_bf16 v[188:203], v[40:43], v[236:239], v[188:203]
    ds_read_b128 v[232:235], v5 offset:9216
    s_waitcnt lgkmcnt(6)
    v_mfma_f32_32x32x16_bf16 v[204:219], v[40:43], v[240:243], v[204:219]
    ds_read_b128 v[236:239], v3 offset:10240
    s_waitcnt lgkmcnt(6)
    v_mfma_f32_32x32x16_bf16 v[188:203], v[44:47], v[244:247], v[188:203]
    ds_read_b128 v[240:243], v5 offset:10240
    s_waitcnt lgkmcnt(6)
    v_mfma_f32_32x32x16_bf16 v[204:219], v[44:47], v[248:251], v[204:219]
    ds_read_b128 v[244:247], v3 offset:11264
    s_waitcnt lgkmcnt(6)
    v_mfma_f32_32x32x16_bf16 v[188:203], v[48:51], v[220:223], v[188:203]
    ds_read_b128 v[248:251], v5 offset:11264
    s_waitcnt lgkmcnt(6)
    v_mfma_f32_32x32x16_bf16 v[204:219], v[48:51], v[224:227], v[204:219]
    s_barrier
    ds_read_b128 v[220:223], v3 offset:12288
    s_waitcnt lgkmcnt(6)
    v_mfma_f32_32x32x16_bf16 v[188:203], v[52:55], v[228:231], v[188:203]
    ds_read_b128 v[224:227], v5 offset:12288
    s_waitcnt lgkmcnt(6)
    v_mfma_f32_32x32x16_bf16 v[204:219], v[52:55], v[232:235], v[204:219]
    ds_read_b128 v[228:231], v3 offset:13312
    s_waitcnt lgkmcnt(6)
    v_mfma_f32_32x32x16_bf16 v[188:203], v[56:59], v[236:239], v[188:203]
    ds_read_b128 v[232:235], v5 offset:13312
    s_waitcnt lgkmcnt(6)
    v_mfma_f32_32x32x16_bf16 v[204:219], v[56:59], v[240:243], v[204:219]
    ds_read_b128 v[236:239], v3 offset:14336
    s_waitcnt lgkmcnt(6)
    v_mfma_f32_32x32x16_bf16 v[188:203], v[60:63], v[244:247], v[188:203]
    ds_read_b128 v[240:243], v5 offset:14336
    s_waitcnt lgkmcnt(6)
    v_mfma_f32_32x32x16_bf16 v[204:219], v[60:63], v[248:251], v[204:219]
    ds_read_b128 v[244:247], v3 offset:15360
    s_waitcnt lgkmcnt(6)
    v_mfma_f32_32x32x16_bf16 v[188:203], v[64:67], v[220:223], v[188:203]
    ds_read_b128 v[248:251], v5 offset:15360
    s_waitcnt lgkmcnt(6)
    v_mfma_f32_32x32x16_bf16 v[204:219], v[64:67], v[224:227], v[204:219]
    s_barrier
    ds_read_b128 v[220:223], v3 offset:16384
    s_waitcnt lgkmcnt(6)
    v_mfma_f32_32x32x16_bf16 v[188:203], v[68:71], v[228:231], v[188:203]
    ds_read_b128 v[224:227], v5 offset:16384
    s_waitcnt lgkmcnt(6)
    v_mfma_f32_32x32x16_bf16 v[204:219], v[68:71], v[232:235], v[204:219]
    ds_read_b128 v[228:231], v3 offset:17408
    s_waitcnt lgkmcnt(6)
    v_mfma_f32_32x32x16_bf16 v[188:203], v[72:75], v[236:239], v[188:203]
    ds_read_b128 v[232:235], v5 offset:17408
    s_waitcnt lgkmcnt(6)
    v_mfma_f32_32x32x16_bf16 v[204:219], v[72:75], v[240:243], v[204:219]
    ds_read_b128 v[236:239], v3 offset:18432
    s_waitcnt lgkmcnt(6)
    v_mfma_f32_32x32x16_bf16 v[188:203], v[76:79], v[244:247], v[188:203]
    ds_read_b128 v[240:243], v5 offset:18432
    s_waitcnt lgkmcnt(6)
    v_mfma_f32_32x32x16_bf16 v[204:219], v[76:79], v[248:251], v[204:219]
    ds_read_b128 v[244:247], v3 offset:19456
    s_waitcnt lgkmcnt(6)
    v_mfma_f32_32x32x16_bf16 v[188:203], v[80:83], v[220:223], v[188:203]
    ds_read_b128 v[248:251], v5 offset:19456
    s_waitcnt lgkmcnt(6)
    v_mfma_f32_32x32x16_bf16 v[204:219], v[80:83], v[224:227], v[204:219]
    s_barrier
    ds_read_b128 v[220:223], v3 offset:20480
    s_waitcnt lgkmcnt(6)
    v_mfma_f32_32x32x16_bf16 v[188:203], v[84:87], v[228:231], v[188:203]
    ds_read_b128 v[224:227], v5 offset:20480
    s_waitcnt lgkmcnt(6)
    v_mfma_f32_32x32x16_bf16 v[204:219], v[84:87], v[232:235], v[204:219]
    ds_read_b128 v[228:231], v3 offset:21504
    s_waitcnt lgkmcnt(6)
    v_mfma_f32_32x32x16_bf16 v[188:203], v[88:91], v[236:239], v[188:203]
    ds_read_b128 v[232:235], v5 offset:21504
    s_waitcnt lgkmcnt(6)
    v_mfma_f32_32x32x16_bf16 v[204:219], v[88:91], v[240:243], v[204:219]
    ds_read_b128 v[236:239], v3 offset:22528
    s_waitcnt lgkmcnt(6)
    v_mfma_f32_32x32x16_bf16 v[188:203], v[92:95], v[244:247], v[188:203]
    ds_read_b128 v[240:243], v5 offset:22528
    s_waitcnt lgkmcnt(6)
    v_mfma_f32_32x32x16_bf16 v[204:219], v[92:95], v[248:251], v[204:219]
    ds_read_b128 v[244:247], v3 offset:23552
    s_waitcnt lgkmcnt(6)
    v_mfma_f32_32x32x16_bf16 v[188:203], v[96:99], v[220:223], v[188:203]
    ds_read_b128 v[24:27], v9 offset:0
    ds_read_b128 v[28:31], v9 offset:32
    ds_read_b128 v[32:35], v9 offset:64
    ds_read_b128 v[36:39], v9 offset:96
    ds_read_b128 v[248:251], v5 offset:23552
    s_waitcnt lgkmcnt(10)
    v_mfma_f32_32x32x16_bf16 v[204:219], v[96:99], v[224:227], v[204:219]
    s_barrier
    ds_read_b128 v[220:223], v3 offset:24576
    s_waitcnt lgkmcnt(10)
    v_mfma_f32_32x32x16_bf16 v[188:203], v[100:103], v[228:231], v[188:203]
    ds_read_b128 v[224:227], v5 offset:24576
    s_waitcnt lgkmcnt(10)
    v_mfma_f32_32x32x16_bf16 v[204:219], v[100:103], v[232:235], v[204:219]
    ds_read_b128 v[228:231], v3 offset:25600
    s_waitcnt lgkmcnt(10)
    v_mfma_f32_32x32x16_bf16 v[188:203], v[104:107], v[236:239], v[188:203]
    ds_read_b128 v[232:235], v5 offset:25600
    s_waitcnt lgkmcnt(10)
    v_mfma_f32_32x32x16_bf16 v[204:219], v[104:107], v[240:243], v[204:219]
    ds_read_b128 v[236:239], v3 offset:26624
    s_waitcnt lgkmcnt(10)
    v_mfma_f32_32x32x16_bf16 v[188:203], v[108:111], v[244:247], v[188:203]
    ds_read_b128 v[240:243], v5 offset:26624
    s_waitcnt lgkmcnt(6)
    v_mfma_f32_32x32x16_bf16 v[204:219], v[108:111], v[248:251], v[204:219]
    ds_read_b128 v[244:247], v3 offset:27648
    s_waitcnt lgkmcnt(6)
    v_mfma_f32_32x32x16_bf16 v[188:203], v[112:115], v[220:223], v[188:203]
    ds_read_b128 v[248:251], v5 offset:27648
    s_waitcnt lgkmcnt(6)
    v_mfma_f32_32x32x16_bf16 v[204:219], v[112:115], v[224:227], v[204:219]
    s_barrier
    ds_read_b128 v[220:223], v3 offset:28672
    s_waitcnt lgkmcnt(6)
    v_mfma_f32_32x32x16_bf16 v[188:203], v[116:119], v[228:231], v[188:203]
    ds_read_b128 v[224:227], v5 offset:28672
    s_waitcnt lgkmcnt(6)
    v_mfma_f32_32x32x16_bf16 v[204:219], v[116:119], v[232:235], v[204:219]
    ds_read_b128 v[228:231], v3 offset:29696
    s_waitcnt lgkmcnt(6)
    v_mfma_f32_32x32x16_bf16 v[188:203], v[120:123], v[236:239], v[188:203]
    ds_read_b128 v[232:235], v5 offset:29696
    s_waitcnt lgkmcnt(6)
    v_mfma_f32_32x32x16_bf16 v[204:219], v[120:123], v[240:243], v[204:219]
    ds_read_b128 v[236:239], v3 offset:30720
    s_waitcnt lgkmcnt(6)
    v_mfma_f32_32x32x16_bf16 v[188:203], v[124:127], v[244:247], v[188:203]
    ds_read_b128 v[240:243], v5 offset:30720
    s_waitcnt lgkmcnt(6)
    v_mfma_f32_32x32x16_bf16 v[204:219], v[124:127], v[248:251], v[204:219]
    ds_read_b128 v[244:247], v3 offset:31744
    s_waitcnt lgkmcnt(6)
    v_mfma_f32_32x32x16_bf16 v[188:203], v[128:131], v[220:223], v[188:203]
    ds_read_b128 v[248:251], v5 offset:31744
    s_waitcnt lgkmcnt(6)
    v_mfma_f32_32x32x16_bf16 v[204:219], v[128:131], v[224:227], v[204:219]
    s_barrier
    ds_read_b128 v[220:223], v3 offset:32768
    s_waitcnt lgkmcnt(6)
    v_mfma_f32_32x32x16_bf16 v[188:203], v[132:135], v[228:231], v[188:203]
    ds_read_b128 v[224:227], v5 offset:32768
    s_waitcnt lgkmcnt(6)
    v_mfma_f32_32x32x16_bf16 v[204:219], v[132:135], v[232:235], v[204:219]
    ds_read_b128 v[228:231], v3 offset:33792
    s_waitcnt lgkmcnt(6)
    v_mfma_f32_32x32x16_bf16 v[188:203], v[136:139], v[236:239], v[188:203]
    ds_read_b128 v[232:235], v5 offset:33792
    s_waitcnt lgkmcnt(6)
    v_mfma_f32_32x32x16_bf16 v[204:219], v[136:139], v[240:243], v[204:219]
    ds_read_b128 v[236:239], v3 offset:34816
    s_waitcnt lgkmcnt(6)
    v_mfma_f32_32x32x16_bf16 v[188:203], v[140:143], v[244:247], v[188:203]
    ds_read_b128 v[240:243], v5 offset:34816
    s_waitcnt lgkmcnt(6)
    v_mfma_f32_32x32x16_bf16 v[204:219], v[140:143], v[248:251], v[204:219]
    ds_read_b128 v[244:247], v3 offset:35840
    s_waitcnt lgkmcnt(6)
    v_mfma_f32_32x32x16_bf16 v[188:203], v[144:147], v[220:223], v[188:203]
    ds_read_b128 v[248:251], v5 offset:35840
    s_waitcnt lgkmcnt(6)
    v_mfma_f32_32x32x16_bf16 v[204:219], v[144:147], v[224:227], v[204:219]
    s_barrier
    ds_read_b128 v[220:223], v3 offset:0
    s_waitcnt lgkmcnt(6)
    v_mfma_f32_32x32x16_bf16 v[188:203], v[148:151], v[228:231], v[188:203]
    ds_read_b128 v[224:227], v5 offset:0
    s_waitcnt lgkmcnt(6)
    v_mfma_f32_32x32x16_bf16 v[204:219], v[148:151], v[232:235], v[204:219]
    ds_read_b128 v[228:231], v3 offset:1024
    s_waitcnt lgkmcnt(6)
    v_mfma_f32_32x32x16_bf16 v[188:203], v[152:155], v[236:239], v[188:203]
    ds_read_b128 v[232:235], v5 offset:1024
    s_waitcnt lgkmcnt(6)
    v_mfma_f32_32x32x16_bf16 v[204:219], v[152:155], v[240:243], v[204:219]
    ds_read_b128 v[236:239], v3 offset:2048
    s_waitcnt lgkmcnt(6)
    v_mfma_f32_32x32x16_bf16 v[188:203], v[156:159], v[244:247], v[188:203]
    ds_read_b128 v[240:243], v5 offset:2048
    s_waitcnt lgkmcnt(6)
    v_mfma_f32_32x32x16_bf16 v[204:219], v[156:159], v[248:251], v[204:219]
    ds_read_b128 v[244:247], v3 offset:3072
    s_waitcnt lgkmcnt(6)
    v_mfma_f32_32x32x16_bf16 v[188:203], v[160:163], v[220:223], v[188:203]
    ds_read_b128 v[248:251], v5 offset:3072
    s_waitcnt lgkmcnt(6)
    v_mfma_f32_32x32x16_bf16 v[204:219], v[160:163], v[224:227], v[204:219]
    s_barrier
    ds_read_b128 v[220:223], v3 offset:4096
    s_waitcnt lgkmcnt(6)
    v_mfma_f32_32x32x16_bf16 v[188:203], v[164:167], v[228:231], v[188:203]
    ds_read_b128 v[224:227], v5 offset:4096
    s_waitcnt lgkmcnt(6)
    v_mfma_f32_32x32x16_bf16 v[204:219], v[164:167], v[232:235], v[204:219]
    ds_read_b128 v[228:231], v3 offset:5120
    s_waitcnt lgkmcnt(6)
    v_mfma_f32_32x32x16_bf16 v[188:203], v[168:171], v[236:239], v[188:203]
    ds_read_b128 v[232:235], v5 offset:5120
    s_waitcnt lgkmcnt(6)
    v_mfma_f32_32x32x16_bf16 v[204:219], v[168:171], v[240:243], v[204:219]
    ds_read_b128 v[236:239], v3 offset:6144
    s_waitcnt lgkmcnt(6)
    v_mfma_f32_32x32x16_bf16 v[188:203], v[172:175], v[244:247], v[188:203]
    ds_read_b128 v[240:243], v5 offset:6144
    s_waitcnt lgkmcnt(6)
    v_mfma_f32_32x32x16_bf16 v[204:219], v[172:175], v[248:251], v[204:219]
    s_waitcnt lgkmcnt(5)
    v_mfma_f32_32x32x16_bf16 v[188:203], v[176:179], v[220:223], v[188:203]
    s_waitcnt lgkmcnt(4)
    v_mfma_f32_32x32x16_bf16 v[204:219], v[176:179], v[224:227], v[204:219]
    s_waitcnt lgkmcnt(3)
    v_mfma_f32_32x32x16_bf16 v[188:203], v[180:183], v[228:231], v[188:203]
    ds_read_b64 v[16:17], v12 offset:0
    ds_read_b64 v[18:19], v12 offset:16
    ds_read_b64 v[20:21], v12 offset:32
    ds_read_b64 v[22:23], v12 offset:48
    s_waitcnt lgkmcnt(6)
    v_mfma_f32_32x32x16_bf16 v[204:219], v[180:183], v[232:235], v[204:219]
    s_waitcnt lgkmcnt(5)
    v_mfma_f32_32x32x16_bf16 v[188:203], v[184:187], v[236:239], v[188:203]
    s_waitcnt lgkmcnt(4)
    v_mfma_f32_32x32x16_bf16 v[204:219], v[184:187], v[240:243], v[204:219]
    s_waitcnt lgkmcnt(0)
    v_lshlrev_b32 v40, 16, v16
    v_and_b32 v41, 0xffff0000, v16
    v_lshlrev_b32 v42, 16, v17
    v_and_b32 v43, 0xffff0000, v17
    v_lshlrev_b32 v44, 16, v18
    v_and_b32 v45, 0xffff0000, v18
    v_lshlrev_b32 v46, 16, v19
    v_and_b32 v47, 0xffff0000, v19
    v_lshlrev_b32 v48, 16, v20
    v_and_b32 v49, 0xffff0000, v20
    v_lshlrev_b32 v50, 16, v21
    v_and_b32 v51, 0xffff0000, v21
    ds_write_b128 v10, v[204:207] offset:0
    ds_write_b128 v10, v[208:211] offset:1024
    ds_write_b128 v10, v[212:215] offset:2048
    ds_write_b128 v10, v[216:219] offset:3072
    v_lshlrev_b32 v52, 16, v22
    v_and_b32 v53, 0xffff0000, v22
    v_lshlrev_b32 v54, 16, v23
    v_and_b32 v55, 0xffff0000, v23
    s_waitcnt lgkmcnt(0)
    s_barrier
    ds_read_b128 v[204:207], v11 offset:0
    ds_read_b128 v[208:211], v11 offset:1024
    ds_read_b128 v[212:215], v11 offset:2048
    ds_read_b128 v[216:219], v11 offset:3072
    s_waitcnt lgkmcnt(3)
    v_pk_add_f32 v[188:189], v[188:189], v[204:205]
    v_pk_add_f32 v[190:191], v[190:191], v[206:207]
    v_pk_fma_f32 v[188:189], v[188:189], v[24:25], v[40:41]
    v_pk_fma_f32 v[190:191], v[190:191], v[26:27], v[42:43]
    v_cvt_pk_bf16_f32 v16, v188, v189
    v_cvt_pk_bf16_f32 v17, v190, v191
    s_waitcnt lgkmcnt(2)
    v_pk_add_f32 v[192:193], v[192:193], v[208:209]
    v_pk_add_f32 v[194:195], v[194:195], v[210:211]
    v_pk_fma_f32 v[192:193], v[192:193], v[28:29], v[44:45]
    v_pk_fma_f32 v[194:195], v[194:195], v[30:31], v[46:47]
    v_cvt_pk_bf16_f32 v18, v192, v193
    v_cvt_pk_bf16_f32 v19, v194, v195
    s_nop 1
    v_permlane32_swap_b32 v16, v18
    v_permlane32_swap_b32 v17, v19
    buffer_store_dwordx4 v[16:19], v8, s[8:11], s40 offen offset:0
    s_waitcnt lgkmcnt(1)
    v_pk_add_f32 v[196:197], v[196:197], v[212:213]
    v_pk_add_f32 v[198:199], v[198:199], v[214:215]
    v_pk_fma_f32 v[196:197], v[196:197], v[32:33], v[48:49]
    v_pk_fma_f32 v[198:199], v[198:199], v[34:35], v[50:51]
    v_cvt_pk_bf16_f32 v20, v196, v197
    v_cvt_pk_bf16_f32 v21, v198, v199
    s_waitcnt lgkmcnt(0)
    v_pk_add_f32 v[200:201], v[200:201], v[216:217]
    v_pk_add_f32 v[202:203], v[202:203], v[218:219]
    v_pk_fma_f32 v[200:201], v[200:201], v[36:37], v[52:53]
    v_pk_fma_f32 v[202:203], v[202:203], v[38:39], v[54:55]
    v_cvt_pk_bf16_f32 v22, v200, v201
    v_cvt_pk_bf16_f32 v23, v202, v203
    s_nop 1
    v_permlane32_swap_b32 v20, v22
    v_permlane32_swap_b32 v21, v23
    buffer_store_dwordx4 v[20:23], v8, s[8:11], s40 offen offset:32
L_kb_end:
    s_endpgm
L_kb_slow:
    s_setprio 3
    v_lshlrev_b32 v12, 2, v0
    v_and_b32 v12, 0x3fc, v12
    v_mov_b32 v6, 0xff800000
    ds_write_b32 v12, v6 offset:20480
    s_waitcnt lgkmcnt(0)
    s_barrier
    s_waitcnt vmcnt(0)
    v_and_b32 v12, 31, v0
    v_lshlrev_b32 v12, 2, v12
    s_add_u32 s22, s33, 0
    s_and_b32 s22, s22, 7
    s_lshl_b32 s22, s22, 10
    s_add_u32 s22, s22, s21
    buffer_load_dwordx4 v[232:235], v2, s[12:15], s22 offen sc1
    v_mov_b32 v6, 0xff800000
    s_waitcnt vmcnt(0)
    v_mfma_f32_32x32x16_bf16 v[120:135], v[16:19], v[232:235], 0
    s_nop 11
    v_max3_f32 v6, v6, v120, v121
    v_max3_f32 v6, v6, v122, v123
    v_max3_f32 v6, v6, v124, v125
    v_max3_f32 v6, v6, v126, v127
    v_max3_f32 v6, v6, v128, v129
    v_max3_f32 v6, v6, v130, v131
    v_max3_f32 v6, v6, v132, v133
    v_max3_f32 v6, v6, v134, v135
    v_mfma_f32_32x32x16_bf16 v[120:135], v[20:23], v[232:235], 0
    s_nop 11
    v_max3_f32 v6, v6, v120, v121
    v_max3_f32 v6, v6, v122, v123
    v_max3_f32 v6, v6, v124, v125
    v_max3_f32 v6, v6, v126, v127
    v_max3_f32 v6, v6, v128, v129
    v_max3_f32 v6, v6, v130, v131
    v_max3_f32 v6, v6, v132, v133
    v_max3_f32 v6, v6, v134, v135
    v_mfma_f32_32x32x16_bf16 v[120:135], v[24:27], v[232:235], 0
    s_nop 11
    v_max3_f32 v6, v6, v120, v121
    v_max3_f32 v6, v6, v122, v123
    v_max3_f32 v6, v6, v124, v125
    v_max3_f32 v6, v6, v126, v127
    v_max3_f32 v6, v6, v128, v129
    v_max3_f32 v6, v6, v130, v131
    v_max3_f32 v6, v6, v132, v133
    v_max3_f32 v6, v6, v134, v135
    v_mfma_f32_32x32x16_bf16 v[120:135], v[28:31], v[232:235], 0
    s_nop 11
    v_max3_f32 v6, v6, v120, v121
    v_max3_f32 v6, v6, v122, v123
    v_max3_f32 v6, v6, v124, v125
    v_max3_f32 v6, v6, v126, v127
    v_max3_f32 v6, v6, v128, v129
    v_max3_f32 v6, v6, v130, v131
    v_max3_f32 v6, v6, v132, v133
    v_max3_f32 v6, v6, v134, v135
    v_mfma_f32_32x32x16_bf16 v[120:135], v[32:35], v[232:235], 0
    s_nop 11
    v_max3_f32 v6, v6, v120, v121
    v_max3_f32 v6, v6, v122, v123
    v_max3_f32 v6, v6, v124, v125
    v_max3_f32 v6, v6, v126, v127
    v_max3_f32 v6, v6, v128, v129
    v_max3_f32 v6, v6, v130, v131
    v_max3_f32 v6, v6, v132, v133
    v_max3_f32 v6, v6, v134, v135
    v_mfma_f32_32x32x16_bf16 v[120:135], v[36:39], v[232:235], 0
    s_nop 11
    v_max3_f32 v6, v6, v120, v121
    v_max3_f32 v6, v6, v122, v123
    v_max3_f32 v6, v6, v124, v125
    v_max3_f32 v6, v6, v126, v127
    v_max3_f32 v6, v6, v128, v129
    v_max3_f32 v6, v6, v130, v131
    v_max3_f32 v6, v6, v132, v133
    v_max3_f32 v6, v6, v134, v135
    v_mfma_f32_32x32x16_bf16 v[120:135], v[40:43], v[232:235], 0
    s_nop 11
    v_max3_f32 v6, v6, v120, v121
    v_max3_f32 v6, v6, v122, v123
    v_max3_f32 v6, v6, v124, v125
    v_max3_f32 v6, v6, v126, v127
    v_max3_f32 v6, v6, v128, v129
    v_max3_f32 v6, v6, v130, v131
    v_max3_f32 v6, v6, v132, v133
    v_max3_f32 v6, v6, v134, v135
    v_mfma_f32_32x32x16_bf16 v[120:135], v[44:47], v[232:235], 0
    s_nop 11
    v_max3_f32 v6, v6, v120, v121
    v_max3_f32 v6, v6, v122, v123
    v_max3_f32 v6, v6, v124, v125
    v_max3_f32 v6, v6, v126, v127
    v_max3_f32 v6, v6, v128, v129
    v_max3_f32 v6, v6, v130, v131
    v_max3_f32 v6, v6, v132, v133
    v_max3_f32 v6, v6, v134, v135
    ds_max_f32 v12, v6 offset:20480
    s_add_u32 s22, s33, 1
    s_and_b32 s22, s22, 7
    s_lshl_b32 s22, s22, 10
    s_add_u32 s22, s22, s21
    buffer_load_dwordx4 v[232:235], v2, s[12:15], s22 offen sc1
    v_mov_b32 v6, 0xff800000
    s_waitcnt vmcnt(0)
    v_mfma_f32_32x32x16_bf16 v[120:135], v[16:19], v[232:235], 0
    s_nop 11
    v_max3_f32 v6, v6, v120, v121
    v_max3_f32 v6, v6, v122, v123
    v_max3_f32 v6, v6, v124, v125
    v_max3_f32 v6, v6, v126, v127
    v_max3_f32 v6, v6, v128, v129
    v_max3_f32 v6, v6, v130, v131
    v_max3_f32 v6, v6, v132, v133
    v_max3_f32 v6, v6, v134, v135
    v_mfma_f32_32x32x16_bf16 v[120:135], v[20:23], v[232:235], 0
    s_nop 11
    v_max3_f32 v6, v6, v120, v121
    v_max3_f32 v6, v6, v122, v123
    v_max3_f32 v6, v6, v124, v125
    v_max3_f32 v6, v6, v126, v127
    v_max3_f32 v6, v6, v128, v129
    v_max3_f32 v6, v6, v130, v131
    v_max3_f32 v6, v6, v132, v133
    v_max3_f32 v6, v6, v134, v135
    v_mfma_f32_32x32x16_bf16 v[120:135], v[24:27], v[232:235], 0
    s_nop 11
    v_max3_f32 v6, v6, v120, v121
    v_max3_f32 v6, v6, v122, v123
    v_max3_f32 v6, v6, v124, v125
    v_max3_f32 v6, v6, v126, v127
    v_max3_f32 v6, v6, v128, v129
    v_max3_f32 v6, v6, v130, v131
    v_max3_f32 v6, v6, v132, v133
    v_max3_f32 v6, v6, v134, v135
    v_mfma_f32_32x32x16_bf16 v[120:135], v[28:31], v[232:235], 0
    s_nop 11
    v_max3_f32 v6, v6, v120, v121
    v_max3_f32 v6, v6, v122, v123
    v_max3_f32 v6, v6, v124, v125
    v_max3_f32 v6, v6, v126, v127
    v_max3_f32 v6, v6, v128, v129
    v_max3_f32 v6, v6, v130, v131
    v_max3_f32 v6, v6, v132, v133
    v_max3_f32 v6, v6, v134, v135
    v_mfma_f32_32x32x16_bf16 v[120:135], v[32:35], v[232:235], 0
    s_nop 11
    v_max3_f32 v6, v6, v120, v121
    v_max3_f32 v6, v6, v122, v123
    v_max3_f32 v6, v6, v124, v125
    v_max3_f32 v6, v6, v126, v127
    v_max3_f32 v6, v6, v128, v129
    v_max3_f32 v6, v6, v130, v131
    v_max3_f32 v6, v6, v132, v133
    v_max3_f32 v6, v6, v134, v135
    v_mfma_f32_32x32x16_bf16 v[120:135], v[36:39], v[232:235], 0
    s_nop 11
    v_max3_f32 v6, v6, v120, v121
    v_max3_f32 v6, v6, v122, v123
    v_max3_f32 v6, v6, v124, v125
    v_max3_f32 v6, v6, v126, v127
    v_max3_f32 v6, v6, v128, v129
    v_max3_f32 v6, v6, v130, v131
    v_max3_f32 v6, v6, v132, v133
    v_max3_f32 v6, v6, v134, v135
    v_mfma_f32_32x32x16_bf16 v[120:135], v[40:43], v[232:235], 0
    s_nop 11
    v_max3_f32 v6, v6, v120, v121
    v_max3_f32 v6, v6, v122, v123
    v_max3_f32 v6, v6, v124, v125
    v_max3_f32 v6, v6, v126, v127
    v_max3_f32 v6, v6, v128, v129
    v_max3_f32 v6, v6, v130, v131
    v_max3_f32 v6, v6, v132, v133
    v_max3_f32 v6, v6, v134, v135
    v_mfma_f32_32x32x16_bf16 v[120:135], v[44:47], v[232:235], 0
    s_nop 11
    v_max3_f32 v6, v6, v120, v121
    v_max3_f32 v6, v6, v122, v123
    v_max3_f32 v6, v6, v124, v125
    v_max3_f32 v6, v6, v126, v127
    v_max3_f32 v6, v6, v128, v129
    v_max3_f32 v6, v6, v130, v131
    v_max3_f32 v6, v6, v132, v133
    v_max3_f32 v6, v6, v134, v135
    ds_max_f32 v12, v6 offset:20608
    s_add_u32 s22, s33, 2
    s_and_b32 s22, s22, 7
    s_lshl_b32 s22, s22, 10
    s_add_u32 s22, s22, s21
    buffer_load_dwordx4 v[232:235], v2, s[12:15], s22 offen sc1
    v_mov_b32 v6, 0xff800000
    s_waitcnt vmcnt(0)
    v_mfma_f32_32x32x16_bf16 v[120:135], v[16:19], v[232:235], 0
    s_nop 11
    v_max3_f32 v6, v6, v120, v121
    v_max3_f32 v6, v6, v122, v123
    v_max3_f32 v6, v6, v124, v125
    v_max3_f32 v6, v6, v126, v127
    v_max3_f32 v6, v6, v128, v129
    v_max3_f32 v6, v6, v130, v131
    v_max3_f32 v6, v6, v132, v133
    v_max3_f32 v6, v6, v134, v135
    v_mfma_f32_32x32x16_bf16 v[120:135], v[20:23], v[232:235], 0
    s_nop 11
    v_max3_f32 v6, v6, v120, v121
    v_max3_f32 v6, v6, v122, v123
    v_max3_f32 v6, v6, v124, v125
    v_max3_f32 v6, v6, v126, v127
    v_max3_f32 v6, v6, v128, v129
    v_max3_f32 v6, v6, v130, v131
    v_max3_f32 v6, v6, v132, v133
    v_max3_f32 v6, v6, v134, v135
    v_mfma_f32_32x32x16_bf16 v[120:135], v[24:27], v[232:235], 0
    s_nop 11
    v_max3_f32 v6, v6, v120, v121
    v_max3_f32 v6, v6, v122, v123
    v_max3_f32 v6, v6, v124, v125
    v_max3_f32 v6, v6, v126, v127
    v_max3_f32 v6, v6, v128, v129
    v_max3_f32 v6, v6, v130, v131
    v_max3_f32 v6, v6, v132, v133
    v_max3_f32 v6, v6, v134, v135
    v_mfma_f32_32x32x16_bf16 v[120:135], v[28:31], v[232:235], 0
    s_nop 11
    v_max3_f32 v6, v6, v120, v121
    v_max3_f32 v6, v6, v122, v123
    v_max3_f32 v6, v6, v124, v125
    v_max3_f32 v6, v6, v126, v127
    v_max3_f32 v6, v6, v128, v129
    v_max3_f32 v6, v6, v130, v131
    v_max3_f32 v6, v6, v132, v133
    v_max3_f32 v6, v6, v134, v135
    v_mfma_f32_32x32x16_bf16 v[120:135], v[32:35], v[232:235], 0
    s_nop 11
    v_max3_f32 v6, v6, v120, v121
    v_max3_f32 v6, v6, v122, v123
    v_max3_f32 v6, v6, v124, v125
    v_max3_f32 v6, v6, v126, v127
    v_max3_f32 v6, v6, v128, v129
    v_max3_f32 v6, v6, v130, v131
    v_max3_f32 v6, v6, v132, v133
    v_max3_f32 v6, v6, v134, v135
    v_mfma_f32_32x32x16_bf16 v[120:135], v[36:39], v[232:235], 0
    s_nop 11
    v_max3_f32 v6, v6, v120, v121
    v_max3_f32 v6, v6, v122, v123
    v_max3_f32 v6, v6, v124, v125
    v_max3_f32 v6, v6, v126, v127
    v_max3_f32 v6, v6, v128, v129
    v_max3_f32 v6, v6, v130, v131
    v_max3_f32 v6, v6, v132, v133
    v_max3_f32 v6, v6, v134, v135
    v_mfma_f32_32x32x16_bf16 v[120:135], v[40:43], v[232:235], 0
    s_nop 11
    v_max3_f32 v6, v6, v120, v121
    v_max3_f32 v6, v6, v122, v123
    v_max3_f32 v6, v6, v124, v125
    v_max3_f32 v6, v6, v126, v127
    v_max3_f32 v6, v6, v128, v129
    v_max3_f32 v6, v6, v130, v131
    v_max3_f32 v6, v6, v132, v133
    v_max3_f32 v6, v6, v134, v135
    v_mfma_f32_32x32x16_bf16 v[120:135], v[44:47], v[232:235], 0
    s_nop 11
    v_max3_f32 v6, v6, v120, v121
    v_max3_f32 v6, v6, v122, v123
    v_max3_f32 v6, v6, v124, v125
    v_max3_f32 v6, v6, v126, v127
    v_max3_f32 v6, v6, v128, v129
    v_max3_f32 v6, v6, v130, v131
    v_max3_f32 v6, v6, v132, v133
    v_max3_f32 v6, v6, v134, v135
    ds_max_f32 v12, v6 offset:20736
    s_add_u32 s22, s33, 3
    s_and_b32 s22, s22, 7
    s_lshl_b32 s22, s22, 10
    s_add_u32 s22, s22, s21
    buffer_load_dwordx4 v[232:235], v2, s[12:15], s22 offen sc1
    v_mov_b32 v6, 0xff800000
    s_waitcnt vmcnt(0)
    v_mfma_f32_32x32x16_bf16 v[120:135], v[16:19], v[232:235], 0
    s_nop 11
    v_max3_f32 v6, v6, v120, v121
    v_max3_f32 v6, v6, v122, v123
    v_max3_f32 v6, v6, v124, v125
    v_max3_f32 v6, v6, v126, v127
    v_max3_f32 v6, v6, v128, v129
    v_max3_f32 v6, v6, v130, v131
    v_max3_f32 v6, v6, v132, v133
    v_max3_f32 v6, v6, v134, v135
    v_mfma_f32_32x32x16_bf16 v[120:135], v[20:23], v[232:235], 0
    s_nop 11
    v_max3_f32 v6, v6, v120, v121
    v_max3_f32 v6, v6, v122, v123
    v_max3_f32 v6, v6, v124, v125
    v_max3_f32 v6, v6, v126, v127
    v_max3_f32 v6, v6, v128, v129
    v_max3_f32 v6, v6, v130, v131
    v_max3_f32 v6, v6, v132, v133
    v_max3_f32 v6, v6, v134, v135
    v_mfma_f32_32x32x16_bf16 v[120:135], v[24:27], v[232:235], 0
    s_nop 11
    v_max3_f32 v6, v6, v120, v121
    v_max3_f32 v6, v6, v122, v123
    v_max3_f32 v6, v6, v124, v125
    v_max3_f32 v6, v6, v126, v127
    v_max3_f32 v6, v6, v128, v129
    v_max3_f32 v6, v6, v130, v131
    v_max3_f32 v6, v6, v132, v133
    v_max3_f32 v6, v6, v134, v135
    v_mfma_f32_32x32x16_bf16 v[120:135], v[28:31], v[232:235], 0
    s_nop 11
    v_max3_f32 v6, v6, v120, v121
    v_max3_f32 v6, v6, v122, v123
    v_max3_f32 v6, v6, v124, v125
    v_max3_f32 v6, v6, v126, v127
    v_max3_f32 v6, v6, v128, v129
    v_max3_f32 v6, v6, v130, v131
    v_max3_f32 v6, v6, v132, v133
    v_max3_f32 v6, v6, v134, v135
    v_mfma_f32_32x32x16_bf16 v[120:135], v[32:35], v[232:235], 0
    s_nop 11
    v_max3_f32 v6, v6, v120, v121
    v_max3_f32 v6, v6, v122, v123
    v_max3_f32 v6, v6, v124, v125
    v_max3_f32 v6, v6, v126, v127
    v_max3_f32 v6, v6, v128, v129
    v_max3_f32 v6, v6, v130, v131
    v_max3_f32 v6, v6, v132, v133
    v_max3_f32 v6, v6, v134, v135
    v_mfma_f32_32x32x16_bf16 v[120:135], v[36:39], v[232:235], 0
    s_nop 11
    v_max3_f32 v6, v6, v120, v121
    v_max3_f32 v6, v6, v122, v123
    v_max3_f32 v6, v6, v124, v125
    v_max3_f32 v6, v6, v126, v127
    v_max3_f32 v6, v6, v128, v129
    v_max3_f32 v6, v6, v130, v131
    v_max3_f32 v6, v6, v132, v133
    v_max3_f32 v6, v6, v134, v135
    v_mfma_f32_32x32x16_bf16 v[120:135], v[40:43], v[232:235], 0
    s_nop 11
    v_max3_f32 v6, v6, v120, v121
    v_max3_f32 v6, v6, v122, v123
    v_max3_f32 v6, v6, v124, v125
    v_max3_f32 v6, v6, v126, v127
    v_max3_f32 v6, v6, v128, v129
    v_max3_f32 v6, v6, v130, v131
    v_max3_f32 v6, v6, v132, v133
    v_max3_f32 v6, v6, v134, v135
    v_mfma_f32_32x32x16_bf16 v[120:135], v[44:47], v[232:235], 0
    s_nop 11
    v_max3_f32 v6, v6, v120, v121
    v_max3_f32 v6, v6, v122, v123
    v_max3_f32 v6, v6, v124, v125
    v_max3_f32 v6, v6, v126, v127
    v_max3_f32 v6, v6, v128, v129
    v_max3_f32 v6, v6, v130, v131
    v_max3_f32 v6, v6, v132, v133
    v_max3_f32 v6, v6, v134, v135
    ds_max_f32 v12, v6 offset:20864
    s_add_u32 s22, s33, 4
    s_and_b32 s22, s22, 7
    s_lshl_b32 s22, s22, 10
    s_add_u32 s22, s22, s21
    buffer_load_dwordx4 v[232:235], v2, s[12:15], s22 offen sc1
    v_mov_b32 v6, 0xff800000
    s_waitcnt vmcnt(0)
    v_mfma_f32_32x32x16_bf16 v[120:135], v[16:19], v[232:235], 0
    s_nop 11
    v_max3_f32 v6, v6, v120, v121
    v_max3_f32 v6, v6, v122, v123
    v_max3_f32 v6, v6, v124, v125
    v_max3_f32 v6, v6, v126, v127
    v_max3_f32 v6, v6, v128, v129
    v_max3_f32 v6, v6, v130, v131
    v_max3_f32 v6, v6, v132, v133
    v_max3_f32 v6, v6, v134, v135
    v_mfma_f32_32x32x16_bf16 v[120:135], v[20:23], v[232:235], 0
    s_nop 11
    v_max3_f32 v6, v6, v120, v121
    v_max3_f32 v6, v6, v122, v123
    v_max3_f32 v6, v6, v124, v125
    v_max3_f32 v6, v6, v126, v127
    v_max3_f32 v6, v6, v128, v129
    v_max3_f32 v6, v6, v130, v131
    v_max3_f32 v6, v6, v132, v133
    v_max3_f32 v6, v6, v134, v135
    v_mfma_f32_32x32x16_bf16 v[120:135], v[24:27], v[232:235], 0
    s_nop 11
    v_max3_f32 v6, v6, v120, v121
    v_max3_f32 v6, v6, v122, v123
    v_max3_f32 v6, v6, v124, v125
    v_max3_f32 v6, v6, v126, v127
    v_max3_f32 v6, v6, v128, v129
    v_max3_f32 v6, v6, v130, v131
    v_max3_f32 v6, v6, v132, v133
    v_max3_f32 v6, v6, v134, v135
    v_mfma_f32_32x32x16_bf16 v[120:135], v[28:31], v[232:235], 0
    s_nop 11
    v_max3_f32 v6, v6, v120, v121
    v_max3_f32 v6, v6, v122, v123
    v_max3_f32 v6, v6, v124, v125
    v_max3_f32 v6, v6, v126, v127
    v_max3_f32 v6, v6, v128, v129
    v_max3_f32 v6, v6, v130, v131
    v_max3_f32 v6, v6, v132, v133
    v_max3_f32 v6, v6, v134, v135
    v_mfma_f32_32x32x16_bf16 v[120:135], v[32:35], v[232:235], 0
    s_nop 11
    v_max3_f32 v6, v6, v120, v121
    v_max3_f32 v6, v6, v122, v123
    v_max3_f32 v6, v6, v124, v125
    v_max3_f32 v6, v6, v126, v127
    v_max3_f32 v6, v6, v128, v129
    v_max3_f32 v6, v6, v130, v131
    v_max3_f32 v6, v6, v132, v133
    v_max3_f32 v6, v6, v134, v135
    v_mfma_f32_32x32x16_bf16 v[120:135], v[36:39], v[232:235], 0
    s_nop 11
    v_max3_f32 v6, v6, v120, v121
    v_max3_f32 v6, v6, v122, v123
    v_max3_f32 v6, v6, v124, v125
    v_max3_f32 v6, v6, v126, v127
    v_max3_f32 v6, v6, v128, v129
    v_max3_f32 v6, v6, v130, v131
    v_max3_f32 v6, v6, v132, v133
    v_max3_f32 v6, v6, v134, v135
    v_mfma_f32_32x32x16_bf16 v[120:135], v[40:43], v[232:235], 0
    s_nop 11
    v_max3_f32 v6, v6, v120, v121
    v_max3_f32 v6, v6, v122, v123
    v_max3_f32 v6, v6, v124, v125
    v_max3_f32 v6, v6, v126, v127
    v_max3_f32 v6, v6, v128, v129
    v_max3_f32 v6, v6, v130, v131
    v_max3_f32 v6, v6, v132, v133
    v_max3_f32 v6, v6, v134, v135
    v_mfma_f32_32x32x16_bf16 v[120:135], v[44:47], v[232:235], 0
    s_nop 11
    v_max3_f32 v6, v6, v120, v121
    v_max3_f32 v6, v6, v122, v123
    v_max3_f32 v6, v6, v124, v125
    v_max3_f32 v6, v6, v126, v127
    v_max3_f32 v6, v6, v128, v129
    v_max3_f32 v6, v6, v130, v131
    v_max3_f32 v6, v6, v132, v133
    v_max3_f32 v6, v6, v134, v135
    ds_max_f32 v12, v6 offset:20992
    s_add_u32 s22, s33, 5
    s_and_b32 s22, s22, 7
    s_lshl_b32 s22, s22, 10
    s_add_u32 s22, s22, s21
    buffer_load_dwordx4 v[232:235], v2, s[12:15], s22 offen sc1
    v_mov_b32 v6, 0xff800000
    s_waitcnt vmcnt(0)
    v_mfma_f32_32x32x16_bf16 v[120:135], v[16:19], v[232:235], 0
    s_nop 11
    v_max3_f32 v6, v6, v120, v121
    v_max3_f32 v6, v6, v122, v123
    v_max3_f32 v6, v6, v124, v125
    v_max3_f32 v6, v6, v126, v127
    v_max3_f32 v6, v6, v128, v129
    v_max3_f32 v6, v6, v130, v131
    v_max3_f32 v6, v6, v132, v133
    v_max3_f32 v6, v6, v134, v135
    v_mfma_f32_32x32x16_bf16 v[120:135], v[20:23], v[232:235], 0
    s_nop 11
    v_max3_f32 v6, v6, v120, v121
    v_max3_f32 v6, v6, v122, v123
    v_max3_f32 v6, v6, v124, v125
    v_max3_f32 v6, v6, v126, v127
    v_max3_f32 v6, v6, v128, v129
    v_max3_f32 v6, v6, v130, v131
    v_max3_f32 v6, v6, v132, v133
    v_max3_f32 v6, v6, v134, v135
    v_mfma_f32_32x32x16_bf16 v[120:135], v[24:27], v[232:235], 0
    s_nop 11
    v_max3_f32 v6, v6, v120, v121
    v_max3_f32 v6, v6, v122, v123
    v_max3_f32 v6, v6, v124, v125
    v_max3_f32 v6, v6, v126, v127
    v_max3_f32 v6, v6, v128, v129
    v_max3_f32 v6, v6, v130, v131
    v_max3_f32 v6, v6, v132, v133
    v_max3_f32 v6, v6, v134, v135
    v_mfma_f32_32x32x16_bf16 v[120:135], v[28:31], v[232:235], 0
    s_nop 11
    v_max3_f32 v6, v6, v120, v121
    v_max3_f32 v6, v6, v122, v123
    v_max3_f32 v6, v6, v124, v125
    v_max3_f32 v6, v6, v126, v127
    v_max3_f32 v6, v6, v128, v129
    v_max3_f32 v6, v6, v130, v131
    v_max3_f32 v6, v6, v132, v133
    v_max3_f32 v6, v6, v134, v135
    v_mfma_f32_32x32x16_bf16 v[120:135], v[32:35], v[232:235], 0
    s_nop 11
    v_max3_f32 v6, v6, v120, v121
    v_max3_f32 v6, v6, v122, v123
    v_max3_f32 v6, v6, v124, v125
    v_max3_f32 v6, v6, v126, v127
    v_max3_f32 v6, v6, v128, v129
    v_max3_f32 v6, v6, v130, v131
    v_max3_f32 v6, v6, v132, v133
    v_max3_f32 v6, v6, v134, v135
    v_mfma_f32_32x32x16_bf16 v[120:135], v[36:39], v[232:235], 0
    s_nop 11
    v_max3_f32 v6, v6, v120, v121
    v_max3_f32 v6, v6, v122, v123
    v_max3_f32 v6, v6, v124, v125
    v_max3_f32 v6, v6, v126, v127
    v_max3_f32 v6, v6, v128, v129
    v_max3_f32 v6, v6, v130, v131
    v_max3_f32 v6, v6, v132, v133
    v_max3_f32 v6, v6, v134, v135
    v_mfma_f32_32x32x16_bf16 v[120:135], v[40:43], v[232:235], 0
    s_nop 11
    v_max3_f32 v6, v6, v120, v121
    v_max3_f32 v6, v6, v122, v123
    v_max3_f32 v6, v6, v124, v125
    v_max3_f32 v6, v6, v126, v127
    v_max3_f32 v6, v6, v128, v129
    v_max3_f32 v6, v6, v130, v131
    v_max3_f32 v6, v6, v132, v133
    v_max3_f32 v6, v6, v134, v135
    v_mfma_f32_32x32x16_bf16 v[120:135], v[44:47], v[232:235], 0
    s_nop 11
    v_max3_f32 v6, v6, v120, v121
    v_max3_f32 v6, v6, v122, v123
    v_max3_f32 v6, v6, v124, v125
    v_max3_f32 v6, v6, v126, v127
    v_max3_f32 v6, v6, v128, v129
    v_max3_f32 v6, v6, v130, v131
    v_max3_f32 v6, v6, v132, v133
    v_max3_f32 v6, v6, v134, v135
    ds_max_f32 v12, v6 offset:21120
    s_add_u32 s22, s33, 6
    s_and_b32 s22, s22, 7
    s_lshl_b32 s22, s22, 10
    s_add_u32 s22, s22, s21
    buffer_load_dwordx4 v[232:235], v2, s[12:15], s22 offen sc1
    v_mov_b32 v6, 0xff800000
    s_waitcnt vmcnt(0)
    v_mfma_f32_32x32x16_bf16 v[120:135], v[16:19], v[232:235], 0
    s_nop 11
    v_max3_f32 v6, v6, v120, v121
    v_max3_f32 v6, v6, v122, v123
    v_max3_f32 v6, v6, v124, v125
    v_max3_f32 v6, v6, v126, v127
    v_max3_f32 v6, v6, v128, v129
    v_max3_f32 v6, v6, v130, v131
    v_max3_f32 v6, v6, v132, v133
    v_max3_f32 v6, v6, v134, v135
    v_mfma_f32_32x32x16_bf16 v[120:135], v[20:23], v[232:235], 0
    s_nop 11
    v_max3_f32 v6, v6, v120, v121
    v_max3_f32 v6, v6, v122, v123
    v_max3_f32 v6, v6, v124, v125
    v_max3_f32 v6, v6, v126, v127
    v_max3_f32 v6, v6, v128, v129
    v_max3_f32 v6, v6, v130, v131
    v_max3_f32 v6, v6, v132, v133
    v_max3_f32 v6, v6, v134, v135
    v_mfma_f32_32x32x16_bf16 v[120:135], v[24:27], v[232:235], 0
    s_nop 11
    v_max3_f32 v6, v6, v120, v121
    v_max3_f32 v6, v6, v122, v123
    v_max3_f32 v6, v6, v124, v125
    v_max3_f32 v6, v6, v126, v127
    v_max3_f32 v6, v6, v128, v129
    v_max3_f32 v6, v6, v130, v131
    v_max3_f32 v6, v6, v132, v133
    v_max3_f32 v6, v6, v134, v135
    v_mfma_f32_32x32x16_bf16 v[120:135], v[28:31], v[232:235], 0
    s_nop 11
    v_max3_f32 v6, v6, v120, v121
    v_max3_f32 v6, v6, v122, v123
    v_max3_f32 v6, v6, v124, v125
    v_max3_f32 v6, v6, v126, v127
    v_max3_f32 v6, v6, v128, v129
    v_max3_f32 v6, v6, v130, v131
    v_max3_f32 v6, v6, v132, v133
    v_max3_f32 v6, v6, v134, v135
    v_mfma_f32_32x32x16_bf16 v[120:135], v[32:35], v[232:235], 0
    s_nop 11
    v_max3_f32 v6, v6, v120, v121
    v_max3_f32 v6, v6, v122, v123
    v_max3_f32 v6, v6, v124, v125
    v_max3_f32 v6, v6, v126, v127
    v_max3_f32 v6, v6, v128, v129
    v_max3_f32 v6, v6, v130, v131
    v_max3_f32 v6, v6, v132, v133
    v_max3_f32 v6, v6, v134, v135
    v_mfma_f32_32x32x16_bf16 v[120:135], v[36:39], v[232:235], 0
    s_nop 11
    v_max3_f32 v6, v6, v120, v121
    v_max3_f32 v6, v6, v122, v123
    v_max3_f32 v6, v6, v124, v125
    v_max3_f32 v6, v6, v126, v127
    v_max3_f32 v6, v6, v128, v129
    v_max3_f32 v6, v6, v130, v131
    v_max3_f32 v6, v6, v132, v133
    v_max3_f32 v6, v6, v134, v135
    v_mfma_f32_32x32x16_bf16 v[120:135], v[40:43], v[232:235], 0
    s_nop 11
    v_max3_f32 v6, v6, v120, v121
    v_max3_f32 v6, v6, v122, v123
    v_max3_f32 v6, v6, v124, v125
    v_max3_f32 v6, v6, v126, v127
    v_max3_f32 v6, v6, v128, v129
    v_max3_f32 v6, v6, v130, v131
    v_max3_f32 v6, v6, v132, v133
    v_max3_f32 v6, v6, v134, v135
    v_mfma_f32_32x32x16_bf16 v[120:135], v[44:47], v[232:235], 0
    s_nop 11
    v_max3_f32 v6, v6, v120, v121
    v_max3_f32 v6, v6, v122, v123
    v_max3_f32 v6, v6, v124, v125
    v_max3_f32 v6, v6, v126, v127
    v_max3_f32 v6, v6, v128, v129
    v_max3_f32 v6, v6, v130, v131
    v_max3_f32 v6, v6, v132, v133
    v_max3_f32 v6, v6, v134, v135
    ds_max_f32 v12, v6 offset:21248
    s_add_u32 s22, s33, 7
    s_and_b32 s22, s22, 7
    s_lshl_b32 s22, s22, 10
    s_add_u32 s22, s22, s21
    buffer_load_dwordx4 v[232:235], v2, s[12:15], s22 offen sc1
    v_mov_b32 v6, 0xff800000
    s_waitcnt vmcnt(0)
    v_mfma_f32_32x32x16_bf16 v[120:135], v[16:19], v[232:235], 0
    s_nop 11
    v_max3_f32 v6, v6, v120, v121
    v_max3_f32 v6, v6, v122, v123
    v_max3_f32 v6, v6, v124, v125
    v_max3_f32 v6, v6, v126, v127
    v_max3_f32 v6, v6, v128, v129
    v_max3_f32 v6, v6, v130, v131
    v_max3_f32 v6, v6, v132, v133
    v_max3_f32 v6, v6, v134, v135
    v_mfma_f32_32x32x16_bf16 v[120:135], v[20:23], v[232:235], 0
    s_nop 11
    v_max3_f32 v6, v6, v120, v121
    v_max3_f32 v6, v6, v122, v123
    v_max3_f32 v6, v6, v124, v125
    v_max3_f32 v6, v6, v126, v127
    v_max3_f32 v6, v6, v128, v129
    v_max3_f32 v6, v6, v130, v131
    v_max3_f32 v6, v6, v132, v133
    v_max3_f32 v6, v6, v134, v135
    v_mfma_f32_32x32x16_bf16 v[120:135], v[24:27], v[232:235], 0
    s_nop 11
    v_max3_f32 v6, v6, v120, v121
    v_max3_f32 v6, v6, v122, v123
    v_max3_f32 v6, v6, v124, v125
    v_max3_f32 v6, v6, v126, v127
    v_max3_f32 v6, v6, v128, v129
    v_max3_f32 v6, v6, v130, v131
    v_max3_f32 v6, v6, v132, v133
    v_max3_f32 v6, v6, v134, v135
    v_mfma_f32_32x32x16_bf16 v[120:135], v[28:31], v[232:235], 0
    s_nop 11
    v_max3_f32 v6, v6, v120, v121
    v_max3_f32 v6, v6, v122, v123
    v_max3_f32 v6, v6, v124, v125
    v_max3_f32 v6, v6, v126, v127
    v_max3_f32 v6, v6, v128, v129
    v_max3_f32 v6, v6, v130, v131
    v_max3_f32 v6, v6, v132, v133
    v_max3_f32 v6, v6, v134, v135
    v_mfma_f32_32x32x16_bf16 v[120:135], v[32:35], v[232:235], 0
    s_nop 11
    v_max3_f32 v6, v6, v120, v121
    v_max3_f32 v6, v6, v122, v123
    v_max3_f32 v6, v6, v124, v125
    v_max3_f32 v6, v6, v126, v127
    v_max3_f32 v6, v6, v128, v129
    v_max3_f32 v6, v6, v130, v131
    v_max3_f32 v6, v6, v132, v133
    v_max3_f32 v6, v6, v134, v135
    v_mfma_f32_32x32x16_bf16 v[120:135], v[36:39], v[232:235], 0
    s_nop 11
    v_max3_f32 v6, v6, v120, v121
    v_max3_f32 v6, v6, v122, v123
    v_max3_f32 v6, v6, v124, v125
    v_max3_f32 v6, v6, v126, v127
    v_max3_f32 v6, v6, v128, v129
    v_max3_f32 v6, v6, v130, v131
    v_max3_f32 v6, v6, v132, v133
    v_max3_f32 v6, v6, v134, v135
    v_mfma_f32_32x32x16_bf16 v[120:135], v[40:43], v[232:235], 0
    s_nop 11
    v_max3_f32 v6, v6, v120, v121
    v_max3_f32 v6, v6, v122, v123
    v_max3_f32 v6, v6, v124, v125
    v_max3_f32 v6, v6, v126, v127
    v_max3_f32 v6, v6, v128, v129
    v_max3_f32 v6, v6, v130, v131
    v_max3_f32 v6, v6, v132, v133
    v_max3_f32 v6, v6, v134, v135
    v_mfma_f32_32x32x16_bf16 v[120:135], v[44:47], v[232:235], 0
    s_nop 11
    v_max3_f32 v6, v6, v120, v121
    v_max3_f32 v6, v6, v122, v123
    v_max3_f32 v6, v6, v124, v125
    v_max3_f32 v6, v6, v126, v127
    v_max3_f32 v6, v6, v128, v129
    v_max3_f32 v6, v6, v130, v131
    v_max3_f32 v6, v6, v132, v133
    v_max3_f32 v6, v6, v134, v135
    ds_max_f32 v12, v6 offset:21376
    s_waitcnt lgkmcnt(0)
    s_barrier
    ds_read_b32 v240, v12 offset:20480
    s_waitcnt lgkmcnt(0)
    v_sub_f32 v240, 0, v240
    v_mov_b32 v241, v240
    v_mov_b32 v242, v240
    v_mov_b32 v243, v240
    v_mov_b32 v244, v240
    v_mov_b32 v245, v240
    v_mov_b32 v246, v240
    v_mov_b32 v247, v240
    v_mov_b32 v248, v240
    v_mov_b32 v249, v240
    v_mov_b32 v250, v240
    v_mov_b32 v251, v240
    v_mov_b32 v252, v240
    v_mov_b32 v253, v240
    v_mov_b32 v254, v240
    v_mov_b32 v255, v240
    s_nop 1
    s_waitcnt lgkmcnt(0)
    v_mfma_f32_32x32x16_bf16 v[152:167], v[236:239], v[236:239], 0
    v_mfma_f32_32x32x16_bf16 v[120:135], v[16:19], v[112:115], v[240:255]
    s_nop 11
    v_exp_f32 v120, v120
    v_exp_f32 v121, v121
    v_exp_f32 v122, v122
    v_exp_f32 v123, v123
    v_exp_f32 v124, v124
    v_mfma_f32_32x32x16_bf16 v[136:151], v[20:23], v[112:115], v[240:255]
    v_exp_f32 v125, v125
    v_exp_f32 v126, v126
    v_exp_f32 v127, v127
    v_exp_f32 v128, v128
    v_exp_f32 v129, v129
    v_exp_f32 v130, v130
    v_smfmac_f32_32x32x32_bf16 v[152:167], v[48:51], v[120:127], v14
    v_exp_f32 v131, v131
    v_exp_f32 v132, v132
    v_exp_f32 v133, v133
    v_exp_f32 v134, v134
    v_exp_f32 v135, v135
    v_exp_f32 v136, v136
    v_exp_f32 v137, v137
    v_smfmac_f32_32x32x32_bf16 v[152:167], v[52:55], v[128:135], v14
    v_exp_f32 v138, v138
    v_exp_f32 v139, v139
    v_exp_f32 v140, v140
    v_mfma_f32_32x32x16_bf16 v[120:135], v[24:27], v[112:115], v[240:255]
    v_exp_f32 v141, v141
    v_exp_f32 v142, v142
    v_exp_f32 v143, v143
    v_exp_f32 v144, v144
    v_exp_f32 v145, v145
    v_exp_f32 v146, v146
    v_smfmac_f32_32x32x32_bf16 v[152:167], v[56:59], v[136:143], v14
    v_exp_f32 v147, v147
    v_exp_f32 v148, v148
    v_exp_f32 v149, v149
    v_exp_f32 v150, v150
    v_exp_f32 v151, v151
    s_setprio 2
    v_exp_f32 v120, v120
    v_exp_f32 v121, v121
    v_smfmac_f32_32x32x32_bf16 v[152:167], v[60:63], v[144:151], v14
    v_exp_f32 v122, v122
    v_exp_f32 v123, v123
    v_exp_f32 v124, v124
    v_mfma_f32_32x32x16_bf16 v[136:151], v[28:31], v[112:115], v[240:255]
    v_exp_f32 v125, v125
    v_exp_f32 v126, v126
    v_exp_f32 v127, v127
    v_exp_f32 v128, v128
    v_exp_f32 v129, v129
    v_exp_f32 v130, v130
    v_smfmac_f32_32x32x32_bf16 v[152:167], v[64:67], v[120:127], v14
    v_exp_f32 v131, v131
    v_exp_f32 v132, v132
    v_exp_f32 v133, v133
    v_exp_f32 v134, v134
    v_exp_f32 v135, v135
    s_setprio 1
    v_exp_f32 v136, v136
    v_exp_f32 v137, v137
    v_smfmac_f32_32x32x32_bf16 v[152:167], v[68:71], v[128:135], v14
    v_exp_f32 v138, v138
    v_exp_f32 v139, v139
    v_exp_f32 v140, v140
    v_mfma_f32_32x32x16_bf16 v[120:135], v[32:35], v[112:115], v[240:255]
    v_exp_f32 v141, v141
    v_exp_f32 v142, v142
    v_exp_f32 v143, v143
    v_exp_f32 v144, v144
    v_exp_f32 v145, v145
    v_exp_f32 v146, v146
    v_smfmac_f32_32x32x32_bf16 v[152:167], v[72:75], v[136:143], v14
    v_exp_f32 v147, v147
    v_exp_f32 v148, v148
    v_exp_f32 v149, v149
    v_exp_f32 v150, v150
    v_exp_f32 v151, v151
    s_setprio 0
    v_exp_f32 v120, v120
    v_exp_f32 v121, v121
    v_smfmac_f32_32x32x32_bf16 v[152:167], v[76:79], v[144:151], v14
    v_exp_f32 v122, v122
    v_exp_f32 v123, v123
    v_exp_f32 v124, v124
    v_mfma_f32_32x32x16_bf16 v[136:151], v[36:39], v[112:115], v[240:255]
    v_exp_f32 v125, v125
    v_exp_f32 v126, v126
    v_exp_f32 v127, v127
    v_exp_f32 v128, v128
    v_exp_f32 v129, v129
    v_exp_f32 v130, v130
    v_smfmac_f32_32x32x32_bf16 v[152:167], v[80:83], v[120:127], v14
    v_exp_f32 v131, v131
    v_exp_f32 v132, v132
    v_exp_f32 v133, v133
    v_exp_f32 v134, v134
    v_exp_f32 v135, v135
    s_setprio 3
    s_waitcnt lgkmcnt(0)
    s_barrier
    v_exp_f32 v136, v136
    v_lshrrev_b32 v3, 3, v1
    v_mul_lo_u32 v3, v3, s61
    v_and_b32 v6, 0x70, v2
    v_add_u32 v3, v3, v6
    s_mov_b32 m0, s40
    s_mov_b32 s53, s60
    s_mov_b32 exec_hi, s41
    buffer_load_dwordx4 v3, s[56:59], s53 offen offset:0 lds
    s_add_u32 s53, s53, s32
    buffer_load_dwordx4 v3, s[56:59], s53 offen offset:1024 lds
    s_add_u32 s53, s53, s32
    buffer_load_dwordx4 v3, s[56:59], s53 offen offset:2048 lds
    s_add_u32 s53, s53, s32
    buffer_load_dwordx4 v3, s[56:59], s53 offen offset:3072 lds
    s_mov_b64 exec, -1
    v_exp_f32 v137, v137
    v_smfmac_f32_32x32x32_bf16 v[152:167], v[84:87], v[128:135], v14
    v_exp_f32 v138, v138
    v_mov_b32 v6, s92
    s_mov_b64 exec, 1
    buffer_store_dword v6, v4, s[12:15], s39 offen sc1
    s_mov_b64 exec, -1
    v_exp_f32 v139, v139
    v_exp_f32 v140, v140
    v_mfma_f32_32x32x16_bf16 v[120:135], v[40:43], v[112:115], v[240:255]
    v_exp_f32 v141, v141
    v_exp_f32 v142, v142
    v_exp_f32 v143, v143
    v_exp_f32 v144, v144
    v_exp_f32 v145, v145
    v_exp_f32 v146, v146
    v_smfmac_f32_32x32x32_bf16 v[152:167], v[88:91], v[136:143], v14
    v_exp_f32 v147, v147
    v_exp_f32 v148, v148
    v_exp_f32 v149, v149
    v_exp_f32 v150, v150
    v_exp_f32 v151, v151
    v_exp_f32 v120, v120
    v_exp_f32 v121, v121
    v_smfmac_f32_32x32x32_bf16 v[152:167], v[92:95], v[144:151], v14
    v_exp_f32 v122, v122
    v_exp_f32 v123, v123
    v_exp_f32 v124, v124
    v_mfma_f32_32x32x16_bf16 v[136:151], v[44:47], v[112:115], v[240:255]
    v_exp_f32 v125, v125
    v_exp_f32 v126, v126
    v_exp_f32 v127, v127
    v_exp_f32 v128, v128
    v_exp_f32 v129, v129
    v_exp_f32 v130, v130
    v_smfmac_f32_32x32x32_bf16 v[152:167], v[96:99], v[120:127], v14
    v_exp_f32 v131, v131
    v_exp_f32 v132, v132
    v_exp_f32 v133, v133
    v_exp_f32 v134, v134
    v_exp_f32 v135, v135
    s_setprio 2
    v_exp_f32 v136, v136
    v_exp_f32 v137, v137
    v_smfmac_f32_32x32x32_bf16 v[152:167], v[100:103], v[128:135], v14
    v_exp_f32 v138, v138
    v_exp_f32 v139, v139
    v_exp_f32 v140, v140
    ds_read_b32 v240, v12 offset:20608
    s_waitcnt lgkmcnt(0)
    v_sub_f32 v240, 0, v240
    v_mov_b32 v241, v240
    v_mov_b32 v242, v240
    v_mov_b32 v243, v240
    v_mov_b32 v244, v240
    v_mov_b32 v245, v240
    v_mov_b32 v246, v240
    v_mov_b32 v247, v240
    v_mov_b32 v248, v240
    v_mov_b32 v249, v240
    v_mov_b32 v250, v240
    v_mov_b32 v251, v240
    v_mov_b32 v252, v240
    v_mov_b32 v253, v240
    v_mov_b32 v254, v240
    v_mov_b32 v255, v240
    s_nop 1
    v_mfma_f32_32x32x16_bf16 v[120:135], v[16:19], v[116:119], v[240:255]
    v_exp_f32 v141, v141
    v_exp_f32 v142, v142
    v_exp_f32 v143, v143
    v_exp_f32 v144, v144
    v_exp_f32 v145, v145
    v_exp_f32 v146, v146
    v_smfmac_f32_32x32x32_bf16 v[152:167], v[104:107], v[136:143], v14
    v_exp_f32 v147, v147
    v_exp_f32 v148, v148
    v_exp_f32 v149, v149
    s_waitcnt lgkmcnt(0)
    v_mfma_f32_32x32x16_bf16 v[168:183], v[236:239], v[236:239], 0
    v_exp_f32 v150, v150
    v_exp_f32 v151, v151
    s_setprio 1
    v_exp_f32 v120, v120
    v_exp_f32 v121, v121
    v_smfmac_f32_32x32x32_bf16 v[152:167], v[108:111], v[144:151], v14
    v_exp_f32 v122, v122
    v_exp_f32 v123, v123
    v_exp_f32 v124, v124
    v_mfma_f32_32x32x16_bf16 v[136:151], v[20:23], v[116:119], v[240:255]
    v_exp_f32 v125, v125
    v_exp_f32 v126, v126
    v_exp_f32 v127, v127
    v_exp_f32 v128, v128
    v_exp_f32 v129, v129
    v_exp_f32 v130, v130
    v_smfmac_f32_32x32x32_bf16 v[168:183], v[48:51], v[120:127], v14
    v_exp_f32 v131, v131
    v_exp_f32 v132, v132
    v_exp_f32 v133, v133
    v_exp_f32 v134, v134
    ds_write2st64_b32 v7, v152, v153 offset0:0 offset1:1
    ds_write2st64_b32 v7, v154, v155 offset0:2 offset1:3
    ds_write2st64_b32 v7, v156, v157 offset0:4 offset1:5
    ds_write2st64_b32 v7, v158, v159 offset0:6 offset1:7
    ds_write_b32 v7, v160 offset:2048
    v_exp_f32 v135, v135
    s_setprio 0
    v_exp_f32 v136, v136
    v_exp_f32 v137, v137
    v_smfmac_f32_32x32x32_bf16 v[168:183], v[52:55], v[128:135], v14
    v_exp_f32 v138, v138
    v_exp_f32 v139, v139
    v_exp_f32 v140, v140
    v_mfma_f32_32x32x16_bf16 v[120:135], v[24:27], v[116:119], v[240:255]
    v_exp_f32 v141, v141
    v_exp_f32 v142, v142
    v_exp_f32 v143, v143
    v_exp_f32 v144, v144
    v_exp_f32 v145, v145
    v_exp_f32 v146, v146
    v_smfmac_f32_32x32x32_bf16 v[168:183], v[56:59], v[136:143], v14
    v_exp_f32 v147, v147
    v_exp_f32 v148, v148
    v_exp_f32 v149, v149
    v_exp_f32 v150, v150
    v_exp_f32 v151, v151
    s_setprio 3
    s_waitcnt lgkmcnt(0)
    s_barrier
    v_exp_f32 v120, v120
    ds_read2st64_b32 v[160:161], v4 offset0:8 offset1:17
    v_exp_f32 v121, v121
    v_smfmac_f32_32x32x32_bf16 v[168:183], v[60:63], v[144:151], v14
    v_exp_f32 v122, v122
    ds_read2st64_b32 v[162:163], v4 offset0:26 offset1:35
    v_exp_f32 v123, v123
    v_exp_f32 v124, v124
    v_mfma_f32_32x32x16_bf16 v[136:151], v[28:31], v[116:119], v[240:255]
    ds_read2st64_b32 v[164:165], v4 offset0:44 offset1:53
    v_exp_f32 v125, v125
    v_exp_f32 v126, v126
    ds_read2st64_b32 v[166:167], v4 offset0:62 offset1:71
    v_exp_f32 v127, v127
    v_exp_f32 v128, v128
    ds_read2st64_b32 v[152:153], v13 offset0:0 offset1:9
    v_exp_f32 v129, v129
    v_exp_f32 v130, v130
    v_smfmac_f32_32x32x32_bf16 v[168:183], v[64:67], v[120:127], v14
    ds_read2st64_b32 v[154:155], v13 offset0:18 offset1:27
    v_exp_f32 v131, v131
    v_exp_f32 v132, v132
    ds_read2st64_b32 v[156:157], v13 offset0:36 offset1:45
    v_exp_f32 v133, v133
    ds_read2st64_b32 v[158:159], v13 offset0:54 offset1:63
    v_exp_f32 v134, v134
    v_exp_f32 v135, v135
    s_setprio 2
    v_exp_f32 v136, v136
    v_exp_f32 v137, v137
    v_smfmac_f32_32x32x32_bf16 v[168:183], v[68:71], v[128:135], v14
    v_exp_f32 v138, v138
    v_exp_f32 v139, v139
    s_waitcnt lgkmcnt(0)
    v_pk_add_f32 v[160:161], v[160:161], v[162:163]
    v_pk_add_f32 v[164:165], v[164:165], v[166:167]
    v_pk_add_f32 v[152:153], v[152:153], v[154:155]
    v_pk_add_f32 v[156:157], v[156:157], v[158:159]
    v_pk_add_f32 v[160:161], v[160:161], v[164:165]
    v_pk_add_f32 v[152:153], v[152:153], v[156:157]
    v_add_f32 v160, v160, v161
    v_rcp_f32 v160, v160
    v_add_f32 v152, v152, v153
    v_exp_f32 v140, v140
    v_mfma_f32_32x32x16_bf16 v[120:135], v[32:35], v[116:119], v[240:255]
    v_mul_f32 v152, v152, v160
    v_cvt_pk_bf16_f32 v152, v152, v152
    ds_write_b16 v5, v152 offset:18432
    v_exp_f32 v141, v141
    v_exp_f32 v142, v142
    v_exp_f32 v143, v143
    v_exp_f32 v144, v144
    v_exp_f32 v145, v145
    v_exp_f32 v146, v146
    v_smfmac_f32_32x32x32_bf16 v[168:183], v[72:75], v[136:143], v14
    v_exp_f32 v147, v147
    v_exp_f32 v148, v148
    v_exp_f32 v149, v149
    v_exp_f32 v150, v150
    v_exp_f32 v151, v151
    s_setprio 3
    s_waitcnt lgkmcnt(0)
    s_barrier
    v_exp_f32 v120, v120
    v_exp_f32 v121, v121
    v_smfmac_f32_32x32x32_bf16 v[168:183], v[76:79], v[144:151], v14
    v_exp_f32 v122, v122
    v_exp_f32 v123, v123
    v_exp_f32 v124, v124
    v_mfma_f32_32x32x16_bf16 v[136:151], v[36:39], v[116:119], v[240:255]
    v_exp_f32 v125, v125
    v_exp_f32 v126, v126
    v_exp_f32 v127, v127
    v_exp_f32 v128, v128
    v_exp_f32 v129, v129
    v_exp_f32 v130, v130
    v_smfmac_f32_32x32x32_bf16 v[168:183], v[80:83], v[120:127], v14
    v_exp_f32 v131, v131
    s_waitcnt vmcnt(1)
    v_exp_f32 v132, v132
    s_add_u32 s22, s33, 2
    s_and_b32 s22, s22, 7
    s_lshl_b32 s22, s22, 10
    s_add_u32 s22, s22, s21
    buffer_load_dwordx4 v[112:115], v2, s[12:15], s22 offen sc1
    v_exp_f32 v133, v133
    v_exp_f32 v134, v134
    v_exp_f32 v135, v135
    v_exp_f32 v136, v136
    ds_read_b128 v[232:235], v2 offset:18432
    v_exp_f32 v137, v137
    v_smfmac_f32_32x32x32_bf16 v[168:183], v[84:87], v[128:135], v14
    v_exp_f32 v138, v138
    v_exp_f32 v139, v139
    v_exp_f32 v140, v140
    v_mfma_f32_32x32x16_bf16 v[120:135], v[40:43], v[116:119], v[240:255]
    v_exp_f32 v141, v141
    v_exp_f32 v142, v142
    v_exp_f32 v143, v143
    v_bfe_u32 v9, v1, 2, 2
    v_and_b32 v3, 3, v1
    s_cmp_ge_u32 s3, 4
    s_cbranch_scc1 L_pa22
    v_bfe_u32 v8, v1, 5, 1
    v_lshlrev_b32 v8, s31, v8
    v_add_lshl_u32 v8, v8, v9, 7
    v_bfe_u32 v9, v1, 4, 1
    v_lshl_add_u32 v8, v9, 5, v8
    v_lshl_add_u32 v8, v3, 3, v8
    v_add_u32 v3, s40, v8
    v_add_u32 v6, s95, v3
    s_branch L_pa22_e
L_pa22:
    v_lshrrev_b32 v6, 4, v1
    v_lshl_add_u32 v9, v6, 4, v9
    v_lshlrev_b32 v3, 3, v3
    v_lshl_add_u32 v3, v9, 7, v3
    s_lshl_b32 s53, s3, 5
    s_add_u32 s53, s53, 38784
    v_add_u32 v3, s53, v3
    v_lshlrev_b32 v6, 4, v6
    v_add_u32 v8, 152576, v6
L_pa22_e:
    v_exp_f32 v144, v144
    v_exp_f32 v145, v145
    v_exp_f32 v146, v146
    v_smfmac_f32_32x32x32_bf16 v[168:183], v[88:91], v[136:143], v14
    v_exp_f32 v147, v147
    v_exp_f32 v148, v148
    v_exp_f32 v149, v149
    s_waitcnt lgkmcnt(0)
    v_smfmac_f32_16x16x64_bf16 v[216:219], v[232:235], v[184:191], v15
    v_exp_f32 v150, v150
    v_exp_f32 v151, v151
    s_setprio 2
    v_smfmac_f32_16x16x64_bf16 v[220:223], v[232:235], v[192:199], v15
    v_exp_f32 v120, v120
    v_exp_f32 v121, v121
    v_smfmac_f32_32x32x32_bf16 v[168:183], v[92:95], v[144:151], v14
    v_exp_f32 v122, v122
    s_add_u32 s48, s33, 1
    s_and_b32 s48, s48, 7
    s_lshl_b32 s48, s48, 16
    s_add_u32 s48, s48, s27
    buffer_load_dwordx4 v[184:187], v2, s[12:15], s48 offen offset:0 sc1
    v_exp_f32 v123, v123
    v_exp_f32 v124, v124
    v_mfma_f32_32x32x16_bf16 v[136:151], v[44:47], v[116:119], v[240:255]
    v_exp_f32 v125, v125
    v_exp_f32 v126, v126
    buffer_load_dwordx4 v[188:191], v2, s[12:15], s48 offen offset:1024 sc1
    v_exp_f32 v127, v127
    v_smfmac_f32_16x16x64_bf16 v[224:227], v[232:235], v[200:207], v15
    v_exp_f32 v128, v128
    v_exp_f32 v129, v129
    v_exp_f32 v130, v130
    v_smfmac_f32_32x32x32_bf16 v[168:183], v[96:99], v[120:127], v14
    v_exp_f32 v131, v131
    buffer_load_dwordx4 v[192:195], v2, s[12:15], s48 offen offset:2048 sc1
    v_exp_f32 v132, v132
    v_exp_f32 v133, v133
    v_smfmac_f32_16x16x64_bf16 v[228:231], v[232:235], v[208:215], v15
    v_exp_f32 v134, v134
    v_exp_f32 v135, v135
    v_exp_f32 v136, v136
    v_exp_f32 v137, v137
    v_smfmac_f32_32x32x32_bf16 v[168:183], v[100:103], v[128:135], v14
    buffer_load_dwordx4 v[196:199], v2, s[12:15], s48 offen offset:3072 sc1
    v_exp_f32 v138, v138
    v_exp_f32 v139, v139
    v_exp_f32 v140, v140
    ds_read_b32 v240, v12 offset:20736
    s_waitcnt lgkmcnt(0)
    v_sub_f32 v240, 0, v240
    v_mov_b32 v241, v240
    v_mov_b32 v242, v240
    v_mov_b32 v243, v240
    v_mov_b32 v244, v240
    v_mov_b32 v245, v240
    v_mov_b32 v246, v240
    v_mov_b32 v247, v240
    v_mov_b32 v248, v240
    v_mov_b32 v249, v240
    v_mov_b32 v250, v240
    v_mov_b32 v251, v240
    v_mov_b32 v252, v240
    v_mov_b32 v253, v240
    v_mov_b32 v254, v240
    v_mov_b32 v255, v240
    s_nop 1
    s_waitcnt vmcnt(4)
    v_mfma_f32_32x32x16_bf16 v[120:135], v[16:19], v[112:115], v[240:255]
    v_exp_f32 v141, v141
    v_exp_f32 v142, v142
    s_add_u32 s48, s48, 4096
    buffer_load_dwordx4 v[200:203], v2, s[12:15], s48 offen offset:0 sc1
    v_exp_f32 v143, v143
    v_exp_f32 v144, v144
    v_exp_f32 v145, v145
    s_cmp_ge_u32 s3, 3
    s_cbranch_scc1 L_pp23
    ds_read_b64_tr_b16 v[8:9], v3 offset:0
    ds_read_b64_tr_b16 v[10:11], v6 offset:0
L_pp23:
    v_exp_f32 v146, v146
    v_smfmac_f32_32x32x32_bf16 v[168:183], v[104:107], v[136:143], v14
    v_exp_f32 v147, v147
    buffer_load_dwordx4 v[204:207], v2, s[12:15], s48 offen offset:1024 sc1
    v_exp_f32 v148, v148
    v_exp_f32 v149, v149
    s_waitcnt lgkmcnt(0)
    v_mfma_f32_32x32x16_bf16 v[152:167], v[236:239], v[236:239], 0
    v_exp_f32 v150, v150
    v_exp_f32 v151, v151
    s_setprio 1
    v_exp_f32 v120, v120
    s_cmp_ge_u32 s3, 3
    s_cbranch_scc1 L_pp24
    s_waitcnt lgkmcnt(0)
    buffer_store_dwordx4 v[8:11], v2, s[12:15], s93 offen offset:0 sc1
L_pp24:
    v_exp_f32 v121, v121
    v_smfmac_f32_32x32x32_bf16 v[168:183], v[108:111], v[144:151], v14
    v_exp_f32 v122, v122
    buffer_load_dwordx4 v[208:211], v2, s[12:15], s48 offen offset:2048 sc1
    v_exp_f32 v123, v123
    v_exp_f32 v124, v124
    v_mfma_f32_32x32x16_bf16 v[136:151], v[20:23], v[112:115], v[240:255]
    v_exp_f32 v125, v125
    s_cmp_ge_u32 s3, 3
    s_cbranch_scc1 L_pp25
    ds_read_b64_tr_b16 v[8:9], v3 offset:2048
    ds_read_b64_tr_b16 v[10:11], v6 offset:2048
L_pp25:
    v_exp_f32 v126, v126
    v_exp_f32 v127, v127
    buffer_load_dwordx4 v[212:215], v2, s[12:15], s48 offen offset:3072 sc1
    v_exp_f32 v128, v128
    v_exp_f32 v129, v129
    v_exp_f32 v130, v130
    v_smfmac_f32_32x32x32_bf16 v[152:167], v[48:51], v[120:127], v14
    v_exp_f32 v131, v131
    v_exp_f32 v132, v132
    s_cmp_ge_u32 s3, 3
    s_cbranch_scc1 L_pp26
    s_waitcnt lgkmcnt(0)
    buffer_store_dwordx4 v[8:11], v2, s[12:15], s93 offen offset:1024 sc1
L_pp26:
    v_exp_f32 v133, v133
    v_exp_f32 v134, v134
    ds_write2st64_b32 v7, v168, v169 offset0:0 offset1:1
    ds_write2st64_b32 v7, v170, v171 offset0:2 offset1:3
    ds_write2st64_b32 v7, v172, v173 offset0:4 offset1:5
    ds_write2st64_b32 v7, v174, v175 offset0:6 offset1:7
    ds_write_b32 v7, v176 offset:2048
    v_exp_f32 v135, v135
    s_setprio 0
    v_exp_f32 v136, v136
    v_exp_f32 v137, v137
    v_smfmac_f32_32x32x32_bf16 v[152:167], v[52:55], v[128:135], v14
    v_exp_f32 v138, v138
    v_exp_f32 v139, v139
    v_exp_f32 v140, v140
    v_mfma_f32_32x32x16_bf16 v[120:135], v[24:27], v[112:115], v[240:255]
    v_exp_f32 v141, v141
    v_exp_f32 v142, v142
    v_exp_f32 v143, v143
    v_exp_f32 v144, v144
    v_exp_f32 v145, v145
    v_exp_f32 v146, v146
    v_smfmac_f32_32x32x32_bf16 v[152:167], v[56:59], v[136:143], v14
    v_exp_f32 v147, v147
    v_exp_f32 v148, v148
    v_exp_f32 v149, v149
    v_exp_f32 v150, v150
    v_exp_f32 v151, v151
    s_setprio 3
    s_waitcnt lgkmcnt(0)
    s_barrier
    v_exp_f32 v120, v120
    ds_read2st64_b32 v[176:177], v4 offset0:8 offset1:17
    v_exp_f32 v121, v121
    v_smfmac_f32_32x32x32_bf16 v[152:167], v[60:63], v[144:151], v14
    v_exp_f32 v122, v122
    ds_read2st64_b32 v[178:179], v4 offset0:26 offset1:35
    v_exp_f32 v123, v123
    v_exp_f32 v124, v124
    v_mfma_f32_32x32x16_bf16 v[136:151], v[28:31], v[112:115], v[240:255]
    ds_read2st64_b32 v[180:181], v4 offset0:44 offset1:53
    v_exp_f32 v125, v125
    v_exp_f32 v126, v126
    ds_read2st64_b32 v[182:183], v4 offset0:62 offset1:71
    v_exp_f32 v127, v127
    v_exp_f32 v128, v128
    ds_read2st64_b32 v[168:169], v13 offset0:0 offset1:9
    v_exp_f32 v129, v129
    v_exp_f32 v130, v130
    v_smfmac_f32_32x32x32_bf16 v[152:167], v[64:67], v[120:127], v14
    ds_read2st64_b32 v[170:171], v13 offset0:18 offset1:27
    v_exp_f32 v131, v131
    v_exp_f32 v132, v132
    ds_read2st64_b32 v[172:173], v13 offset0:36 offset1:45
    v_exp_f32 v133, v133
    ds_read2st64_b32 v[174:175], v13 offset0:54 offset1:63
    v_exp_f32 v134, v134
    v_exp_f32 v135, v135
    s_setprio 2
    v_exp_f32 v136, v136
    v_exp_f32 v137, v137
    v_smfmac_f32_32x32x32_bf16 v[152:167], v[68:71], v[128:135], v14
    v_exp_f32 v138, v138
    v_exp_f32 v139, v139
    s_waitcnt lgkmcnt(0)
    v_pk_add_f32 v[176:177], v[176:177], v[178:179]
    v_pk_add_f32 v[180:181], v[180:181], v[182:183]
    v_pk_add_f32 v[168:169], v[168:169], v[170:171]
    v_pk_add_f32 v[172:173], v[172:173], v[174:175]
    v_pk_add_f32 v[176:177], v[176:177], v[180:181]
    v_pk_add_f32 v[168:169], v[168:169], v[172:173]
    v_add_f32 v176, v176, v177
    v_rcp_f32 v176, v176
    v_add_f32 v168, v168, v169
    v_exp_f32 v140, v140
    v_mfma_f32_32x32x16_bf16 v[120:135], v[32:35], v[112:115], v[240:255]
    v_mul_f32 v168, v168, v176
    v_cvt_pk_bf16_f32 v168, v168, v168
    ds_write_b16 v5, v168 offset:19456
    v_exp_f32 v141, v141
    v_exp_f32 v142, v142
    v_exp_f32 v143, v143
    v_exp_f32 v144, v144
    v_exp_f32 v145, v145
    v_exp_f32 v146, v146
    v_smfmac_f32_32x32x32_bf16 v[152:167], v[72:75], v[136:143], v14
    v_exp_f32 v147, v147
    v_exp_f32 v148, v148
    v_exp_f32 v149, v149
    v_exp_f32 v150, v150
    v_exp_f32 v151, v151
    s_setprio 3
    s_waitcnt lgkmcnt(0)
    s_barrier
    v_exp_f32 v120, v120
    s_add_u32 s22, s33, 3
    s_and_b32 s22, s22, 7
    s_lshl_b32 s22, s22, 10
    s_add_u32 s22, s22, s21
    buffer_load_dwordx4 v[116:119], v2, s[12:15], s22 offen sc1
    v_exp_f32 v121, v121
    v_smfmac_f32_32x32x32_bf16 v[152:167], v[76:79], v[144:151], v14
    v_exp_f32 v122, v122
    ds_read_b128 v[232:235], v2 offset:19456
    v_exp_f32 v123, v123
    v_exp_f32 v124, v124
    v_mfma_f32_32x32x16_bf16 v[136:151], v[36:39], v[112:115], v[240:255]
    v_exp_f32 v125, v125
    s_cmp_ge_u32 s3, 3
    s_cbranch_scc1 L_pp27
    ds_read_b64_tr_b16 v[8:9], v3 offset:64
    ds_read_b64_tr_b16 v[10:11], v6 offset:64
L_pp27:
    v_exp_f32 v126, v126
    v_exp_f32 v127, v127
    s_cmp_lt_u32 s3, 4
    s_cbranch_scc1 L_mq28
    ds_read_b64_tr_b16 v[168:169], v3 offset:0
    ds_read_b64_tr_b16 v[170:171], v3 offset:1024
    ds_read_b64_tr_b16 v[172:173], v3 offset:8192
    ds_read_b64_tr_b16 v[174:175], v3 offset:9216
    ds_read_b128 v[176:179], v8
    ds_read_b128 v[8:11], v8 offset:64
L_mq28:
    v_exp_f32 v128, v128
    v_exp_f32 v129, v129
    v_exp_f32 v130, v130
    v_smfmac_f32_32x32x32_bf16 v[152:167], v[80:83], v[120:127], v14
    v_exp_f32 v131, v131
    v_exp_f32 v132, v132
    v_exp_f32 v133, v133
    s_waitcnt lgkmcnt(0)
    s_waitcnt vmcnt(7)
    v_smfmac_f32_16x16x64_bf16 v[216:219], v[232:235], v[184:191], v15
    v_exp_f32 v134, v134
    v_exp_f32 v135, v135
    s_waitcnt vmcnt(5)
    v_smfmac_f32_16x16x64_bf16 v[220:223], v[232:235], v[192:199], v15
    v_exp_f32 v136, v136
    v_exp_f32 v137, v137
    v_smfmac_f32_32x32x32_bf16 v[152:167], v[84:87], v[128:135], v14
    s_cmp_ge_u32 s3, 3
    s_cbranch_scc1 L_pp29
    s_waitcnt lgkmcnt(0)
    buffer_store_dwordx4 v[8:11], v2, s[12:15], s94 offen offset:0 sc1
L_pp29:
    v_exp_f32 v138, v138
    v_exp_f32 v139, v139
    s_cmp_lt_u32 s3, 4
    s_cbranch_scc1 L_mq30
    s_waitcnt lgkmcnt(0)
    v_mfma_f32_16x16x32_bf16 v[180:183], v[168:171], v[176:179], 0
    v_mfma_f32_16x16x32_bf16 v[180:183], v[172:175], v[8:11], v[180:183]
L_mq30:
    s_add_u32 s48, s33, 2
    s_and_b32 s48, s48, 7
    s_lshl_b32 s48, s48, 16
    s_add_u32 s48, s48, s27
    buffer_load_dwordx4 v[184:187], v2, s[12:15], s48 offen offset:0 sc1
    v_exp_f32 v140, v140
    v_mfma_f32_32x32x16_bf16 v[120:135], v[40:43], v[112:115], v[240:255]
    v_exp_f32 v141, v141
    v_exp_f32 v142, v142
    v_exp_f32 v143, v143
    s_waitcnt vmcnt(4)
    v_smfmac_f32_16x16x64_bf16 v[224:227], v[232:235], v[200:207], v15
    v_exp_f32 v144, v144
    v_exp_f32 v145, v145
    s_cmp_ge_u32 s3, 3
    s_cbranch_scc1 L_pp31
    ds_read_b64_tr_b16 v[8:9], v3 offset:2112
    ds_read_b64_tr_b16 v[10:11], v6 offset:2112
L_pp31:
    v_exp_f32 v146, v146
    v_smfmac_f32_32x32x32_bf16 v[152:167], v[88:91], v[136:143], v14
    v_exp_f32 v147, v147
    buffer_load_dwordx4 v[188:191], v2, s[12:15], s48 offen offset:1024 sc1
    v_exp_f32 v148, v148
    v_exp_f32 v149, v149
    s_waitcnt vmcnt(3)
    v_smfmac_f32_16x16x64_bf16 v[228:231], v[232:235], v[208:215], v15
    v_exp_f32 v150, v150
    v_exp_f32 v151, v151
    s_setprio 2
    v_exp_f32 v120, v120
    s_cmp_lt_u32 s3, 4
    s_cbranch_scc1 L_mq32
    s_mov_b32 exec_lo, 0x10001
    s_mov_b32 exec_hi, 0x10001
    buffer_store_dwordx4 v[180:183], v6, s[12:15], s93 offen sc1
    s_mov_b64 exec, -1
L_mq32:
    v_exp_f32 v121, v121
    v_smfmac_f32_32x32x32_bf16 v[152:167], v[92:95], v[144:151], v14
    s_cmp_ge_u32 s3, 3
    s_cbranch_scc1 L_pp33
    s_waitcnt lgkmcnt(0)
    buffer_store_dwordx4 v[8:11], v2, s[12:15], s94 offen offset:1024 sc1
L_pp33:
    v_exp_f32 v122, v122
    v_exp_f32 v123, v123
    buffer_load_dwordx4 v[192:195], v2, s[12:15], s48 offen offset:2048 sc1
    v_exp_f32 v124, v124
    v_mfma_f32_32x32x16_bf16 v[136:151], v[44:47], v[112:115], v[240:255]
    v_exp_f32 v125, v125
    v_exp_f32 v126, v126
    v_exp_f32 v127, v127
    v_exp_f32 v128, v128
    v_exp_f32 v129, v129
    v_exp_f32 v130, v130
    v_smfmac_f32_32x32x32_bf16 v[152:167], v[96:99], v[120:127], v14
    v_exp_f32 v131, v131
    v_exp_f32 v132, v132
    buffer_load_dwordx4 v[196:199], v2, s[12:15], s48 offen offset:3072 sc1
    v_exp_f32 v133, v133
    v_exp_f32 v134, v134
    v_exp_f32 v135, v135
    v_exp_f32 v136, v136
    v_exp_f32 v137, v137
    v_smfmac_f32_32x32x32_bf16 v[152:167], v[100:103], v[128:135], v14
    v_exp_f32 v138, v138
    v_exp_f32 v139, v139
    s_add_u32 s48, s48, 4096
    buffer_load_dwordx4 v[200:203], v2, s[12:15], s48 offen offset:0 sc1
    v_exp_f32 v140, v140
    ds_read_b32 v240, v12 offset:20864
    s_waitcnt lgkmcnt(0)
    v_sub_f32 v240, 0, v240
    v_mov_b32 v241, v240
    v_mov_b32 v242, v240
    v_mov_b32 v243, v240
    v_mov_b32 v244, v240
    v_mov_b32 v245, v240
    v_mov_b32 v246, v240
    v_mov_b32 v247, v240
    v_mov_b32 v248, v240
    v_mov_b32 v249, v240
    v_mov_b32 v250, v240
    v_mov_b32 v251, v240
    v_mov_b32 v252, v240
    v_mov_b32 v253, v240
    v_mov_b32 v254, v240
    v_mov_b32 v255, v240
    s_nop 1
    s_waitcnt vmcnt(5)
    v_mfma_f32_32x32x16_bf16 v[120:135], v[16:19], v[116:119], v[240:255]
    v_exp_f32 v141, v141
    v_exp_f32 v142, v142
    v_exp_f32 v143, v143
    v_exp_f32 v144, v144
    v_exp_f32 v145, v145
    v_exp_f32 v146, v146
    v_smfmac_f32_32x32x32_bf16 v[152:167], v[104:107], v[136:143], v14
    v_exp_f32 v147, v147
    buffer_load_dwordx4 v[204:207], v2, s[12:15], s48 offen offset:1024 sc1
    v_exp_f32 v148, v148
    v_exp_f32 v149, v149
    s_waitcnt lgkmcnt(0)
    v_mfma_f32_32x32x16_bf16 v[168:183], v[236:239], v[236:239], 0
    v_exp_f32 v150, v150
    v_exp_f32 v151, v151
    s_setprio 1
    v_exp_f32 v120, v120
    v_exp_f32 v121, v121
    v_smfmac_f32_32x32x32_bf16 v[152:167], v[108:111], v[144:151], v14
    v_exp_f32 v122, v122
    buffer_load_dwordx4 v[208:211], v2, s[12:15], s48 offen offset:2048 sc1
    v_exp_f32 v123, v123
    v_exp_f32 v124, v124
    v_mfma_f32_32x32x16_bf16 v[136:151], v[20:23], v[116:119], v[240:255]
    v_exp_f32 v125, v125
    v_exp_f32 v126, v126
    v_exp_f32 v127, v127
    buffer_load_dwordx4 v[212:215], v2, s[12:15], s48 offen offset:3072 sc1
    v_exp_f32 v128, v128
    v_exp_f32 v129, v129
    v_exp_f32 v130, v130
    v_smfmac_f32_32x32x32_bf16 v[168:183], v[48:51], v[120:127], v14
    v_exp_f32 v131, v131
    v_exp_f32 v132, v132
    v_exp_f32 v133, v133
    v_exp_f32 v134, v134
    ds_write2st64_b32 v7, v152, v153 offset0:0 offset1:1
    ds_write2st64_b32 v7, v154, v155 offset0:2 offset1:3
    ds_write2st64_b32 v7, v156, v157 offset0:4 offset1:5
    ds_write2st64_b32 v7, v158, v159 offset0:6 offset1:7
    ds_write_b32 v7, v160 offset:2048
    v_exp_f32 v135, v135
    s_setprio 0
    v_exp_f32 v136, v136
    v_exp_f32 v137, v137
    v_smfmac_f32_32x32x32_bf16 v[168:183], v[52:55], v[128:135], v14
    v_exp_f32 v138, v138
    v_exp_f32 v139, v139
    v_exp_f32 v140, v140
    v_mfma_f32_32x32x16_bf16 v[120:135], v[24:27], v[116:119], v[240:255]
    v_exp_f32 v141, v141
    v_exp_f32 v142, v142
    v_exp_f32 v143, v143
    v_exp_f32 v144, v144
    v_exp_f32 v145, v145
    v_exp_f32 v146, v146
    v_smfmac_f32_32x32x32_bf16 v[168:183], v[56:59], v[136:143], v14
    v_exp_f32 v147, v147
    v_exp_f32 v148, v148
    s_waitcnt vmcnt(4)
    v_exp_f32 v149, v149
    v_exp_f32 v150, v150
    v_exp_f32 v151, v151
    s_setprio 3
    s_waitcnt lgkmcnt(0)
    s_barrier
    v_exp_f32 v120, v120
    ds_read2st64_b32 v[160:161], v4 offset0:8 offset1:17
    v_exp_f32 v121, v121
    v_smfmac_f32_32x32x32_bf16 v[168:183], v[60:63], v[144:151], v14
    v_mov_b32 v6, s92
    v_and_b32 v11, 7, v1
    v_lshlrev_b32 v10, 10, v11
    v_lshrrev_b32 v3, 3, v1
    v_lshl_add_u32 v3, v3, 4, v10
    s_mov_b64 exec, 1
    buffer_store_dword v6, v4, s[12:15], s37 offen sc1
    s_mov_b64 exec, -1
    v_exp_f32 v122, v122
    ds_read2st64_b32 v[162:163], v4 offset0:26 offset1:35
    v_exp_f32 v123, v123
    v_exp_f32 v124, v124
    v_mfma_f32_32x32x16_bf16 v[136:151], v[28:31], v[116:119], v[240:255]
    ds_read2st64_b32 v[164:165], v4 offset0:44 offset1:53
    v_exp_f32 v125, v125
    v_exp_f32 v126, v126
    ds_read2st64_b32 v[166:167], v4 offset0:62 offset1:71
    v_exp_f32 v127, v127
    v_exp_f32 v128, v128
    ds_read2st64_b32 v[152:153], v13 offset0:0 offset1:9
    v_exp_f32 v129, v129
    v_exp_f32 v130, v130
    v_smfmac_f32_32x32x32_bf16 v[168:183], v[64:67], v[120:127], v14
    ds_read2st64_b32 v[154:155], v13 offset0:18 offset1:27
    v_exp_f32 v131, v131
    v_exp_f32 v132, v132
    ds_read2st64_b32 v[156:157], v13 offset0:36 offset1:45
    v_exp_f32 v133, v133
    ds_read2st64_b32 v[158:159], v13 offset0:54 offset1:63
    v_exp_f32 v134, v134
    v_exp_f32 v135, v135
    s_setprio 2
    v_exp_f32 v136, v136
    v_exp_f32 v137, v137
    v_smfmac_f32_32x32x32_bf16 v[168:183], v[68:71], v[128:135], v14
    v_exp_f32 v138, v138
    v_exp_f32 v139, v139
    s_waitcnt lgkmcnt(0)
    v_pk_add_f32 v[160:161], v[160:161], v[162:163]
    v_pk_add_f32 v[164:165], v[164:165], v[166:167]
    v_pk_add_f32 v[152:153], v[152:153], v[154:155]
    v_pk_add_f32 v[156:157], v[156:157], v[158:159]
    v_pk_add_f32 v[160:161], v[160:161], v[164:165]
    v_pk_add_f32 v[152:153], v[152:153], v[156:157]
    v_add_f32 v160, v160, v161
    v_rcp_f32 v160, v160
    v_add_f32 v152, v152, v153
    v_exp_f32 v140, v140
    v_mfma_f32_32x32x16_bf16 v[120:135], v[32:35], v[116:119], v[240:255]
    v_mul_f32 v152, v152, v160
    v_cvt_pk_bf16_f32 v152, v152, v152
    ds_write_b16 v5, v152 offset:18432
    v_exp_f32 v141, v141
    v_exp_f32 v142, v142
    v_exp_f32 v143, v143
    v_exp_f32 v144, v144
    v_exp_f32 v145, v145
    v_exp_f32 v146, v146
    v_smfmac_f32_32x32x32_bf16 v[168:183], v[72:75], v[136:143], v14
    v_exp_f32 v147, v147
    v_exp_f32 v148, v148
    v_exp_f32 v149, v149
    v_exp_f32 v150, v150
    v_exp_f32 v151, v151
    s_setprio 3
    s_waitcnt lgkmcnt(0)
    s_barrier
    v_exp_f32 v120, v120
    s_add_u32 s22, s33, 4
    s_and_b32 s22, s22, 7
    s_lshl_b32 s22, s22, 10
    s_add_u32 s22, s22, s21
    buffer_load_dwordx4 v[112:115], v2, s[12:15], s22 offen sc1
    v_exp_f32 v121, v121
    v_smfmac_f32_32x32x32_bf16 v[168:183], v[76:79], v[144:151], v14
    v_exp_f32 v122, v122
    ds_read_b128 v[232:235], v2 offset:18432
    v_exp_f32 v123, v123
    v_exp_f32 v124, v124
    v_mfma_f32_32x32x16_bf16 v[136:151], v[36:39], v[116:119], v[240:255]
    v_exp_f32 v125, v125
    v_exp_f32 v126, v126
    v_exp_f32 v127, v127
    v_exp_f32 v128, v128
    v_exp_f32 v129, v129
    v_exp_f32 v130, v130
    v_smfmac_f32_32x32x32_bf16 v[168:183], v[80:83], v[120:127], v14
    v_exp_f32 v131, v131
    v_exp_f32 v132, v132
    v_exp_f32 v133, v133
    s_waitcnt lgkmcnt(0)
    v_smfmac_f32_16x16x64_bf16 v[216:219], v[232:235], v[184:191], v15
    v_exp_f32 v134, v134
    v_exp_f32 v135, v135
    v_smfmac_f32_16x16x64_bf16 v[220:223], v[232:235], v[192:199], v15
    v_exp_f32 v136, v136
    v_exp_f32 v137, v137
    v_smfmac_f32_32x32x32_bf16 v[168:183], v[84:87], v[128:135], v14
    v_exp_f32 v138, v138
    v_exp_f32 v139, v139
    s_add_u32 s48, s33, 3
    s_and_b32 s48, s48, 7
    s_lshl_b32 s48, s48, 16
    s_add_u32 s48, s48, s27
    buffer_load_dwordx4 v[184:187], v2, s[12:15], s48 offen offset:0 sc1
    v_exp_f32 v140, v140
    v_mfma_f32_32x32x16_bf16 v[120:135], v[40:43], v[116:119], v[240:255]
    v_exp_f32 v141, v141
    v_exp_f32 v142, v142
    v_exp_f32 v143, v143
    s_waitcnt vmcnt(5)
    v_smfmac_f32_16x16x64_bf16 v[224:227], v[232:235], v[200:207], v15
    v_exp_f32 v144, v144
    v_exp_f32 v145, v145
    v_exp_f32 v146, v146
    v_smfmac_f32_32x32x32_bf16 v[168:183], v[88:91], v[136:143], v14
    v_exp_f32 v147, v147
    buffer_load_dwordx4 v[188:191], v2, s[12:15], s48 offen offset:1024 sc1
    v_exp_f32 v148, v148
    v_exp_f32 v149, v149
    s_waitcnt vmcnt(4)
    v_smfmac_f32_16x16x64_bf16 v[228:231], v[232:235], v[208:215], v15
    v_exp_f32 v150, v150
    v_exp_f32 v151, v151
    s_setprio 2
    v_exp_f32 v120, v120
    v_exp_f32 v121, v121
    v_smfmac_f32_32x32x32_bf16 v[168:183], v[92:95], v[144:151], v14
    v_exp_f32 v122, v122
    v_exp_f32 v123, v123
    buffer_load_dwordx4 v[192:195], v2, s[12:15], s48 offen offset:2048 sc1
    v_exp_f32 v124, v124
    v_mfma_f32_32x32x16_bf16 v[136:151], v[44:47], v[116:119], v[240:255]
    v_exp_f32 v125, v125
    v_exp_f32 v126, v126
    v_exp_f32 v127, v127
    v_exp_f32 v128, v128
    v_exp_f32 v129, v129
    v_exp_f32 v130, v130
    v_smfmac_f32_32x32x32_bf16 v[168:183], v[96:99], v[120:127], v14
    v_exp_f32 v131, v131
    v_exp_f32 v132, v132
    buffer_load_dwordx4 v[196:199], v2, s[12:15], s48 offen offset:3072 sc1
    v_exp_f32 v133, v133
    v_exp_f32 v134, v134
    v_exp_f32 v135, v135
    v_exp_f32 v136, v136
    v_exp_f32 v137, v137
    v_smfmac_f32_32x32x32_bf16 v[168:183], v[100:103], v[128:135], v14
    v_exp_f32 v138, v138
    v_exp_f32 v139, v139
    s_add_u32 s48, s48, 4096
    buffer_load_dwordx4 v[200:203], v2, s[12:15], s48 offen offset:0 sc1
    v_exp_f32 v140, v140
    ds_read_b32 v240, v12 offset:20992
    s_waitcnt lgkmcnt(0)
    v_sub_f32 v240, 0, v240
    v_mov_b32 v241, v240
    v_mov_b32 v242, v240
    v_mov_b32 v243, v240
    v_mov_b32 v244, v240
    v_mov_b32 v245, v240
    v_mov_b32 v246, v240
    v_mov_b32 v247, v240
    v_mov_b32 v248, v240
    v_mov_b32 v249, v240
    v_mov_b32 v250, v240
    v_mov_b32 v251, v240
    v_mov_b32 v252, v240
    v_mov_b32 v253, v240
    v_mov_b32 v254, v240
    v_mov_b32 v255, v240
    s_nop 1
    s_waitcnt vmcnt(5)
    v_mfma_f32_32x32x16_bf16 v[120:135], v[16:19], v[112:115], v[240:255]
    v_exp_f32 v141, v141
    v_exp_f32 v142, v142
    v_exp_f32 v143, v143
    v_exp_f32 v144, v144
    v_exp_f32 v145, v145
    v_exp_f32 v146, v146
    v_smfmac_f32_32x32x32_bf16 v[168:183], v[104:107], v[136:143], v14
    v_exp_f32 v147, v147
    buffer_load_dwordx4 v[204:207], v2, s[12:15], s48 offen offset:1024 sc1
    v_exp_f32 v148, v148
    v_exp_f32 v149, v149
    s_waitcnt lgkmcnt(0)
    v_mfma_f32_32x32x16_bf16 v[152:167], v[236:239], v[236:239], 0
    v_exp_f32 v150, v150
    v_exp_f32 v151, v151
    s_setprio 1
    v_exp_f32 v120, v120
    v_exp_f32 v121, v121
    v_smfmac_f32_32x32x32_bf16 v[168:183], v[108:111], v[144:151], v14
    v_exp_f32 v122, v122
    buffer_load_dwordx4 v[208:211], v2, s[12:15], s48 offen offset:2048 sc1
    v_exp_f32 v123, v123
    v_exp_f32 v124, v124
    v_mfma_f32_32x32x16_bf16 v[136:151], v[20:23], v[112:115], v[240:255]
    v_exp_f32 v125, v125
    v_exp_f32 v126, v126
    v_exp_f32 v127, v127
    buffer_load_dwordx4 v[212:215], v2, s[12:15], s48 offen offset:3072 sc1
    v_exp_f32 v128, v128
    v_exp_f32 v129, v129
    v_exp_f32 v130, v130
    v_smfmac_f32_32x32x32_bf16 v[152:167], v[48:51], v[120:127], v14
    v_exp_f32 v131, v131
    v_exp_f32 v132, v132
    v_lshlrev_b32 v8, 5, v1
    v_and_b32 v8, 0x3e0, v8
    s_mov_b32 exec_hi, 0
    buffer_load_dword v9, v8, s[12:15], s45 offen sc1
    s_mov_b64 exec, -1
    v_exp_f32 v133, v133
    v_exp_f32 v134, v134
    ds_write2st64_b32 v7, v168, v169 offset0:0 offset1:1
    ds_write2st64_b32 v7, v170, v171 offset0:2 offset1:3
    ds_write2st64_b32 v7, v172, v173 offset0:4 offset1:5
    ds_write2st64_b32 v7, v174, v175 offset0:6 offset1:7
    ds_write_b32 v7, v176 offset:2048
    v_exp_f32 v135, v135
    s_setprio 0
    v_exp_f32 v136, v136
    v_exp_f32 v137, v137
    v_smfmac_f32_32x32x32_bf16 v[152:167], v[52:55], v[128:135], v14
    v_exp_f32 v138, v138
    v_exp_f32 v139, v139
    v_exp_f32 v140, v140
    v_mfma_f32_32x32x16_bf16 v[120:135], v[24:27], v[112:115], v[240:255]
    v_exp_f32 v141, v141
    v_exp_f32 v142, v142
    v_exp_f32 v143, v143
    v_exp_f32 v144, v144
    v_exp_f32 v145, v145
    v_exp_f32 v146, v146
    v_smfmac_f32_32x32x32_bf16 v[152:167], v[56:59], v[136:143], v14
    v_exp_f32 v147, v147
    v_exp_f32 v148, v148
    v_exp_f32 v149, v149
    v_exp_f32 v150, v150
    v_exp_f32 v151, v151
    s_setprio 3
    s_waitcnt lgkmcnt(0)
    s_barrier
    v_exp_f32 v120, v120
    ds_read2st64_b32 v[176:177], v4 offset0:8 offset1:17
    v_exp_f32 v121, v121
    v_smfmac_f32_32x32x32_bf16 v[152:167], v[60:63], v[144:151], v14
    v_exp_f32 v122, v122
    ds_read2st64_b32 v[178:179], v4 offset0:26 offset1:35
    v_exp_f32 v123, v123
    v_exp_f32 v124, v124
    v_mfma_f32_32x32x16_bf16 v[136:151], v[28:31], v[112:115], v[240:255]
    ds_read2st64_b32 v[180:181], v4 offset0:44 offset1:53
    v_exp_f32 v125, v125
    v_exp_f32 v126, v126
    ds_read2st64_b32 v[182:183], v4 offset0:62 offset1:71
    v_exp_f32 v127, v127
    v_exp_f32 v128, v128
    ds_read2st64_b32 v[168:169], v13 offset0:0 offset1:9
    v_exp_f32 v129, v129
    v_exp_f32 v130, v130
    v_smfmac_f32_32x32x32_bf16 v[152:167], v[64:67], v[120:127], v14
    ds_read2st64_b32 v[170:171], v13 offset0:18 offset1:27
    v_exp_f32 v131, v131
    v_exp_f32 v132, v132
    ds_read2st64_b32 v[172:173], v13 offset0:36 offset1:45
    v_exp_f32 v133, v133
    ds_read2st64_b32 v[174:175], v13 offset0:54 offset1:63
    v_exp_f32 v134, v134
    v_exp_f32 v135, v135
    s_setprio 2
    v_exp_f32 v136, v136
    v_exp_f32 v137, v137
    v_smfmac_f32_32x32x32_bf16 v[152:167], v[68:71], v[128:135], v14
    v_exp_f32 v138, v138
    v_exp_f32 v139, v139
    s_waitcnt lgkmcnt(0)
    v_pk_add_f32 v[176:177], v[176:177], v[178:179]
    v_pk_add_f32 v[180:181], v[180:181], v[182:183]
    v_pk_add_f32 v[168:169], v[168:169], v[170:171]
    v_pk_add_f32 v[172:173], v[172:173], v[174:175]
    v_pk_add_f32 v[176:177], v[176:177], v[180:181]
    v_pk_add_f32 v[168:169], v[168:169], v[172:173]
    v_add_f32 v176, v176, v177
    v_rcp_f32 v176, v176
    v_add_f32 v168, v168, v169
    v_exp_f32 v140, v140
    v_mfma_f32_32x32x16_bf16 v[120:135], v[32:35], v[112:115], v[240:255]
    v_mul_f32 v168, v168, v176
    v_cvt_pk_bf16_f32 v168, v168, v168
    ds_write_b16 v5, v168 offset:19456
    v_exp_f32 v141, v141
    v_exp_f32 v142, v142
    v_exp_f32 v143, v143
    v_exp_f32 v144, v144
    v_exp_f32 v145, v145
    v_exp_f32 v146, v146
    v_smfmac_f32_32x32x32_bf16 v[152:167], v[72:75], v[136:143], v14
    v_exp_f32 v147, v147
    s_waitcnt vmcnt(0)
    s_mov_b32 s54, 0
L_rc34:
    v_cmp_eq_u32 vcc, s92, v9
    s_cmp_eq_u32 vcc_lo, -1
    s_cbranch_scc1 L_rc34_ok
    s_add_u32 s54, s54, 1
    s_cmp_gt_u32 s54, 1048576
    s_cbranch_scc1 L_rc34_ok
    s_sleep 4
    buffer_load_dword v9, v8, s[12:15], s45 offen sc1
    s_waitcnt vmcnt(0)
    s_branch L_rc34
L_rc34_ok:
    v_exp_f32 v148, v148
    v_exp_f32 v149, v149
    v_exp_f32 v150, v150
    v_exp_f32 v151, v151
    s_setprio 3
    s_waitcnt lgkmcnt(0)
    s_barrier
    v_exp_f32 v120, v120
    s_add_u32 s22, s33, 5
    s_and_b32 s22, s22, 7
    s_lshl_b32 s22, s22, 10
    s_add_u32 s22, s22, s21
    buffer_load_dwordx4 v[116:119], v2, s[12:15], s22 offen sc1
    v_exp_f32 v121, v121
    v_smfmac_f32_32x32x32_bf16 v[152:167], v[76:79], v[144:151], v14
    v_exp_f32 v122, v122
    ds_read_b128 v[232:235], v2 offset:19456
    v_exp_f32 v123, v123
    v_lshrrev_b32 v8, 3, v1
    v_and_b32 v9, 28, v4
    v_lshl_add_u32 v8, v8, 13, v9
    buffer_load_dword v10, v8, s[12:15], s42 offen sc1
    v_exp_f32 v124, v124
    v_mfma_f32_32x32x16_bf16 v[136:151], v[36:39], v[112:115], v[240:255]
    v_exp_f32 v125, v125
    v_exp_f32 v126, v126
    s_add_u32 m0, s26, 0
    s_add_u32 s53, s24, 0
    buffer_load_dwordx4 v2, s[96:99], s53 offen sc1 lds
    v_exp_f32 v127, v127
    v_exp_f32 v128, v128
    v_exp_f32 v129, v129
    v_exp_f32 v130, v130
    v_smfmac_f32_32x32x32_bf16 v[152:167], v[80:83], v[120:127], v14
    s_add_u32 m0, s26, 1024
    s_add_u32 s53, s24, 1024
    buffer_load_dwordx4 v2, s[96:99], s53 offen sc1 lds
    v_exp_f32 v131, v131
    v_exp_f32 v132, v132
    v_exp_f32 v133, v133
    s_waitcnt lgkmcnt(0)
    v_smfmac_f32_16x16x64_bf16 v[216:219], v[232:235], v[184:191], v15
    v_exp_f32 v134, v134
    v_exp_f32 v135, v135
    v_smfmac_f32_16x16x64_bf16 v[220:223], v[232:235], v[192:199], v15
    v_exp_f32 v136, v136
    v_exp_f32 v137, v137
    v_smfmac_f32_32x32x32_bf16 v[152:167], v[84:87], v[128:135], v14
    v_exp_f32 v138, v138
    v_exp_f32 v139, v139
    s_add_u32 s48, s33, 4
    s_and_b32 s48, s48, 7
    s_lshl_b32 s48, s48, 16
    s_add_u32 s48, s48, s27
    buffer_load_dwordx4 v[184:187], v2, s[12:15], s48 offen offset:0 sc1
    v_exp_f32 v140, v140
    v_mfma_f32_32x32x16_bf16 v[120:135], v[40:43], v[112:115], v[240:255]
    v_exp_f32 v141, v141
    v_exp_f32 v142, v142
    v_exp_f32 v143, v143
    v_smfmac_f32_16x16x64_bf16 v[224:227], v[232:235], v[200:207], v15
    v_exp_f32 v144, v144
    v_exp_f32 v145, v145
    v_exp_f32 v146, v146
    v_smfmac_f32_32x32x32_bf16 v[152:167], v[88:91], v[136:143], v14
    v_exp_f32 v147, v147
    buffer_load_dwordx4 v[188:191], v2, s[12:15], s48 offen offset:1024 sc1
    v_exp_f32 v148, v148
    v_exp_f32 v149, v149
    v_smfmac_f32_16x16x64_bf16 v[228:231], v[232:235], v[208:215], v15
    v_exp_f32 v150, v150
    v_exp_f32 v151, v151
    s_setprio 2
    v_exp_f32 v120, v120
    v_exp_f32 v121, v121
    v_smfmac_f32_32x32x32_bf16 v[152:167], v[92:95], v[144:151], v14
    v_exp_f32 v122, v122
    v_exp_f32 v123, v123
    buffer_load_dwordx4 v[192:195], v2, s[12:15], s48 offen offset:2048 sc1
    v_exp_f32 v124, v124
    v_mfma_f32_32x32x16_bf16 v[136:151], v[44:47], v[112:115], v[240:255]
    v_exp_f32 v125, v125
    v_exp_f32 v126, v126
    v_exp_f32 v127, v127
    s_add_u32 m0, s26, 2048
    s_add_u32 s53, s24, 2048
    buffer_load_dwordx4 v2, s[96:99], s53 offen sc1 lds
    v_exp_f32 v128, v128
    v_exp_f32 v129, v129
    s_waitcnt vmcnt(6)
    s_cmp_lg_u32 s3, 0
    s_cbranch_scc1 L_mp35
    v_add_f32_dpp v10, v10, v10 row_ror:8 row_mask:0xf bank_mask:0xf
    s_lshr_b32 s53, s20, 6
    v_mov_b32 v11, v10
    s_cmp_eq_u32 s53, 2
    s_cselect_b32 s53, 1.0, 0
    v_permlane16_swap_b32 v10, v11
    v_add_f32 v10, v10, v11
    v_mov_b32 v11, v10
    s_nop 1
    v_permlane32_swap_b32 v10, v11
    v_add_f32 v10, v10, v11
    v_cvt_pk_bf16_f32 v10, v10, v10
    v_lshlrev_b32 v10, 16, v10
    v_add_f32 v10, s53, v10
    v_cvt_pk_bf16_f32 v10, v10, v10
    v_lshlrev_b32 v10, 16, v10
    v_mov_b32 v11, s92
    v_lshlrev_b32 v9, 1, v9
    s_mov_b64 exec, 0xff
    buffer_store_dwordx2 v[10:11], v9, s[12:15], s43 offen sc1
    s_mov_b64 exec, -1
L_mp35:
    v_exp_f32 v130, v130
    v_smfmac_f32_32x32x32_bf16 v[152:167], v[96:99], v[120:127], v14
    v_exp_f32 v131, v131
    v_exp_f32 v132, v132
    buffer_load_dwordx4 v[196:199], v2, s[12:15], s48 offen offset:3072 sc1
    v_exp_f32 v133, v133
    v_exp_f32 v134, v134
    v_exp_f32 v135, v135
    v_exp_f32 v136, v136
    v_exp_f32 v137, v137
    v_smfmac_f32_32x32x32_bf16 v[152:167], v[100:103], v[128:135], v14
    v_exp_f32 v138, v138
    v_exp_f32 v139, v139
    s_add_u32 s48, s48, 4096
    buffer_load_dwordx4 v[200:203], v2, s[12:15], s48 offen offset:0 sc1
    v_exp_f32 v140, v140
    ds_read_b32 v240, v12 offset:21120
    s_waitcnt lgkmcnt(0)
    v_sub_f32 v240, 0, v240
    v_mov_b32 v241, v240
    v_mov_b32 v242, v240
    v_mov_b32 v243, v240
    v_mov_b32 v244, v240
    v_mov_b32 v245, v240
    v_mov_b32 v246, v240
    v_mov_b32 v247, v240
    v_mov_b32 v248, v240
    v_mov_b32 v249, v240
    v_mov_b32 v250, v240
    v_mov_b32 v251, v240
    v_mov_b32 v252, v240
    v_mov_b32 v253, v240
    v_mov_b32 v254, v240
    v_mov_b32 v255, v240
    s_nop 1
    v_mfma_f32_32x32x16_bf16 v[120:135], v[16:19], v[116:119], v[240:255]
    v_exp_f32 v141, v141
    v_exp_f32 v142, v142
    v_exp_f32 v143, v143
    s_add_u32 m0, s26, 3072
    s_add_u32 s53, s24, 3072
    buffer_load_dwordx4 v2, s[96:99], s53 offen sc1 lds
    v_exp_f32 v144, v144
    v_exp_f32 v145, v145
    v_exp_f32 v146, v146
    v_smfmac_f32_32x32x32_bf16 v[152:167], v[104:107], v[136:143], v14
    v_exp_f32 v147, v147
    buffer_load_dwordx4 v[204:207], v2, s[12:15], s48 offen offset:1024 sc1
    v_exp_f32 v148, v148
    v_exp_f32 v149, v149
    s_waitcnt lgkmcnt(0)
    v_mfma_f32_32x32x16_bf16 v[168:183], v[236:239], v[236:239], 0
    v_exp_f32 v150, v150
    v_exp_f32 v151, v151
    s_setprio 1
    v_exp_f32 v120, v120
    v_exp_f32 v121, v121
    v_smfmac_f32_32x32x32_bf16 v[152:167], v[108:111], v[144:151], v14
    v_exp_f32 v122, v122
    buffer_load_dwordx4 v[208:211], v2, s[12:15], s48 offen offset:2048 sc1
    v_exp_f32 v123, v123
    v_exp_f32 v124, v124
    v_mfma_f32_32x32x16_bf16 v[136:151], v[20:23], v[116:119], v[240:255]
    v_exp_f32 v125, v125
    v_exp_f32 v126, v126
    v_exp_f32 v127, v127
    buffer_load_dwordx4 v[212:215], v2, s[12:15], s48 offen offset:3072 sc1
    v_exp_f32 v128, v128
    v_exp_f32 v129, v129
    v_exp_f32 v130, v130
    v_smfmac_f32_32x32x32_bf16 v[168:183], v[48:51], v[120:127], v14
    s_add_u32 m0, s26, 4096
    s_add_u32 s53, s24, 4096
    buffer_load_dwordx4 v2, s[96:99], s53 offen sc1 lds
    v_exp_f32 v131, v131
    v_exp_f32 v132, v132
    v_lshlrev_b32 v8, 7, v1
    s_mov_b64 exec, 0xff
    buffer_load_dword v9, v8, s[12:15], s35 offen sc1
    s_mov_b64 exec, -1
    v_exp_f32 v133, v133
    v_exp_f32 v134, v134
    ds_write2st64_b32 v7, v152, v153 offset0:0 offset1:1
    ds_write2st64_b32 v7, v154, v155 offset0:2 offset1:3
    ds_write2st64_b32 v7, v156, v157 offset0:4 offset1:5
    ds_write2st64_b32 v7, v158, v159 offset0:6 offset1:7
    ds_write_b32 v7, v160 offset:2048
    v_exp_f32 v135, v135
    s_setprio 0
    v_exp_f32 v136, v136
    v_exp_f32 v137, v137
    v_smfmac_f32_32x32x32_bf16 v[168:183], v[52:55], v[128:135], v14
    v_exp_f32 v138, v138
    v_exp_f32 v139, v139
    v_exp_f32 v140, v140
    v_mfma_f32_32x32x16_bf16 v[120:135], v[24:27], v[116:119], v[240:255]
    v_exp_f32 v141, v141
    v_exp_f32 v142, v142
    v_exp_f32 v143, v143
    v_exp_f32 v144, v144
    v_exp_f32 v145, v145
    v_exp_f32 v146, v146
    v_smfmac_f32_32x32x32_bf16 v[168:183], v[56:59], v[136:143], v14
    v_exp_f32 v147, v147
    v_exp_f32 v148, v148
    v_exp_f32 v149, v149
    v_exp_f32 v150, v150
    v_exp_f32 v151, v151
    s_setprio 3
    s_waitcnt lgkmcnt(0)
    s_barrier
    v_exp_f32 v120, v120
    ds_read2st64_b32 v[160:161], v4 offset0:8 offset1:17
    v_exp_f32 v121, v121
    v_smfmac_f32_32x32x32_bf16 v[168:183], v[60:63], v[144:151], v14
    v_exp_f32 v122, v122
    ds_read2st64_b32 v[162:163], v4 offset0:26 offset1:35
    v_exp_f32 v123, v123
    v_exp_f32 v124, v124
    v_mfma_f32_32x32x16_bf16 v[136:151], v[28:31], v[116:119], v[240:255]
    ds_read2st64_b32 v[164:165], v4 offset0:44 offset1:53
    v_exp_f32 v125, v125
    v_exp_f32 v126, v126
    ds_read2st64_b32 v[166:167], v4 offset0:62 offset1:71
    v_exp_f32 v127, v127
    v_exp_f32 v128, v128
    ds_read2st64_b32 v[152:153], v13 offset0:0 offset1:9
    v_exp_f32 v129, v129
    v_exp_f32 v130, v130
    v_smfmac_f32_32x32x32_bf16 v[168:183], v[64:67], v[120:127], v14
    ds_read2st64_b32 v[154:155], v13 offset0:18 offset1:27
    v_exp_f32 v131, v131
    v_exp_f32 v132, v132
    ds_read2st64_b32 v[156:157], v13 offset0:36 offset1:45
    v_exp_f32 v133, v133
    ds_read2st64_b32 v[158:159], v13 offset0:54 offset1:63
    v_exp_f32 v134, v134
    v_exp_f32 v135, v135
    s_setprio 2
    v_exp_f32 v136, v136
    v_exp_f32 v137, v137
    v_smfmac_f32_32x32x32_bf16 v[168:183], v[68:71], v[128:135], v14
    v_exp_f32 v138, v138
    v_exp_f32 v139, v139
    s_waitcnt lgkmcnt(0)
    v_pk_add_f32 v[160:161], v[160:161], v[162:163]
    v_pk_add_f32 v[164:165], v[164:165], v[166:167]
    v_pk_add_f32 v[152:153], v[152:153], v[154:155]
    v_pk_add_f32 v[156:157], v[156:157], v[158:159]
    v_pk_add_f32 v[160:161], v[160:161], v[164:165]
    v_pk_add_f32 v[152:153], v[152:153], v[156:157]
    v_add_f32 v160, v160, v161
    v_rcp_f32 v160, v160
    v_add_f32 v152, v152, v153
    v_exp_f32 v140, v140
    v_mfma_f32_32x32x16_bf16 v[120:135], v[32:35], v[116:119], v[240:255]
    v_mul_f32 v152, v152, v160
    v_cvt_pk_bf16_f32 v152, v152, v152
    ds_write_b16 v5, v152 offset:18432
    v_exp_f32 v141, v141
    v_exp_f32 v142, v142
    v_exp_f32 v143, v143
    v_exp_f32 v144, v144
    v_exp_f32 v145, v145
    v_exp_f32 v146, v146
    v_smfmac_f32_32x32x32_bf16 v[168:183], v[72:75], v[136:143], v14
    v_exp_f32 v147, v147
    v_exp_f32 v148, v148
    v_exp_f32 v149, v149
    v_exp_f32 v150, v150
    v_exp_f32 v151, v151
    s_setprio 3
    s_waitcnt lgkmcnt(0)
    s_barrier
    v_exp_f32 v120, v120
    s_add_u32 s22, s33, 6
    s_and_b32 s22, s22, 7
    s_lshl_b32 s22, s22, 10
    s_add_u32 s22, s22, s21
    buffer_load_dwordx4 v[112:115], v2, s[12:15], s22 offen sc1
    v_exp_f32 v121, v121
    v_smfmac_f32_32x32x32_bf16 v[168:183], v[76:79], v[144:151], v14
    v_exp_f32 v122, v122
    ds_read_b128 v[232:235], v2 offset:18432
    v_exp_f32 v123, v123
    v_exp_f32 v124, v124
    v_mfma_f32_32x32x16_bf16 v[136:151], v[36:39], v[116:119], v[240:255]
    v_exp_f32 v125, v125
    v_exp_f32 v126, v126
    s_add_u32 m0, s26, 5120
    s_add_u32 s53, s24, 5120
    buffer_load_dwordx4 v2, s[96:99], s53 offen sc1 lds
    v_exp_f32 v127, v127
    v_exp_f32 v128, v128
    v_exp_f32 v129, v129
    v_exp_f32 v130, v130
    v_smfmac_f32_32x32x32_bf16 v[168:183], v[80:83], v[120:127], v14
    s_add_u32 m0, s26, 6144
    s_add_u32 s53, s24, 6144
    buffer_load_dwordx4 v2, s[96:99], s53 offen sc1 lds
    v_exp_f32 v131, v131
    v_exp_f32 v132, v132
    v_exp_f32 v133, v133
    s_waitcnt lgkmcnt(0)
    s_waitcnt vmcnt(13)
    v_smfmac_f32_16x16x64_bf16 v[216:219], v[232:235], v[184:191], v15
    v_exp_f32 v134, v134
    v_exp_f32 v135, v135
    s_waitcnt vmcnt(10)
    v_smfmac_f32_16x16x64_bf16 v[220:223], v[232:235], v[192:199], v15
    v_exp_f32 v136, v136
    v_exp_f32 v137, v137
    v_smfmac_f32_32x32x32_bf16 v[168:183], v[84:87], v[128:135], v14
    v_exp_f32 v138, v138
    v_exp_f32 v139, v139
    s_add_u32 s48, s33, 5
    s_and_b32 s48, s48, 7
    s_lshl_b32 s48, s48, 16
    s_add_u32 s48, s48, s27
    buffer_load_dwordx4 v[184:187], v2, s[12:15], s48 offen offset:0 sc1
    v_exp_f32 v140, v140
    v_mfma_f32_32x32x16_bf16 v[120:135], v[40:43], v[116:119], v[240:255]
    v_exp_f32 v141, v141
    v_exp_f32 v142, v142
    v_exp_f32 v143, v143
    s_waitcnt vmcnt(8)
    v_smfmac_f32_16x16x64_bf16 v[224:227], v[232:235], v[200:207], v15
    v_exp_f32 v144, v144
    v_exp_f32 v145, v145
    v_exp_f32 v146, v146
    v_smfmac_f32_32x32x32_bf16 v[168:183], v[88:91], v[136:143], v14
    v_exp_f32 v147, v147
    buffer_load_dwordx4 v[188:191], v2, s[12:15], s48 offen offset:1024 sc1
    v_exp_f32 v148, v148
    v_exp_f32 v149, v149
    s_waitcnt vmcnt(7)
    v_smfmac_f32_16x16x64_bf16 v[228:231], v[232:235], v[208:215], v15
    v_exp_f32 v150, v150
    v_exp_f32 v151, v151
    s_setprio 2
    v_exp_f32 v120, v120
    v_exp_f32 v121, v121
    v_smfmac_f32_32x32x32_bf16 v[168:183], v[92:95], v[144:151], v14
    v_exp_f32 v122, v122
    v_exp_f32 v123, v123
    buffer_load_dwordx4 v[192:195], v2, s[12:15], s48 offen offset:2048 sc1
    v_exp_f32 v124, v124
    v_mfma_f32_32x32x16_bf16 v[136:151], v[44:47], v[116:119], v[240:255]
    v_exp_f32 v125, v125
    v_exp_f32 v126, v126
    v_exp_f32 v127, v127
    s_add_u32 m0, s26, 7168
    s_add_u32 s53, s24, 7168
    buffer_load_dwordx4 v2, s[96:99], s53 offen sc1 lds
    v_exp_f32 v128, v128
    v_exp_f32 v129, v129
    v_exp_f32 v130, v130
    v_smfmac_f32_32x32x32_bf16 v[168:183], v[96:99], v[120:127], v14
    v_exp_f32 v131, v131
    v_exp_f32 v132, v132
    buffer_load_dwordx4 v[196:199], v2, s[12:15], s48 offen offset:3072 sc1
    v_exp_f32 v133, v133
    v_exp_f32 v134, v134
    v_exp_f32 v135, v135
    v_exp_f32 v136, v136
    v_exp_f32 v137, v137
    v_smfmac_f32_32x32x32_bf16 v[168:183], v[100:103], v[128:135], v14
    v_exp_f32 v138, v138
    v_exp_f32 v139, v139
    s_add_u32 s48, s48, 4096
    buffer_load_dwordx4 v[200:203], v2, s[12:15], s48 offen offset:0 sc1
    v_exp_f32 v140, v140
    ds_read_b32 v240, v12 offset:21248
    s_waitcnt lgkmcnt(0)
    v_sub_f32 v240, 0, v240
    v_mov_b32 v241, v240
    v_mov_b32 v242, v240
    v_mov_b32 v243, v240
    v_mov_b32 v244, v240
    v_mov_b32 v245, v240
    v_mov_b32 v246, v240
    v_mov_b32 v247, v240
    v_mov_b32 v248, v240
    v_mov_b32 v249, v240
    v_mov_b32 v250, v240
    v_mov_b32 v251, v240
    v_mov_b32 v252, v240
    v_mov_b32 v253, v240
    v_mov_b32 v254, v240
    v_mov_b32 v255, v240
    s_nop 1
    s_waitcnt vmcnt(8)
    v_mfma_f32_32x32x16_bf16 v[120:135], v[16:19], v[112:115], v[240:255]
    v_exp_f32 v141, v141
    v_exp_f32 v142, v142
    v_exp_f32 v143, v143
    s_add_u32 m0, s26, 8192
    s_add_u32 s53, s24, 8192
    buffer_load_dwordx4 v2, s[96:99], s53 offen sc1 lds
    v_exp_f32 v144, v144
    v_exp_f32 v145, v145
    v_exp_f32 v146, v146
    v_smfmac_f32_32x32x32_bf16 v[168:183], v[104:107], v[136:143], v14
    v_exp_f32 v147, v147
    buffer_load_dwordx4 v[204:207], v2, s[12:15], s48 offen offset:1024 sc1
    v_exp_f32 v148, v148
    v_exp_f32 v149, v149
    s_waitcnt lgkmcnt(0)
    v_mfma_f32_32x32x16_bf16 v[152:167], v[236:239], v[236:239], 0
    v_exp_f32 v150, v150
    v_exp_f32 v151, v151
    s_setprio 1
    v_exp_f32 v120, v120
    v_exp_f32 v121, v121
    v_smfmac_f32_32x32x32_bf16 v[168:183], v[108:111], v[144:151], v14
    v_exp_f32 v122, v122
    buffer_load_dwordx4 v[208:211], v2, s[12:15], s48 offen offset:2048 sc1
    v_exp_f32 v123, v123
    v_exp_f32 v124, v124
    v_mfma_f32_32x32x16_bf16 v[136:151], v[20:23], v[112:115], v[240:255]
    v_exp_f32 v125, v125
    v_exp_f32 v126, v126
    v_exp_f32 v127, v127
    buffer_load_dwordx4 v[212:215], v2, s[12:15], s48 offen offset:3072 sc1
    v_exp_f32 v128, v128
    v_exp_f32 v129, v129
    v_exp_f32 v130, v130
    v_smfmac_f32_32x32x32_bf16 v[152:167], v[48:51], v[120:127], v14
    s_add_u32 m0, s26, 9216
    s_add_u32 s53, s24, 9216
    buffer_load_dwordx4 v2, s[96:99], s53 offen sc1 lds
    v_exp_f32 v131, v131
    v_exp_f32 v132, v132
    buffer_load_dwordx4 v[8:11], v2, s[12:15], s44 offen offset:0 sc1
    v_exp_f32 v133, v133
    v_exp_f32 v134, v134
    ds_write2st64_b32 v7, v168, v169 offset0:0 offset1:1
    ds_write2st64_b32 v7, v170, v171 offset0:2 offset1:3
    ds_write2st64_b32 v7, v172, v173 offset0:4 offset1:5
    ds_write2st64_b32 v7, v174, v175 offset0:6 offset1:7
    ds_write_b32 v7, v176 offset:2048
    v_exp_f32 v135, v135
    s_setprio 0
    v_exp_f32 v136, v136
    v_exp_f32 v137, v137
    v_smfmac_f32_32x32x32_bf16 v[152:167], v[52:55], v[128:135], v14
    v_exp_f32 v138, v138
    v_exp_f32 v139, v139
    v_exp_f32 v140, v140
    v_mfma_f32_32x32x16_bf16 v[120:135], v[24:27], v[112:115], v[240:255]
    v_exp_f32 v141, v141
    v_exp_f32 v142, v142
    v_exp_f32 v143, v143
    v_exp_f32 v144, v144
    v_exp_f32 v145, v145
    v_exp_f32 v146, v146
    v_smfmac_f32_32x32x32_bf16 v[152:167], v[56:59], v[136:143], v14
    v_exp_f32 v147, v147
    v_exp_f32 v148, v148
    v_exp_f32 v149, v149
    v_exp_f32 v150, v150
    v_exp_f32 v151, v151
    s_setprio 3
    s_waitcnt lgkmcnt(0)
    s_barrier
    v_exp_f32 v120, v120
    ds_read2st64_b32 v[176:177], v4 offset0:8 offset1:17
    v_exp_f32 v121, v121
    v_smfmac_f32_32x32x32_bf16 v[152:167], v[60:63], v[144:151], v14
    v_exp_f32 v122, v122
    ds_read2st64_b32 v[178:179], v4 offset0:26 offset1:35
    v_exp_f32 v123, v123
    v_exp_f32 v124, v124
    v_mfma_f32_32x32x16_bf16 v[136:151], v[28:31], v[112:115], v[240:255]
    ds_read2st64_b32 v[180:181], v4 offset0:44 offset1:53
    v_exp_f32 v125, v125
    v_exp_f32 v126, v126
    ds_read2st64_b32 v[182:183], v4 offset0:62 offset1:71
    v_exp_f32 v127, v127
    v_exp_f32 v128, v128
    ds_read2st64_b32 v[168:169], v13 offset0:0 offset1:9
    v_exp_f32 v129, v129
    v_exp_f32 v130, v130
    v_smfmac_f32_32x32x32_bf16 v[152:167], v[64:67], v[120:127], v14
    ds_read2st64_b32 v[170:171], v13 offset0:18 offset1:27
    v_exp_f32 v131, v131
    v_exp_f32 v132, v132
    ds_read2st64_b32 v[172:173], v13 offset0:36 offset1:45
    v_exp_f32 v133, v133
    ds_read2st64_b32 v[174:175], v13 offset0:54 offset1:63
    v_exp_f32 v134, v134
    v_exp_f32 v135, v135
    s_setprio 2
    v_exp_f32 v136, v136
    v_exp_f32 v137, v137
    v_smfmac_f32_32x32x32_bf16 v[152:167], v[68:71], v[128:135], v14
    v_exp_f32 v138, v138
    v_exp_f32 v139, v139
    s_waitcnt lgkmcnt(0)
    v_pk_add_f32 v[176:177], v[176:177], v[178:179]
    v_pk_add_f32 v[180:181], v[180:181], v[182:183]
    v_pk_add_f32 v[168:169], v[168:169], v[170:171]
    v_pk_add_f32 v[172:173], v[172:173], v[174:175]
    v_pk_add_f32 v[176:177], v[176:177], v[180:181]
    v_pk_add_f32 v[168:169], v[168:169], v[172:173]
    v_add_f32 v176, v176, v177
    v_rcp_f32 v176, v176
    v_add_f32 v168, v168, v169
    v_exp_f32 v140, v140
    v_mfma_f32_32x32x16_bf16 v[120:135], v[32:35], v[112:115], v[240:255]
    v_mul_f32 v168, v168, v176
    v_cvt_pk_bf16_f32 v168, v168, v168
    ds_write_b16 v5, v168 offset:19456
    v_exp_f32 v141, v141
    v_exp_f32 v142, v142
    v_exp_f32 v143, v143
    v_exp_f32 v144, v144
    v_exp_f32 v145, v145
    v_exp_f32 v146, v146
    v_smfmac_f32_32x32x32_bf16 v[152:167], v[72:75], v[136:143], v14
    v_exp_f32 v147, v147
    v_exp_f32 v148, v148
    v_exp_f32 v149, v149
    v_exp_f32 v150, v150
    v_exp_f32 v151, v151
    s_setprio 3
    s_waitcnt lgkmcnt(0)
    s_barrier
    v_exp_f32 v120, v120
    s_add_u32 s22, s33, 7
    s_and_b32 s22, s22, 7
    s_lshl_b32 s22, s22, 10
    s_add_u32 s22, s22, s21
    buffer_load_dwordx4 v[116:119], v2, s[12:15], s22 offen sc1
    v_exp_f32 v121, v121
    v_smfmac_f32_32x32x32_bf16 v[152:167], v[76:79], v[144:151], v14
    v_exp_f32 v122, v122
    ds_read_b128 v[232:235], v2 offset:19456
    v_exp_f32 v123, v123
    v_exp_f32 v124, v124
    v_mfma_f32_32x32x16_bf16 v[136:151], v[36:39], v[112:115], v[240:255]
    v_exp_f32 v125, v125
    v_exp_f32 v126, v126
    s_add_u32 m0, s26, 10240
    s_add_u32 s53, s24, 10240
    buffer_load_dwordx4 v2, s[96:99], s53 offen sc1 lds
    v_exp_f32 v127, v127
    v_exp_f32 v128, v128
    s_waitcnt vmcnt(2)
    s_mov_b32 s54, 0
L_rc36:
    v_cmp_eq_u32 vcc, s92, v9
    v_cmp_eq_u32 s[46:47], s92, v11
    s_and_b64 vcc, vcc, s[46:47]
    s_cmp_eq_u64 vcc, -1
    s_cbranch_scc1 L_rc36_ok
    s_add_u32 s54, s54, 1
    s_cmp_gt_u32 s54, 1048576
    s_cbranch_scc1 L_rc36_ok
    s_sleep 4
    buffer_load_dwordx4 v[8:11], v2, s[12:15], s44 offen offset:0 sc1
    s_waitcnt vmcnt(0)
    s_branch L_rc36
L_rc36_ok:
    s_lshl_b32 s53, s3, 10
    s_add_u32 s53, s53, 155648
    v_lshl_add_u32 v9, v1, 3, s53
    s_cmp_ge_u32 s3, 2
    s_cselect_b32 s53, 0x3fb8aa3b, 1.0
    s_cmp_ge_u32 s3, 6
    s_cselect_b32 s53, 0x3f317218, s53
    v_mul_f32 v8, s53, v8
    v_mul_f32 v10, s53, v10
    ds_write2_b32 v9, v8, v10 offset0:0 offset1:1
    v_exp_f32 v129, v129
    v_exp_f32 v130, v130
    v_smfmac_f32_32x32x32_bf16 v[152:167], v[80:83], v[120:127], v14
    s_add_u32 m0, s26, 11264
    s_add_u32 s53, s24, 11264
    buffer_load_dwordx4 v2, s[96:99], s53 offen sc1 lds
    v_exp_f32 v131, v131
    v_exp_f32 v132, v132
    v_exp_f32 v133, v133
    s_waitcnt lgkmcnt(1)
    v_smfmac_f32_16x16x64_bf16 v[216:219], v[232:235], v[184:191], v15
    v_exp_f32 v134, v134
    v_exp_f32 v135, v135
    v_smfmac_f32_16x16x64_bf16 v[220:223], v[232:235], v[192:199], v15
    v_exp_f32 v136, v136
    v_exp_f32 v137, v137
    v_smfmac_f32_32x32x32_bf16 v[152:167], v[84:87], v[128:135], v14
    v_exp_f32 v138, v138
    v_exp_f32 v139, v139
    s_add_u32 s48, s33, 6
    s_and_b32 s48, s48, 7
    s_lshl_b32 s48, s48, 16
    s_add_u32 s48, s48, s27
    buffer_load_dwordx4 v[184:187], v2, s[12:15], s48 offen offset:0 sc1
    v_exp_f32 v140, v140
    v_mfma_f32_32x32x16_bf16 v[120:135], v[40:43], v[112:115], v[240:255]
    v_exp_f32 v141, v141
    s_waitcnt lgkmcnt(0)
    buffer_load_dwordx4 v[8:11], v2, s[12:15], s44 offen offset:1024 sc1
    v_exp_f32 v142, v142
    v_exp_f32 v143, v143
    v_smfmac_f32_16x16x64_bf16 v[224:227], v[232:235], v[200:207], v15
    v_exp_f32 v144, v144
    v_exp_f32 v145, v145
    v_exp_f32 v146, v146
    v_smfmac_f32_32x32x32_bf16 v[152:167], v[88:91], v[136:143], v14
    v_exp_f32 v147, v147
    buffer_load_dwordx4 v[188:191], v2, s[12:15], s48 offen offset:1024 sc1
    v_exp_f32 v148, v148
    v_exp_f32 v149, v149
    v_smfmac_f32_16x16x64_bf16 v[228:231], v[232:235], v[208:215], v15
    v_exp_f32 v150, v150
    v_exp_f32 v151, v151
    s_setprio 2
    v_exp_f32 v120, v120
    v_exp_f32 v121, v121
    v_smfmac_f32_32x32x32_bf16 v[152:167], v[92:95], v[144:151], v14
    v_exp_f32 v122, v122
    v_exp_f32 v123, v123
    buffer_load_dwordx4 v[192:195], v2, s[12:15], s48 offen offset:2048 sc1
    v_exp_f32 v124, v124
    v_mfma_f32_32x32x16_bf16 v[136:151], v[44:47], v[112:115], v[240:255]
    v_exp_f32 v125, v125
    v_exp_f32 v126, v126
    v_exp_f32 v127, v127
    s_add_u32 m0, s101, 0
    s_add_u32 s53, s100, 0
    buffer_load_dwordx4 v2, s[12:15], s53 offen sc1 lds
    v_exp_f32 v128, v128
    v_exp_f32 v129, v129
    v_exp_f32 v130, v130
    v_smfmac_f32_32x32x32_bf16 v[152:167], v[96:99], v[120:127], v14
    v_exp_f32 v131, v131
    v_exp_f32 v132, v132
    buffer_load_dwordx4 v[196:199], v2, s[12:15], s48 offen offset:3072 sc1
    v_exp_f32 v133, v133
    v_exp_f32 v134, v134
    v_exp_f32 v135, v135
    v_exp_f32 v136, v136
    v_exp_f32 v137, v137
    v_smfmac_f32_32x32x32_bf16 v[152:167], v[100:103], v[128:135], v14
    v_exp_f32 v138, v138
    v_exp_f32 v139, v139
    s_add_u32 s48, s48, 4096
    buffer_load_dwordx4 v[200:203], v2, s[12:15], s48 offen offset:0 sc1
    v_exp_f32 v140, v140
    ds_read_b32 v240, v12 offset:21376
    s_waitcnt lgkmcnt(0)
    v_sub_f32 v240, 0, v240
    v_mov_b32 v241, v240
    v_mov_b32 v242, v240
    v_mov_b32 v243, v240
    v_mov_b32 v244, v240
    v_mov_b32 v245, v240
    v_mov_b32 v246, v240
    v_mov_b32 v247, v240
    v_mov_b32 v248, v240
    v_mov_b32 v249, v240
    v_mov_b32 v250, v240
    v_mov_b32 v251, v240
    v_mov_b32 v252, v240
    v_mov_b32 v253, v240
    v_mov_b32 v254, v240
    v_mov_b32 v255, v240
    s_nop 1
    s_waitcnt vmcnt(9)
    v_mfma_f32_32x32x16_bf16 v[120:135], v[16:19], v[116:119], v[240:255]
    v_exp_f32 v141, v141
    v_exp_f32 v142, v142
    v_exp_f32 v143, v143
    s_add_u32 m0, s101, 1024
    s_add_u32 s53, s100, 1024
    buffer_load_dwordx4 v2, s[12:15], s53 offen sc1 lds
    v_exp_f32 v144, v144
    v_exp_f32 v145, v145
    v_exp_f32 v146, v146
    v_smfmac_f32_32x32x32_bf16 v[152:167], v[104:107], v[136:143], v14
    v_exp_f32 v147, v147
    buffer_load_dwordx4 v[204:207], v2, s[12:15], s48 offen offset:1024 sc1
    v_exp_f32 v148, v148
    v_exp_f32 v149, v149
    s_waitcnt lgkmcnt(0)
    v_mfma_f32_32x32x16_bf16 v[168:183], v[236:239], v[236:239], 0
    v_exp_f32 v150, v150
    v_exp_f32 v151, v151
    s_setprio 1
    v_exp_f32 v120, v120
    v_exp_f32 v121, v121
    v_smfmac_f32_32x32x32_bf16 v[152:167], v[108:111], v[144:151], v14
    v_exp_f32 v122, v122
    buffer_load_dwordx4 v[208:211], v2, s[12:15], s48 offen offset:2048 sc1
    v_exp_f32 v123, v123
    v_exp_f32 v124, v124
    v_mfma_f32_32x32x16_bf16 v[136:151], v[20:23], v[116:119], v[240:255]
    s_waitcnt vmcnt(8)
    s_mov_b32 s54, 0
L_rc37:
    v_cmp_eq_u32 vcc, s92, v9
    v_cmp_eq_u32 s[46:47], s92, v11
    s_and_b64 vcc, vcc, s[46:47]
    s_cmp_eq_u64 vcc, -1
    s_cbranch_scc1 L_rc37_ok
    s_add_u32 s54, s54, 1
    s_cmp_gt_u32 s54, 1048576
    s_cbranch_scc1 L_rc37_ok
    s_sleep 4
    buffer_load_dwordx4 v[8:11], v2, s[12:15], s44 offen offset:1024 sc1
    s_waitcnt vmcnt(0)
    s_branch L_rc37
L_rc37_ok:
    s_lshl_b32 s53, s3, 10
    s_add_u32 s53, s53, 156160
    v_lshl_add_u32 v9, v1, 3, s53
    s_cmp_ge_u32 s3, 2
    s_cselect_b32 s53, 0x3fb8aa3b, 1.0
    s_cmp_ge_u32 s3, 6
    s_cselect_b32 s53, 0x3f317218, s53
    v_mul_f32 v8, s53, v8
    v_mul_f32 v10, s53, v10
    ds_write2_b32 v9, v8, v10 offset0:0 offset1:1
    v_exp_f32 v125, v125
    v_exp_f32 v126, v126
    v_exp_f32 v127, v127
    buffer_load_dwordx4 v[212:215], v2, s[12:15], s48 offen offset:3072 sc1
    v_exp_f32 v128, v128
    v_exp_f32 v129, v129
    v_exp_f32 v130, v130
    v_smfmac_f32_32x32x32_bf16 v[168:183], v[48:51], v[120:127], v14
    s_add_u32 m0, s101, 2048
    s_add_u32 s53, s100, 2048
    buffer_load_dwordx4 v2, s[12:15], s53 offen sc1 lds
    v_exp_f32 v131, v131
    v_exp_f32 v132, v132
    v_exp_f32 v133, v133
    s_waitcnt lgkmcnt(0)
    buffer_load_dwordx4 v[8:11], v3, s[8:11], s30 offen
    v_lshrrev_b32 v6, 3, v1
    s_add_u32 s53, s50, 155648
    v_lshl_add_u32 v6, v6, 5, s53
    v_exp_f32 v134, v134
    ds_write2st64_b32 v7, v152, v153 offset0:0 offset1:1
    ds_write2st64_b32 v7, v154, v155 offset0:2 offset1:3
    ds_write2st64_b32 v7, v156, v157 offset0:4 offset1:5
    ds_write2st64_b32 v7, v158, v159 offset0:6 offset1:7
    ds_write_b32 v7, v160 offset:2048
    v_exp_f32 v135, v135
    s_setprio 0
    v_exp_f32 v136, v136
    v_exp_f32 v137, v137
    v_smfmac_f32_32x32x32_bf16 v[168:183], v[52:55], v[128:135], v14
    v_exp_f32 v138, v138
    v_exp_f32 v139, v139
    v_exp_f32 v140, v140
    v_mfma_f32_32x32x16_bf16 v[120:135], v[24:27], v[116:119], v[240:255]
    v_exp_f32 v141, v141
    v_exp_f32 v142, v142
    v_exp_f32 v143, v143
    v_exp_f32 v144, v144
    v_exp_f32 v145, v145
    v_exp_f32 v146, v146
    v_smfmac_f32_32x32x32_bf16 v[168:183], v[56:59], v[136:143], v14
    v_exp_f32 v147, v147
    v_exp_f32 v148, v148
    v_exp_f32 v149, v149
    v_exp_f32 v150, v150
    v_exp_f32 v151, v151
    s_setprio 3
    s_waitcnt lgkmcnt(0)
    s_barrier
    v_exp_f32 v120, v120
    ds_read2st64_b32 v[160:161], v4 offset0:8 offset1:17
    v_exp_f32 v121, v121
    v_smfmac_f32_32x32x32_bf16 v[168:183], v[60:63], v[144:151], v14
    v_exp_f32 v122, v122
    ds_read2st64_b32 v[162:163], v4 offset0:26 offset1:35
    v_exp_f32 v123, v123
    v_exp_f32 v124, v124
    v_mfma_f32_32x32x16_bf16 v[136:151], v[28:31], v[116:119], v[240:255]
    ds_read2st64_b32 v[164:165], v4 offset0:44 offset1:53
    v_exp_f32 v125, v125
    v_exp_f32 v126, v126
    ds_read2st64_b32 v[166:167], v4 offset0:62 offset1:71
    v_exp_f32 v127, v127
    v_exp_f32 v128, v128
    ds_read2st64_b32 v[152:153], v13 offset0:0 offset1:9
    v_exp_f32 v129, v129
    v_exp_f32 v130, v130
    v_smfmac_f32_32x32x32_bf16 v[168:183], v[64:67], v[120:127], v14
    ds_read2st64_b32 v[154:155], v13 offset0:18 offset1:27
    v_exp_f32 v131, v131
    v_exp_f32 v132, v132
    ds_read2st64_b32 v[156:157], v13 offset0:36 offset1:45
    v_exp_f32 v133, v133
    ds_read2st64_b32 v[158:159], v13 offset0:54 offset1:63
    v_exp_f32 v134, v134
    v_exp_f32 v135, v135
    s_setprio 2
    v_exp_f32 v136, v136
    v_exp_f32 v137, v137
    v_smfmac_f32_32x32x32_bf16 v[168:183], v[68:71], v[128:135], v14
    v_exp_f32 v138, v138
    v_exp_f32 v139, v139
    s_waitcnt lgkmcnt(0)
    v_pk_add_f32 v[160:161], v[160:161], v[162:163]
    v_pk_add_f32 v[164:165], v[164:165], v[166:167]
    v_pk_add_f32 v[152:153], v[152:153], v[154:155]
    v_pk_add_f32 v[156:157], v[156:157], v[158:159]
    v_pk_add_f32 v[160:161], v[160:161], v[164:165]
    v_pk_add_f32 v[152:153], v[152:153], v[156:157]
    v_add_f32 v160, v160, v161
    v_rcp_f32 v160, v160
    v_add_f32 v152, v152, v153
    v_exp_f32 v140, v140
    v_mfma_f32_32x32x16_bf16 v[120:135], v[32:35], v[116:119], v[240:255]
    v_mul_f32 v152, v152, v160
    v_cvt_pk_bf16_f32 v152, v152, v152
    ds_write_b16 v5, v152 offset:18432
    v_exp_f32 v141, v141
    v_exp_f32 v142, v142
    v_exp_f32 v143, v143
    v_exp_f32 v144, v144
    v_exp_f32 v145, v145
    v_exp_f32 v146, v146
    v_smfmac_f32_32x32x32_bf16 v[168:183], v[72:75], v[136:143], v14
    v_exp_f32 v147, v147
    v_exp_f32 v148, v148
    v_exp_f32 v149, v149
    v_exp_f32 v150, v150
    v_exp_f32 v151, v151
    s_setprio 3
    s_waitcnt lgkmcnt(0)
    s_barrier
    v_exp_f32 v120, v120
    v_exp_f32 v121, v121
    v_smfmac_f32_32x32x32_bf16 v[168:183], v[76:79], v[144:151], v14
    v_exp_f32 v122, v122
    ds_read_b128 v[232:235], v2 offset:18432
    v_exp_f32 v123, v123
    v_exp_f32 v124, v124
    v_mfma_f32_32x32x16_bf16 v[136:151], v[36:39], v[116:119], v[240:255]
    v_exp_f32 v125, v125
    v_exp_f32 v126, v126
    s_add_u32 m0, s101, 3072
    s_add_u32 s53, s100, 3072
    buffer_load_dwordx4 v2, s[12:15], s53 offen sc1 lds
    v_exp_f32 v127, v127
    v_exp_f32 v128, v128
    v_exp_f32 v129, v129
    v_exp_f32 v130, v130
    v_smfmac_f32_32x32x32_bf16 v[168:183], v[80:83], v[120:127], v14
    v_exp_f32 v131, v131
    v_exp_f32 v132, v132
    v_exp_f32 v133, v133
    s_waitcnt lgkmcnt(0)
    s_waitcnt vmcnt(11)
    v_smfmac_f32_16x16x64_bf16 v[216:219], v[232:235], v[184:191], v15
    v_exp_f32 v134, v134
    v_exp_f32 v135, v135
    s_setprio 2
    s_waitcnt vmcnt(8)
    v_smfmac_f32_16x16x64_bf16 v[220:223], v[232:235], v[192:199], v15
    v_exp_f32 v136, v136
    v_exp_f32 v137, v137
    v_smfmac_f32_32x32x32_bf16 v[168:183], v[84:87], v[128:135], v14
    v_exp_f32 v138, v138
    s_add_u32 s48, s33, 7
    s_and_b32 s48, s48, 7
    s_lshl_b32 s48, s48, 16
    s_add_u32 s48, s48, s27
    buffer_load_dwordx4 v[184:187], v2, s[12:15], s48 offen offset:0 sc1
    v_exp_f32 v139, v139
    v_exp_f32 v140, v140
    v_mfma_f32_32x32x16_bf16 v[120:135], v[40:43], v[116:119], v[240:255]
    v_exp_f32 v141, v141
    buffer_load_dwordx4 v[188:191], v2, s[12:15], s48 offen offset:1024 sc1
    v_exp_f32 v142, v142
    v_exp_f32 v143, v143
    s_waitcnt vmcnt(7)
    v_smfmac_f32_16x16x64_bf16 v[224:227], v[232:235], v[200:207], v15
    v_exp_f32 v144, v144
    v_exp_f32 v145, v145
    buffer_load_dwordx4 v[192:195], v2, s[12:15], s48 offen offset:2048 sc1
    v_exp_f32 v146, v146
    v_smfmac_f32_32x32x32_bf16 v[168:183], v[88:91], v[136:143], v14
    v_exp_f32 v147, v147
    v_exp_f32 v148, v148
    buffer_load_dwordx4 v[196:199], v2, s[12:15], s48 offen offset:3072 sc1
    v_exp_f32 v149, v149
    s_waitcnt vmcnt(7)
    v_smfmac_f32_16x16x64_bf16 v[228:231], v[232:235], v[208:215], v15
    v_exp_f32 v150, v150
    v_exp_f32 v151, v151
    s_setprio 1
    ds_read_b128 v[152:155], v6 offset:0
    v_exp_f32 v120, v120
    s_add_u32 s48, s48, 4096
    buffer_load_dwordx4 v[200:203], v2, s[12:15], s48 offen offset:0 sc1
    v_exp_f32 v121, v121
    v_smfmac_f32_32x32x32_bf16 v[168:183], v[92:95], v[144:151], v14
    v_exp_f32 v122, v122
    ds_read_b128 v[156:159], v6 offset:16
    v_exp_f32 v123, v123
    buffer_load_dwordx4 v[204:207], v2, s[12:15], s48 offen offset:1024 sc1
    v_exp_f32 v124, v124
    v_mfma_f32_32x32x16_bf16 v[136:151], v[44:47], v[116:119], v[240:255]
    v_exp_f32 v125, v125
    ds_read_b128 v[160:163], v6 offset:2048
    v_exp_f32 v126, v126
    v_exp_f32 v127, v127
    buffer_load_dwordx4 v[208:211], v2, s[12:15], s48 offen offset:2048 sc1
    v_exp_f32 v128, v128
    ds_read_b128 v[164:167], v6 offset:2064
    v_exp_f32 v129, v129
    v_exp_f32 v130, v130
    v_smfmac_f32_32x32x32_bf16 v[168:183], v[96:99], v[120:127], v14
    v_exp_f32 v131, v131
    ds_read_b128 v[112:115], v6 offset:4096
    v_exp_f32 v132, v132
    buffer_load_dwordx4 v[212:215], v2, s[12:15], s48 offen offset:3072 sc1
    v_exp_f32 v133, v133
    ds_read_b128 v[236:239], v6 offset:4112
    v_exp_f32 v134, v134
    v_exp_f32 v135, v135
    s_setprio 0
    v_exp_f32 v136, v136
    v_exp_f32 v137, v137
    v_smfmac_f32_32x32x32_bf16 v[168:183], v[100:103], v[128:135], v14
    v_exp_f32 v138, v138
    v_exp_f32 v139, v139
    v_exp_f32 v140, v140
    v_exp_f32 v141, v141
    v_exp_f32 v142, v142
    v_exp_f32 v143, v143
    v_exp_f32 v144, v144
    v_exp_f32 v145, v145
    v_exp_f32 v146, v146
    v_smfmac_f32_32x32x32_bf16 v[168:183], v[104:107], v[136:143], v14
    v_exp_f32 v147, v147
    v_exp_f32 v148, v148
    v_exp_f32 v149, v149
    v_exp_f32 v150, v150
    v_exp_f32 v151, v151
    s_nop 1
    v_smfmac_f32_32x32x32_bf16 v[168:183], v[108:111], v[144:151], v14
    s_branch L_kb_tail
.section .rodata,"a"
.p2align 6
.amdhsa_kernel adaLN_cond__grouped_kv_mqa__dense_activation_silu__prompt_kernel
  .amdhsa_next_free_vgpr 256
  .amdhsa_next_free_sgpr 102
  .amdhsa_accum_offset 256
  .amdhsa_group_segment_fixed_size 0
  .amdhsa_kernarg_size 104
  .amdhsa_user_sgpr_count 2
  .amdhsa_user_sgpr_kernarg_segment_ptr 1
  .amdhsa_system_sgpr_workgroup_id_x 1
.end_amdhsa_kernel
```
